```python
import torch

def _softmax(x, axis=-1):
    return torch.softmax(x, dim=axis)
def _gelu(x):
    return torch.nn.functional.gelu(x, approximate="tanh")
def _silu(x):
    return torch.nn.functional.silu(x)
def _sigmoid(x):
    return torch.sigmoid(x)
def _layernorm(x, axis=-1, eps=1e-5):
    m = x.mean(dim=axis, keepdim=True)
    v = x.var(dim=axis, keepdim=True, unbiased=False)
    return (x - m) / torch.sqrt(v + eps)
def _scatter_add(tgt, idx, src, axis=0):
    return tgt.clone().index_add_(axis, idx, src)
def _segment_sum(src, seg, n):
    out = torch.zeros((n,) + src.shape[1:], dtype=src.dtype)
    return out.index_add_(0, seg, src)
def _pad(x, pw):
    flat = tuple(v for pair in reversed(pw) for v in pair)
    return torch.nn.functional.pad(x, flat)

kernel_name = 'recurrent_scan__spectral_gfnet__geglu_ffn__prompt'

def setup_inputs():

    _w = (lambda a: (lambda t: t.to(torch.bfloat16) if t.is_floating_point() else t)(torch.as_tensor(a)))
    def _A_setup():
        B, S, D = 1, 2048, 640
        Df = D // 2 + 1
        return {
            "x": _w((lambda *s: torch.randn(*s, dtype=torch.bfloat16) * 0.05)(B, S, D)),
            "w_r": _w((lambda *s: torch.randn(*s, dtype=torch.bfloat16) * 0.05)(S, Df) * 0.02),
            "w_i": _w((lambda *s: torch.randn(*s, dtype=torch.bfloat16) * 0.05)(S, Df) * 0.02),
        }
    _A_in = _A_setup()

    def _B_setup():
        B, S, D, F = 1, 2048, 640, 1536
        return {
            "x": _w((lambda *s: torch.randn(*s, dtype=torch.bfloat16) * 0.05)(B, S, D)),
            "w_gate": _w((lambda *s: torch.randn(*s, dtype=torch.bfloat16) * 0.05)(D, F)),
            "w_up": _w((lambda *s: torch.randn(*s, dtype=torch.bfloat16) * 0.05)(D, F)),
            "w_down": _w((lambda *s: torch.randn(*s, dtype=torch.bfloat16) * 0.05)(F, D)),
        }
    _B_in = _B_setup()

    return {
        "A_x": _A_in["x"],
        "A_w_r": _A_in["w_r"],
        "A_w_i": _A_in["w_i"],
        "B_x": _B_in["x"],
        "B_w_gate": _B_in["w_gate"],
        "B_w_up": _B_in["w_up"],
        "B_w_down": _B_in["w_down"],
    }

def reference(A_x, A_w_r, A_w_i, B_x, B_w_gate, B_w_up, B_w_down):
    def _A_ref(x, w_r, w_i):
        B, S, D = x.shape
        X = (lambda x, axes=(-2,-1): torch.fft.rfft2(x.float(), dim=axes))(x, axes=(-2, -1))
        W = w_r + 1j * w_i
        X = X * W
        y = (lambda x, s, axes=(-2,-1): torch.fft.irfft2(x, s=s, dim=axes).to(torch.bfloat16))(X, (S, D), axes=(-2, -1))
        return y

    def _B_ref(x, w_gate, w_up, w_down):
        return (_gelu(x @ w_gate) * (x @ w_up)) @ w_down

    x = A_x
    xn = _layernorm(x, axis=-1)
    s = _A_ref(xn, A_w_r, A_w_i)
    g = _silu(_B_ref(xn, B_w_gate, B_w_up, B_w_down))
    return x + s * g
```

```asm
; @launch grid=(256,1,1) block=(256,1,1) lds=163840
.amdgcn_target "amdgcn-amd-amdhsa--gfx950"
.text
.text
.globl recurrent_scan__spectral_gfnet__geglu_ffn__prompt_kernel
.p2align 8
.type recurrent_scan__spectral_gfnet__geglu_ffn__prompt_kernel,@function
recurrent_scan__spectral_gfnet__geglu_ffn__prompt_kernel:
    s_load_dwordx2 s[4:5], s[0:1], 0
    s_load_dwordx2 s[8:9], s[0:1], 72
    s_load_dwordx2 s[20:21], s[0:1], 48
    s_load_dwordx2 s[24:25], s[0:1], 56
    s_cmp_lt_u32 s2, 64
    s_cselect_b32 s3, 8, 32
    s_add_u32 s33, s3, 8
    s_load_dwordx2 s[12:13], s[0:1], s3
    s_load_dwordx2 s[16:17], s[0:1], s33
    s_cmp_ge_u32 s2, 256
    s_cbranch_scc1 L_end
    v_lshrrev_b32 v1, 6, v0
    v_and_b32 v0, 63, v0
    v_readfirstlane_b32 s32, v1
    s_getpc_b64 s[56:57]
L_pc:
    s_lshr_b32 s58, s2, 3
    s_and_b32 s58, s58, 31
    s_cmp_lg_u32 s32, 0
    s_cbranch_scc1 L_notouch
    v_lshl_add_u32 v28, v0, 5, s58
    v_lshlrev_b32 v28, 7, v28
    v_min_u32 v28, L_code_end-L_pc-4, v28
    v_mov_b32 v29, s57
    v_add_co_u32 v28, vcc, s56, v28
    s_nop 1
    v_addc_co_u32 v29, vcc, 0, v29, vcc
    global_load_dword a255, v[28:29], off
L_notouch:
    s_mov_b32 s6, 2621440
    s_mov_b32 s7, 0x20000
    s_mov_b32 s10, 16777216
    s_mov_b32 s11, 0x20000
    s_mov_b32 s22, 1966080
    s_mov_b32 s23, 0x20000
    s_mov_b32 s26, 2621440
    s_mov_b32 s27, 0x20000
    s_cmp_ge_u32 s2, 64
    s_cbranch_scc1 L_ffn
L_spec0:
    s_and_b32 s56, s2, 1
    s_lshl_b32 s56, s56, 3
    s_and_b32 s57, s2, 6
    s_add_u32 s56, s56, s57
    s_lshr_b32 s57, s2, 5
    s_add_u32 s33, s56, s57
    s_bfe_u32 s34, s2, 0x20003
    v_lshrrev_b32 v2, 3, v0
    v_and_b32 v3, 7, v0
    v_mul_u32_u24 v4, 20480, v2
    s_mul_i32 s57, s32, 163840
    s_mul_i32 s58, s33, 1280
    s_add_u32 s57, s57, s58
    v_add_u32 v4, s57, v4
    v_lshl_add_u32 v5, v3, 3, v4
    v_lshl_add_u32 v4, v3, 4, v4
    s_mul_i32 s58, s34, 655360
    s_add_u32 s68, s34, 0
    s_and_b32 s68, s68, 3
    s_mul_i32 s60, s68, 320
    s_add_u32 s60, s60, s58
    s_add_u32 s69, s34, 1
    s_and_b32 s69, s69, 3
    s_mul_i32 s61, s69, 320
    s_add_u32 s61, s61, s58
    s_add_u32 s70, s34, 2
    s_and_b32 s70, s70, 3
    s_mul_i32 s62, s70, 320
    s_add_u32 s62, s62, s58
    s_add_u32 s71, s34, 3
    s_and_b32 s71, s71, 3
    s_mul_i32 s63, s71, 320
    s_add_u32 s63, s63, s58
    s_waitcnt lgkmcnt(0)
    s_load_dwordx2 s[86:87], s[8:9], 0
    buffer_load_dwordx4 v[106:109], v4, s[4:7], s61 offen
    buffer_load_dwordx4 v[110:113], v4, s[4:7], s61 offen offset:128
    buffer_load_dwordx2 v[114:115], v5, s[4:7], s61 offen offset:256
    buffer_load_dwordx4 v[116:119], v4, s[4:7], s62 offen
    buffer_load_dwordx4 v[120:123], v4, s[4:7], s62 offen offset:128
    buffer_load_dwordx2 v[124:125], v5, s[4:7], s62 offen offset:256
    buffer_load_dwordx4 v[126:129], v4, s[4:7], s63 offen
    buffer_load_dwordx4 v[130:133], v4, s[4:7], s63 offen offset:128
    buffer_load_dwordx2 v[134:135], v5, s[4:7], s63 offen offset:256
    buffer_load_dwordx4 v[96:99], v4, s[4:7], s60 offen
    buffer_load_dwordx4 v[100:103], v4, s[4:7], s60 offen offset:128
    buffer_load_dwordx2 v[104:105], v5, s[4:7], s60 offen offset:256
    s_branch L_spec
L_ffn:
    s_lshr_b32 s77, s2, 3
    s_sub_u32 s77, s77, 8
    s_and_b32 s56, s77, 3
    s_lshr_b32 s57, s77, 2
    s_and_b32 s58, s2, 1
    s_lshl_b32 s59, s58, 2
    s_add_u32 s33, s59, s56
    s_bfe_u32 s59, s2, 0x20001
    s_mul_i32 s59, s59, 6
    s_add_u32 s34, s59, s57
    s_mul_i32 s59, s56, 5
    s_add_u32 s59, s59, 1
    s_lshr_b32 s59, s59, 1
    s_mul_i32 s60, s58, 1
    s_add_u32 s59, s59, s60
    s_mul_i32 s60, s34, 1
    s_add_u32 s59, s59, s60
    s_mul_i32 s60, s59, 205
    s_lshr_b32 s60, s60, 11
    s_mul_i32 s60, s60, 10
    s_sub_u32 s59, s59, s60
    s_lshl_b32 s60, s59, 7
    v_lshrrev_b32 v26, 3, v0
    v_and_b32 v27, 7, v0
    v_and_b32 v28, 2, v26
    v_xor_b32 v28, v27, v28
    v_mul_u32_u24 v2, 3072, v26
    v_lshl_add_u32 v2, v28, 4, v2
    s_mul_i32 s82, s32, 49152
    s_lshl_b32 s59, s34, 7
    s_add_u32 s82, s82, s59
    v_add_u32 v2, s82, v2
    v_xor_b32 v3, 64, v2
    v_add_u32 v3, 24576, v3
    s_lshl_b32 s83, s32, 12
    s_lshl_b32 s59, s32, 2
    v_lshrrev_b32 v29, 4, v0
    v_add_u32 v30, s59, v29
    v_and_b32 v30, 7, v30
    v_xor_b32 v30, v27, v30
    v_mul_u32_u24 v1, 20480, v26
    v_lshl_add_u32 v1, v30, 4, v1
    s_lshl_b32 s78, s32, 10
    s_mul_i32 s59, s32, 163840
    s_mul_i32 s58, s33, 2560
    s_add_u32 s59, s59, s58
    v_add_u32 v1, s59, v1
    s_mov_b32 s14, 1966080
    s_mov_b32 s15, 0x20000
    s_mov_b32 s18, 1966080
    s_mov_b32 s19, 0x20000
    s_add_u32 s61, s60, 128
    s_cmp_eq_u32 s61, 1280
    s_cselect_b32 s61, 0, s61
    s_add_u32 s62, s61, 128
    s_cmp_eq_u32 s62, 1280
    s_cselect_b32 s62, 0, s62
    s_waitcnt lgkmcnt(0)
    s_load_dwordx2 s[86:87], s[8:9], 0
    s_add_u32 m0, s83, 98304
    s_mul_i32 s59, s60, 1536
    buffer_load_dwordx4 v2, s[12:15], s59 offen lds
    s_add_u32 m0, s83, 99328
    s_nop 0
    buffer_load_dwordx4 v2, s[16:19], s59 offen lds
    s_add_u32 m0, s83, 100352
    s_nop 0
    buffer_load_dwordx4 v3, s[12:15], s59 offen lds
    s_add_u32 m0, s83, 101376
    s_nop 0
    buffer_load_dwordx4 v3, s[16:19], s59 offen lds
    s_add_u32 m0, s78, 4096
    s_nop 0
    buffer_load_dwordx4 v1, s[4:7], s60 offen offset:0 lds
    s_add_u32 m0, s78, 43776
    s_nop 0
    buffer_load_dwordx4 v1, s[4:7], s60 offen offset:1280 lds
    s_add_u32 m0, s83, 114688
    s_mul_i32 s59, s61, 1536
    buffer_load_dwordx4 v2, s[12:15], s59 offen lds
    s_add_u32 m0, s83, 115712
    s_nop 0
    buffer_load_dwordx4 v2, s[16:19], s59 offen lds
    s_add_u32 m0, s83, 116736
    s_nop 0
    buffer_load_dwordx4 v3, s[12:15], s59 offen lds
    s_add_u32 m0, s83, 117760
    s_nop 0
    buffer_load_dwordx4 v3, s[16:19], s59 offen lds
    s_add_u32 m0, s78, 8192
    s_nop 0
    buffer_load_dwordx4 v1, s[4:7], s61 offen offset:0 lds
    s_add_u32 m0, s78, 47872
    s_nop 0
    buffer_load_dwordx4 v1, s[4:7], s61 offen offset:1280 lds
    s_add_u32 s63, s62, 128
    s_cmp_eq_u32 s63, 1280
    s_cselect_b32 s63, 0, s63
    s_add_u32 s64, s63, 128
    s_cmp_eq_u32 s64, 1280
    s_cselect_b32 s64, 0, s64
    s_add_u32 s65, s64, 128
    s_cmp_eq_u32 s65, 1280
    s_cselect_b32 s65, 0, s65
    s_add_u32 s66, s65, 128
    s_cmp_eq_u32 s66, 1280
    s_cselect_b32 s66, 0, s66
    s_add_u32 s67, s66, 128
    s_cmp_eq_u32 s67, 1280
    s_cselect_b32 s67, 0, s67
    s_add_u32 s68, s67, 128
    s_cmp_eq_u32 s68, 1280
    s_cselect_b32 s68, 0, s68
    s_add_u32 s69, s68, 128
    s_cmp_eq_u32 s69, 1280
    s_cselect_b32 s69, 0, s69
    s_and_b32 s58, s2, 1
    s_lshl_b32 s58, s58, 3
    s_bfe_u32 s59, s2, 0x10001
    s_lshl_b32 s59, s59, 2
    s_add_u32 s58, s58, s59
    s_add_u32 s35, s58, s56
    s_bfe_u32 s59, s2, 0x10002
    s_mul_i32 s59, s59, 5
    s_add_u32 s3, s59, s57
    v_lshlrev_b32 v4, 4, v0
    s_lshl_b32 s76, s33, 13
    s_add_u32 s76, s76, 12582912
    s_mul_i32 s81, s33, 768
    s_lshl_b32 s56, s34, 2
    s_add_u32 s81, s81, s56
    s_add_u32 s81, s81, s32
    s_lshl_b32 s81, s81, 10
    s_add_u32 s81, s81, 6291456
    v_and_b32 v30, 15, v0
    v_lshrrev_b32 v31, 1, v30
    v_xor_b32 v31, v29, v31
    v_lshlrev_b32 v31, 4, v31
    v_lshl_add_u32 v8, v30, 7, v31
    v_xor_b32 v9, 64, v8
    v_add_u32 v10, 0x10000, v8
    v_add_u32 v11, 0x10000, v9
    v_lshlrev_b32 v20, 4, v30
    v_add_u32 v20, 0, v20
    s_add_u32 s56, s78, 0
    v_add_u32 v21, s56, v4
    v_bfe_u32 v30, v0, 2, 2
    v_and_b32 v31, 3, v0
    v_lshlrev_b32 v31, 3, v31
    v_lshl_add_u32 v30, v30, 7, v31
    v_bfe_u32 v31, v0, 3, 2
    v_lshl_add_u32 v12, v31, 5, v30
    v_xor_b32 v31, s32, v31
    v_lshl_add_u32 v5, v31, 5, v30
    v_lshl_add_u32 v5, v29, 11, v5
    v_add_u32 v5, 98304, v5
    s_lshl_b32 s79, s32, 13
    s_add_u32 s79, s79, 126976
    v_lshl_add_u32 v12, v29, 10, v12
    v_add_u32 v12, s79, v12
    v_xor_b32 v13, 32, v12
    v_xor_b32 v14, 64, v12
    v_xor_b32 v15, 96, v12
    v_mov_b32 v156, 0xbf80bf80
    v_mov_b32 v157, 0xbf80bf80
    v_mov_b32 v158, 0xbf80bf80
    v_mov_b32 v159, 0xbf80bf80
    v_mul_u32_u24 v16, 1280, v26
    v_lshl_add_u32 v16, v28, 4, v16
    s_mul_i32 s84, s32, 491520
    s_lshl_b32 s56, s3, 7
    s_add_u32 s84, s84, s56
    s_cmp_ge_u32 s77, 20
    s_cselect_b32 s88, 2130706432, 0
    s_cselect_b32 s84, 0, s84
    s_add_u32 s20, s20, s84
    s_addc_u32 s21, s21, 0
    s_sub_u32 s22, s22, s84
    v_add_u32 v16, s88, v16
    v_xor_b32 v17, 64, v16
    v_add_u32 v17, 9216, v17
    v_add_u32 v18, 18432, v16
    v_add_u32 v19, 18432, v17
    s_mul_i32 s56, s33, 24
    s_add_u32 s56, s56, s34
    s_lshl_b32 s56, s56, 2
    s_add_u32 s56, s56, s32
    s_mul_i32 s56, s56, 128
    v_lshrrev_b32 v30, 4, v0
    v_lshlrev_b32 v30, 24, v30
    v_lshl_add_u32 v30, v0, 3, v30
    v_add_u32 v7, s56, v30
    v_lshrrev_b32 v30, 5, v0
    v_mul_u32_u24 v30, 3584, v30
    v_add3_u32 v22, v30, v4, s78
    v_min_u32 v30, 23, v0
    s_lshr_b32 s56, s35, 1
    s_lshl_b32 s56, s56, 2
    s_add_u32 s56, s56, s32
    s_mul_i32 s56, s56, 24
    v_add_u32 v30, s56, v30
    v_mul_u32_u24 v25, 128, v30
    s_mov_b32 s28, 12648448
    s_mov_b32 s29, 12746752
    s_mov_b32 s80, 12845056
    s_mov_b32 s89, 12943360
    s_sub_u32 s56, 1280, s60
    s_cmp_eq_u32 s56, 1280
    s_cselect_b32 s56, 0, s56
    s_lshl_b32 s70, s56, 5
    s_add_u32 s70, s70, s78
    s_add_u32 s56, s56, 128
    s_cmp_eq_u32 s56, 1280
    s_cselect_b32 s56, 0, s56
    s_lshl_b32 s71, s56, 5
    s_add_u32 s71, s71, s78
    s_add_u32 s56, s56, 128
    s_cmp_eq_u32 s56, 1280
    s_cselect_b32 s56, 0, s56
    s_lshl_b32 s72, s56, 5
    s_add_u32 s72, s72, s78
    s_add_u32 s56, s56, 128
    s_cmp_eq_u32 s56, 1280
    s_cselect_b32 s56, 0, s56
    s_lshl_b32 s73, s56, 5
    s_add_u32 s73, s73, s78
    s_add_u32 s56, s56, 128
    s_cmp_eq_u32 s56, 1280
    s_cselect_b32 s56, 0, s56
    s_lshl_b32 s74, s56, 5
    s_add_u32 s74, s74, s78
    s_add_u32 s56, s56, 128
    s_cmp_eq_u32 s56, 1280
    s_cselect_b32 s56, 0, s56
    s_lshl_b32 s75, s56, 5
    s_add_u32 s75, s75, s78
    s_add_u32 s56, s56, 128
    s_cmp_eq_u32 s56, 1280
    s_cselect_b32 s56, 0, s56
    s_lshl_b32 s82, s56, 5
    s_add_u32 s82, s82, s78
    s_add_u32 s56, s56, 128
    s_cmp_eq_u32 s56, 1280
    s_cselect_b32 s56, 0, s56
    s_lshl_b32 s84, s56, 5
    s_add_u32 s84, s84, s78
    s_add_u32 s56, s56, 128
    s_cmp_eq_u32 s56, 1280
    s_cselect_b32 s56, 0, s56
    s_lshl_b32 s85, s56, 5
    s_add_u32 s85, s85, s78
    s_add_u32 s56, s56, 128
    s_cmp_eq_u32 s56, 1280
    s_cselect_b32 s56, 0, s56
    s_lshl_b32 s90, s56, 5
    s_add_u32 s90, s90, s78
    s_add_u32 s56, s56, 128
    s_mov_b64 exec, 0
    s_cmp_eq_u32 s32, 0
    s_cbranch_scc1 L_gbody_h0
    s_cmp_eq_u32 s32, 1
    s_cbranch_scc1 L_gbody_h1
    s_cmp_eq_u32 s32, 2
    s_cbranch_scc1 L_gbody_h2
    s_branch L_gbody_h3
L_gbody_hr:
    s_mov_b64 exec, -1
    v_and_b32 v26, 15, v0
    s_lshl_b32 s56, s32, 5
    v_add_u32 v26, s56, v26
    v_cvt_f32_u32 v26, v26
    v_mul_f32 v27, 0.5, v26
    v_cos_f32 v27, v27
    v_mul_f32 v26, 0x3c000000, v26
    v_lshrrev_b32 v29, 4, v0
    v_lshlrev_b32 v29, 2, v29
    v_cvt_f32_u32 v29, v29
    v_cmp_gt_u32 s[30:31], 16, v0
    v_mul_f32 v28, v29, v26
    v_fmamk_f32 v69, v26, 0x3f800000, v28
    v_fmamk_f32 v70, v26, 0x40000000, v28
    v_fmamk_f32 v71, v26, 0x40400000, v28
    v_cos_f32 v64, v28
    v_sin_f32 v68, v28
    v_cos_f32 v65, v69
    v_sin_f32 v69, v69
    v_cos_f32 v66, v70
    v_sin_f32 v70, v70
    v_cos_f32 v67, v71
    v_sin_f32 v71, v71
    v_cndmask_b32 v68, v68, v27, s[30:31]
    v_cvt_pk_bf16_f32 v64, v64, v68
    v_cvt_pk_bf16_f32 v65, v65, v69
    v_cvt_pk_bf16_f32 v66, v66, v70
    v_cvt_pk_bf16_f32 v67, v67, v71
    v_accvgpr_write_b32 a160, v64
    v_accvgpr_write_b32 a161, v65
    v_accvgpr_write_b32 a162, v66
    v_accvgpr_write_b32 a163, v67
    v_fmamk_f32 v76, v26, 0x41800000, v28
    v_fmamk_f32 v77, v26, 0x41880000, v28
    v_fmamk_f32 v78, v26, 0x41900000, v28
    v_fmamk_f32 v79, v26, 0x41980000, v28
    v_cos_f32 v72, v76
    v_sin_f32 v76, v76
    v_cos_f32 v73, v77
    v_sin_f32 v77, v77
    v_cos_f32 v74, v78
    v_sin_f32 v78, v78
    v_cos_f32 v75, v79
    v_sin_f32 v79, v79
    v_cvt_pk_bf16_f32 v72, v72, v76
    v_cvt_pk_bf16_f32 v73, v73, v77
    v_cvt_pk_bf16_f32 v74, v74, v78
    v_cvt_pk_bf16_f32 v75, v75, v79
    v_accvgpr_write_b32 a168, v72
    v_accvgpr_write_b32 a169, v73
    v_accvgpr_write_b32 a170, v74
    v_accvgpr_write_b32 a171, v75
    v_fmamk_f32 v68, v26, 0x42000000, v28
    v_fmamk_f32 v69, v26, 0x42040000, v28
    v_fmamk_f32 v70, v26, 0x42080000, v28
    v_fmamk_f32 v71, v26, 0x420c0000, v28
    v_cos_f32 v64, v68
    v_sin_f32 v68, v68
    v_cos_f32 v65, v69
    v_sin_f32 v69, v69
    v_cos_f32 v66, v70
    v_sin_f32 v70, v70
    v_cos_f32 v67, v71
    v_sin_f32 v71, v71
    v_cvt_pk_bf16_f32 v64, v64, v68
    v_cvt_pk_bf16_f32 v65, v65, v69
    v_cvt_pk_bf16_f32 v66, v66, v70
    v_cvt_pk_bf16_f32 v67, v67, v71
    v_accvgpr_write_b32 a176, v64
    v_accvgpr_write_b32 a177, v65
    v_accvgpr_write_b32 a178, v66
    v_accvgpr_write_b32 a179, v67
    v_fmamk_f32 v76, v26, 0x42400000, v28
    v_fmamk_f32 v77, v26, 0x42440000, v28
    v_fmamk_f32 v78, v26, 0x42480000, v28
    v_fmamk_f32 v79, v26, 0x424c0000, v28
    v_cos_f32 v72, v76
    v_sin_f32 v76, v76
    v_cos_f32 v73, v77
    v_sin_f32 v77, v77
    v_cos_f32 v74, v78
    v_sin_f32 v78, v78
    v_cos_f32 v75, v79
    v_sin_f32 v79, v79
    v_cvt_pk_bf16_f32 v72, v72, v76
    v_cvt_pk_bf16_f32 v73, v73, v77
    v_cvt_pk_bf16_f32 v74, v74, v78
    v_cvt_pk_bf16_f32 v75, v75, v79
    v_accvgpr_write_b32 a184, v72
    v_accvgpr_write_b32 a185, v73
    v_accvgpr_write_b32 a186, v74
    v_accvgpr_write_b32 a187, v75
    v_add_f32 v26, 0x3e000000, v26
    v_mul_f32 v28, v29, v26
    v_fmamk_f32 v69, v26, 0x3f800000, v28
    v_fmamk_f32 v70, v26, 0x40000000, v28
    v_fmamk_f32 v71, v26, 0x40400000, v28
    v_cos_f32 v64, v28
    v_sin_f32 v68, v28
    v_cos_f32 v65, v69
    v_sin_f32 v69, v69
    v_cos_f32 v66, v70
    v_sin_f32 v70, v70
    v_cos_f32 v67, v71
    v_sin_f32 v71, v71
    v_cndmask_b32 v68, v68, v27, s[30:31]
    v_cvt_pk_bf16_f32 v64, v64, v68
    v_cvt_pk_bf16_f32 v65, v65, v69
    v_cvt_pk_bf16_f32 v66, v66, v70
    v_cvt_pk_bf16_f32 v67, v67, v71
    v_accvgpr_write_b32 a164, v64
    v_accvgpr_write_b32 a165, v65
    v_accvgpr_write_b32 a166, v66
    v_accvgpr_write_b32 a167, v67
    v_fmamk_f32 v76, v26, 0x41800000, v28
    v_fmamk_f32 v77, v26, 0x41880000, v28
    v_fmamk_f32 v78, v26, 0x41900000, v28
    v_fmamk_f32 v79, v26, 0x41980000, v28
    v_cos_f32 v72, v76
    v_sin_f32 v76, v76
    v_cos_f32 v73, v77
    v_sin_f32 v77, v77
    v_cos_f32 v74, v78
    v_sin_f32 v78, v78
    v_cos_f32 v75, v79
    v_sin_f32 v79, v79
    v_cvt_pk_bf16_f32 v72, v72, v76
    v_cvt_pk_bf16_f32 v73, v73, v77
    v_cvt_pk_bf16_f32 v74, v74, v78
    v_cvt_pk_bf16_f32 v75, v75, v79
    v_accvgpr_write_b32 a172, v72
    v_accvgpr_write_b32 a173, v73
    v_accvgpr_write_b32 a174, v74
    v_accvgpr_write_b32 a175, v75
    v_fmamk_f32 v68, v26, 0x42000000, v28
    v_fmamk_f32 v69, v26, 0x42040000, v28
    v_fmamk_f32 v70, v26, 0x42080000, v28
    v_fmamk_f32 v71, v26, 0x420c0000, v28
    v_cos_f32 v64, v68
    v_sin_f32 v68, v68
    v_cos_f32 v65, v69
    v_sin_f32 v69, v69
    v_cos_f32 v66, v70
    v_sin_f32 v70, v70
    v_cos_f32 v67, v71
    v_sin_f32 v71, v71
    v_cvt_pk_bf16_f32 v64, v64, v68
    v_cvt_pk_bf16_f32 v65, v65, v69
    v_cvt_pk_bf16_f32 v66, v66, v70
    v_cvt_pk_bf16_f32 v67, v67, v71
    v_accvgpr_write_b32 a180, v64
    v_accvgpr_write_b32 a181, v65
    v_accvgpr_write_b32 a182, v66
    v_accvgpr_write_b32 a183, v67
    v_fmamk_f32 v76, v26, 0x42400000, v28
    v_fmamk_f32 v77, v26, 0x42440000, v28
    v_fmamk_f32 v78, v26, 0x42480000, v28
    v_fmamk_f32 v79, v26, 0x424c0000, v28
    v_cos_f32 v72, v76
    v_sin_f32 v76, v76
    v_cos_f32 v73, v77
    v_sin_f32 v77, v77
    v_cos_f32 v74, v78
    v_sin_f32 v78, v78
    v_cos_f32 v75, v79
    v_sin_f32 v79, v79
    v_cvt_pk_bf16_f32 v72, v72, v76
    v_cvt_pk_bf16_f32 v73, v73, v77
    v_cvt_pk_bf16_f32 v74, v74, v78
    v_cvt_pk_bf16_f32 v75, v75, v79
    v_accvgpr_write_b32 a188, v72
    v_accvgpr_write_b32 a189, v73
    v_accvgpr_write_b32 a190, v74
    v_accvgpr_write_b32 a191, v75
    s_waitcnt lgkmcnt(0)
    s_add_u32 s86, s86, 0x9e3779b9
    s_add_u32 s87, s87, 0x7f4a7c15
    s_branch L_gbody
.p2align 12
L_gbody:
L_gbody_h0:
    s_cbranch_execz L_gbody_h4
    s_mul_i32 s59, s62, 1536
    s_add_u32 m0, s83, 131072
    s_nop 0
    buffer_load_dwordx4 v2, s[12:15], s59 offen lds
    s_add_u32 m0, s83, 132096
    s_nop 0
    buffer_load_dwordx4 v2, s[16:19], s59 offen lds
    s_add_u32 m0, s83, 133120
    s_nop 0
    buffer_load_dwordx4 v3, s[12:15], s59 offen lds
    s_add_u32 m0, s83, 134144
    s_nop 0
    buffer_load_dwordx4 v3, s[16:19], s59 offen lds
    s_waitcnt vmcnt(10)
    s_barrier
    s_add_u32 m0, s78, 12288
    ds_read_b64_tr_b16 v[160:161], v5 offset:0
    ds_read_b64_tr_b16 v[162:163], v5 offset:512
    buffer_load_dwordx4 v1, s[4:7], s62 offen offset:0 lds
    ds_read_b64_tr_b16 v[164:165], v5 offset:1024
    ds_read_b64_tr_b16 v[166:167], v5 offset:1536
    s_add_u32 m0, s78, 51968
    ds_read_b128 v[96:99], v8 offset:4096
    ds_read_b128 a[0:3], v8 offset:45056
    buffer_load_dwordx4 v1, s[4:7], s62 offen offset:1280 lds
    ds_read_b128 v[100:103], v8 offset:6144
    ds_read_b128 a[4:7], v8 offset:47104
    s_mul_i32 s58, s63, 1536
    s_add_u32 m0, s83, 147456
    ds_read_b64_tr_b16 v[168:169], v5 offset:8192
    ds_read_b64_tr_b16 v[170:171], v5 offset:8704
    buffer_load_dwordx4 v2, s[12:15], s58 offen lds
    ds_read_b64_tr_b16 v[172:173], v5 offset:9216
    ds_read_b64_tr_b16 v[174:175], v5 offset:9728
    s_add_u32 m0, s83, 148480
    ds_read_b128 v[104:107], v9 offset:4096
    ds_read_b128 a[8:11], v9 offset:45056
    buffer_load_dwordx4 v2, s[16:19], s58 offen lds
    ds_read_b128 v[108:111], v9 offset:6144
    ds_read_b128 a[12:15], v9 offset:47104
    s_add_u32 m0, s83, 149504
    s_nop 0
    buffer_load_dwordx4 v3, s[12:15], s58 offen lds
    s_add_u32 m0, s83, 150528
    s_nop 0
    buffer_load_dwordx4 v3, s[16:19], s58 offen lds
    s_waitcnt vmcnt(10) lgkmcnt(0)
    s_barrier
    v_mfma_f32_16x16x32_bf16 v[32:35], v[160:163], v[96:99], 0
    s_add_u32 m0, s78, 16384
    ds_read_b64_tr_b16 v[176:177], v5 offset:16384
    ds_read_b64_tr_b16 v[178:179], v5 offset:16896
    v_mfma_f32_16x16x32_bf16 v[40:43], v[164:167], v[96:99], 0
    buffer_load_dwordx4 v1, s[4:7], s63 offen offset:0 lds
    v_mfma_f32_16x16x32_bf16 v[48:51], v[160:163], a[0:3], 0
    s_add_u32 m0, s78, 56064
    ds_read_b64_tr_b16 v[180:181], v5 offset:17408
    ds_read_b64_tr_b16 v[182:183], v5 offset:17920
    v_mfma_f32_16x16x32_bf16 v[56:59], v[164:167], a[0:3], 0
    buffer_load_dwordx4 v1, s[4:7], s63 offen offset:1280 lds
    v_mfma_f32_16x16x32_bf16 v[80:83], v[156:159], v[160:163], 0
    ds_read_b128 v[112:115], v8 offset:8192
    ds_read_b128 a[16:19], v8 offset:49152
    v_mfma_f32_16x16x32_bf16 v[44:47], v[164:167], v[100:103], 0
    s_mul_i32 s59, s64, 1536
    s_add_u32 m0, s83, 98304
    ds_read_b128 v[116:119], v8 offset:10240
    ds_read_b128 a[20:23], v8 offset:51200
    v_mfma_f32_16x16x32_bf16 v[36:39], v[160:163], v[100:103], 0
    buffer_load_dwordx4 v2, s[12:15], s59 offen lds
    v_mfma_f32_16x16x32_bf16 v[60:63], v[164:167], a[4:7], 0
    ds_read_b64_tr_b16 v[184:185], v5 offset:24576
    ds_read_b64_tr_b16 v[186:187], v5 offset:25088
    v_mfma_f32_16x16x32_bf16 v[52:55], v[160:163], a[4:7], 0
    s_add_u32 m0, s83, 99328
    ds_read_b64_tr_b16 v[188:189], v5 offset:25600
    ds_read_b64_tr_b16 v[190:191], v5 offset:26112
    v_mfma_f32_16x16x32_bf16 v[84:87], v[156:159], v[164:167], 0
    buffer_load_dwordx4 v2, s[16:19], s59 offen lds
    v_mfma_f32_16x16x32_bf16 v[32:35], v[168:171], v[104:107], v[32:35]
    s_add_u32 m0, s83, 100352
    ds_read_b128 v[120:123], v9 offset:8192
    ds_read_b128 a[24:27], v9 offset:49152
    v_mfma_f32_16x16x32_bf16 v[40:43], v[172:175], v[104:107], v[40:43]
    buffer_load_dwordx4 v3, s[12:15], s59 offen lds
    v_mfma_f32_16x16x32_bf16 v[48:51], v[168:171], a[8:11], v[48:51]
    ds_read_b128 v[124:127], v9 offset:10240
    ds_read_b128 a[28:31], v9 offset:51200
    v_mfma_f32_16x16x32_bf16 v[56:59], v[172:175], a[8:11], v[56:59]
    s_add_u32 m0, s83, 101376
    v_mfma_f32_16x16x32_bf16 v[80:83], v[156:159], v[168:171], v[80:83]
    buffer_load_dwordx4 v3, s[16:19], s59 offen lds
    v_mfma_f32_16x16x32_bf16 v[44:47], v[172:175], v[108:111], v[44:47]
    v_mfma_f32_16x16x32_bf16 v[36:39], v[168:171], v[108:111], v[36:39]
    s_add_u32 m0, s78, 20480
    v_mfma_f32_16x16x32_bf16 v[60:63], v[172:175], a[12:15], v[60:63]
    buffer_load_dwordx4 v1, s[4:7], s64 offen offset:0 lds
    v_mfma_f32_16x16x32_bf16 v[52:55], v[168:171], a[12:15], v[52:55]
    v_mfma_f32_16x16x32_bf16 v[84:87], v[156:159], v[172:175], v[84:87]
    s_waitcnt vmcnt(11) lgkmcnt(0)
    s_barrier
    v_mfma_f32_16x16x32_bf16 v[32:35], v[176:179], v[112:115], v[32:35]
    s_add_u32 m0, s78, 60160
    ds_read_b64_tr_b16 v[192:193], v5 offset:32768
    ds_read_b64_tr_b16 v[194:195], v5 offset:33280
    v_mfma_f32_16x16x32_bf16 v[40:43], v[180:183], v[112:115], v[40:43]
    buffer_load_dwordx4 v1, s[4:7], s64 offen offset:1280 lds
    v_mfma_f32_16x16x32_bf16 v[48:51], v[176:179], a[16:19], v[48:51]
    s_mul_i32 s58, s65, 1536
    s_add_u32 m0, s83, 114688
    ds_read_b64_tr_b16 v[196:197], v5 offset:33792
    ds_read_b64_tr_b16 v[198:199], v5 offset:34304
    v_mfma_f32_16x16x32_bf16 v[56:59], v[180:183], a[16:19], v[56:59]
    buffer_load_dwordx4 v2, s[12:15], s58 offen lds
    v_mfma_f32_16x16x32_bf16 v[80:83], v[156:159], v[176:179], v[80:83]
    ds_read_b128 v[96:99], v8 offset:12288
    ds_read_b128 a[0:3], v8 offset:53248
    v_mfma_f32_16x16x32_bf16 v[44:47], v[180:183], v[116:119], v[44:47]
    s_add_u32 m0, s83, 115712
    ds_read_b128 v[100:103], v8 offset:14336
    ds_read_b128 a[4:7], v8 offset:55296
    v_mfma_f32_16x16x32_bf16 v[36:39], v[176:179], v[116:119], v[36:39]
    buffer_load_dwordx4 v2, s[16:19], s58 offen lds
    v_mfma_f32_16x16x32_bf16 v[60:63], v[180:183], a[20:23], v[60:63]
    ds_read_b64_tr_b16 v[200:201], v5 offset:40960
    ds_read_b64_tr_b16 v[202:203], v5 offset:41472
    v_mfma_f32_16x16x32_bf16 v[52:55], v[176:179], a[20:23], v[52:55]
    s_add_u32 m0, s83, 116736
    ds_read_b64_tr_b16 v[204:205], v5 offset:41984
    ds_read_b64_tr_b16 v[206:207], v5 offset:42496
    v_mfma_f32_16x16x32_bf16 v[84:87], v[156:159], v[180:183], v[84:87]
    buffer_load_dwordx4 v3, s[12:15], s58 offen lds
    v_mfma_f32_16x16x32_bf16 v[32:35], v[184:187], v[120:123], v[32:35]
    s_add_u32 m0, s83, 117760
    ds_read_b128 v[104:107], v9 offset:12288
    ds_read_b128 a[8:11], v9 offset:53248
    v_mfma_f32_16x16x32_bf16 v[40:43], v[188:191], v[120:123], v[40:43]
    buffer_load_dwordx4 v3, s[16:19], s58 offen lds
    v_mfma_f32_16x16x32_bf16 v[48:51], v[184:187], a[24:27], v[48:51]
    ds_read_b128 v[108:111], v9 offset:14336
    ds_read_b128 a[12:15], v9 offset:55296
    v_mfma_f32_16x16x32_bf16 v[56:59], v[188:191], a[24:27], v[56:59]
    s_add_u32 m0, s78, 24576
    v_mfma_f32_16x16x32_bf16 v[80:83], v[156:159], v[184:187], v[80:83]
    buffer_load_dwordx4 v1, s[4:7], s65 offen offset:0 lds
    v_mfma_f32_16x16x32_bf16 v[44:47], v[188:191], v[124:127], v[44:47]
    v_mfma_f32_16x16x32_bf16 v[36:39], v[184:187], v[124:127], v[36:39]
    s_add_u32 m0, s78, 64256
    v_mfma_f32_16x16x32_bf16 v[60:63], v[188:191], a[28:31], v[60:63]
    buffer_load_dwordx4 v1, s[4:7], s65 offen offset:1280 lds
    v_mfma_f32_16x16x32_bf16 v[52:55], v[184:187], a[28:31], v[52:55]
    v_mfma_f32_16x16x32_bf16 v[84:87], v[156:159], v[188:191], v[84:87]
    s_waitcnt vmcnt(12) lgkmcnt(0)
    s_barrier
    v_mfma_f32_16x16x32_bf16 v[32:35], v[192:195], v[96:99], v[32:35]
    s_mul_i32 s59, s66, 1536
    s_add_u32 m0, s83, 131072
    ds_read_b64_tr_b16 v[208:209], v5 offset:49152
    ds_read_b64_tr_b16 v[210:211], v5 offset:49664
    v_mfma_f32_16x16x32_bf16 v[40:43], v[196:199], v[96:99], v[40:43]
    buffer_load_dwordx4 v2, s[12:15], s59 offen lds
    v_mfma_f32_16x16x32_bf16 v[48:51], v[192:195], a[0:3], v[48:51]
    ds_read_b64_tr_b16 v[212:213], v5 offset:50176
    ds_read_b64_tr_b16 v[214:215], v5 offset:50688
    v_mfma_f32_16x16x32_bf16 v[56:59], v[196:199], a[0:3], v[56:59]
    s_add_u32 m0, s83, 132096
    ds_read_b128 v[112:115], v8 offset:16384
    ds_read_b128 a[16:19], v8 offset:57344
    v_mfma_f32_16x16x32_bf16 v[80:83], v[156:159], v[192:195], v[80:83]
    buffer_load_dwordx4 v2, s[16:19], s59 offen lds
    v_mfma_f32_16x16x32_bf16 v[44:47], v[196:199], v[100:103], v[44:47]
    ds_read_b128 v[116:119], v8 offset:18432
    ds_read_b128 a[20:23], v8 offset:59392
    v_mfma_f32_16x16x32_bf16 v[36:39], v[192:195], v[100:103], v[36:39]
    s_add_u32 m0, s83, 133120
    ds_read_b64_tr_b16 v[216:217], v5 offset:57344
    ds_read_b64_tr_b16 v[218:219], v5 offset:57856
    v_mfma_f32_16x16x32_bf16 v[60:63], v[196:199], a[4:7], v[60:63]
    buffer_load_dwordx4 v3, s[12:15], s59 offen lds
    v_mfma_f32_16x16x32_bf16 v[52:55], v[192:195], a[4:7], v[52:55]
    ds_read_b64_tr_b16 v[220:221], v5 offset:58368
    ds_read_b64_tr_b16 v[222:223], v5 offset:58880
    v_mfma_f32_16x16x32_bf16 v[84:87], v[156:159], v[196:199], v[84:87]
    s_add_u32 m0, s83, 134144
    ds_read_b128 v[120:123], v9 offset:16384
    ds_read_b128 a[24:27], v9 offset:57344
    v_mfma_f32_16x16x32_bf16 v[32:35], v[200:203], v[104:107], v[32:35]
    buffer_load_dwordx4 v3, s[16:19], s59 offen lds
    v_mfma_f32_16x16x32_bf16 v[40:43], v[204:207], v[104:107], v[40:43]
    ds_read_b128 v[124:127], v9 offset:18432
    ds_read_b128 a[28:31], v9 offset:59392
    v_mfma_f32_16x16x32_bf16 v[48:51], v[200:203], a[8:11], v[48:51]
    s_add_u32 m0, s78, 28672
    v_mfma_f32_16x16x32_bf16 v[56:59], v[204:207], a[8:11], v[56:59]
    buffer_load_dwordx4 v1, s[4:7], s66 offen offset:0 lds
    v_mfma_f32_16x16x32_bf16 v[80:83], v[156:159], v[200:203], v[80:83]
    v_mfma_f32_16x16x32_bf16 v[44:47], v[204:207], v[108:111], v[44:47]
    s_add_u32 m0, s78, 68352
    v_mfma_f32_16x16x32_bf16 v[36:39], v[200:203], v[108:111], v[36:39]
    buffer_load_dwordx4 v1, s[4:7], s66 offen offset:1280 lds
    v_mfma_f32_16x16x32_bf16 v[60:63], v[204:207], a[12:15], v[60:63]
    v_mfma_f32_16x16x32_bf16 v[52:55], v[200:203], a[12:15], v[52:55]
    v_mfma_f32_16x16x32_bf16 v[84:87], v[156:159], v[204:207], v[84:87]
    s_waitcnt vmcnt(12) lgkmcnt(0)
    s_barrier
    v_mfma_f32_16x16x32_bf16 v[32:35], v[208:211], v[112:115], v[32:35]
    s_mul_i32 s58, s67, 1536
    s_add_u32 m0, s83, 147456
    ds_read_b64_tr_b16 v[224:225], v5 offset:0
    ds_read_b64_tr_b16 v[226:227], v5 offset:512
    v_mfma_f32_16x16x32_bf16 v[40:43], v[212:215], v[112:115], v[40:43]
    buffer_load_dwordx4 v2, s[12:15], s58 offen lds
    v_mfma_f32_16x16x32_bf16 v[48:51], v[208:211], a[16:19], v[48:51]
    ds_read_b64_tr_b16 v[228:229], v5 offset:1024
    ds_read_b64_tr_b16 v[230:231], v5 offset:1536
    v_mfma_f32_16x16x32_bf16 v[56:59], v[212:215], a[16:19], v[56:59]
    s_add_u32 m0, s83, 148480
    ds_read_b128 v[96:99], v8 offset:20480
    ds_read_b128 a[0:3], v8 offset:61440
    v_mfma_f32_16x16x32_bf16 v[80:83], v[156:159], v[208:211], v[80:83]
    buffer_load_dwordx4 v2, s[16:19], s58 offen lds
    v_mfma_f32_16x16x32_bf16 v[44:47], v[212:215], v[116:119], v[44:47]
    ds_read_b128 v[100:103], v8 offset:22528
    ds_read_b128 a[4:7], v8 offset:63488
    v_mfma_f32_16x16x32_bf16 v[36:39], v[208:211], v[116:119], v[36:39]
    s_add_u32 m0, s83, 149504
    ds_read_b64_tr_b16 v[232:233], v5 offset:8192
    ds_read_b64_tr_b16 v[234:235], v5 offset:8704
    v_mfma_f32_16x16x32_bf16 v[60:63], v[212:215], a[20:23], v[60:63]
    buffer_load_dwordx4 v3, s[12:15], s58 offen lds
    v_mfma_f32_16x16x32_bf16 v[52:55], v[208:211], a[20:23], v[52:55]
    ds_read_b64_tr_b16 v[236:237], v5 offset:9216
    ds_read_b64_tr_b16 v[238:239], v5 offset:9728
    v_mfma_f32_16x16x32_bf16 v[84:87], v[156:159], v[212:215], v[84:87]
    s_add_u32 m0, s83, 150528
    ds_read_b128 v[104:107], v9 offset:20480
    ds_read_b128 a[8:11], v9 offset:61440
    v_mfma_f32_16x16x32_bf16 v[32:35], v[216:219], v[120:123], v[32:35]
    buffer_load_dwordx4 v3, s[16:19], s58 offen lds
    v_mfma_f32_16x16x32_bf16 v[40:43], v[220:223], v[120:123], v[40:43]
    ds_read_b128 v[108:111], v9 offset:22528
    ds_read_b128 a[12:15], v9 offset:63488
    v_mfma_f32_16x16x32_bf16 v[48:51], v[216:219], a[24:27], v[48:51]
    s_add_u32 m0, s78, 86016
    v_mfma_f32_16x16x32_bf16 v[56:59], v[220:223], a[24:27], v[56:59]
    buffer_load_dwordx4 v1, s[4:7], s67 offen offset:0 lds
    v_mfma_f32_16x16x32_bf16 v[80:83], v[156:159], v[216:219], v[80:83]
    v_mfma_f32_16x16x32_bf16 v[44:47], v[220:223], v[124:127], v[44:47]
    s_add_u32 m0, s78, 72448
    v_mfma_f32_16x16x32_bf16 v[36:39], v[216:219], v[124:127], v[36:39]
    buffer_load_dwordx4 v1, s[4:7], s67 offen offset:1280 lds
    v_mfma_f32_16x16x32_bf16 v[60:63], v[220:223], a[28:31], v[60:63]
    v_mfma_f32_16x16x32_bf16 v[52:55], v[216:219], a[28:31], v[52:55]
    v_mfma_f32_16x16x32_bf16 v[84:87], v[156:159], v[220:223], v[84:87]
    s_waitcnt vmcnt(12) lgkmcnt(0)
    s_barrier
    v_mfma_f32_16x16x32_bf16 v[32:35], v[224:227], v[96:99], v[32:35]
    s_mul_i32 s59, s68, 1536
    s_add_u32 m0, s83, 98304
    ds_read_b64_tr_b16 v[240:241], v5 offset:16384
    ds_read_b64_tr_b16 v[242:243], v5 offset:16896
    v_mfma_f32_16x16x32_bf16 v[40:43], v[228:231], v[96:99], v[40:43]
    buffer_load_dwordx4 v2, s[12:15], s59 offen lds
    v_mfma_f32_16x16x32_bf16 v[48:51], v[224:227], a[0:3], v[48:51]
    ds_read_b64_tr_b16 v[244:245], v5 offset:17408
    ds_read_b64_tr_b16 v[246:247], v5 offset:17920
    v_mfma_f32_16x16x32_bf16 v[56:59], v[228:231], a[0:3], v[56:59]
    s_add_u32 m0, s83, 99328
    ds_read_b128 v[112:115], v8 offset:24576
    ds_read_b128 a[16:19], v10 offset:0
    v_mfma_f32_16x16x32_bf16 v[80:83], v[156:159], v[224:227], v[80:83]
    buffer_load_dwordx4 v2, s[16:19], s59 offen lds
    v_mfma_f32_16x16x32_bf16 v[44:47], v[228:231], v[100:103], v[44:47]
    ds_read_b128 v[116:119], v8 offset:26624
    ds_read_b128 a[20:23], v10 offset:2048
    v_mfma_f32_16x16x32_bf16 v[36:39], v[224:227], v[100:103], v[36:39]
    s_add_u32 m0, s83, 100352
    ds_read_b64_tr_b16 v[248:249], v5 offset:24576
    ds_read_b64_tr_b16 v[250:251], v5 offset:25088
    v_mfma_f32_16x16x32_bf16 v[60:63], v[228:231], a[4:7], v[60:63]
    buffer_load_dwordx4 v3, s[12:15], s59 offen lds
    v_mfma_f32_16x16x32_bf16 v[52:55], v[224:227], a[4:7], v[52:55]
    ds_read_b64_tr_b16 v[252:253], v5 offset:25600
    ds_read_b64_tr_b16 v[254:255], v5 offset:26112
    v_mfma_f32_16x16x32_bf16 v[84:87], v[156:159], v[228:231], v[84:87]
    s_add_u32 m0, s83, 101376
    ds_read_b128 v[120:123], v9 offset:24576
    ds_read_b128 a[24:27], v11 offset:0
    v_mfma_f32_16x16x32_bf16 v[32:35], v[232:235], v[104:107], v[32:35]
    buffer_load_dwordx4 v3, s[16:19], s59 offen lds
    v_mfma_f32_16x16x32_bf16 v[40:43], v[236:239], v[104:107], v[40:43]
    ds_read_b128 v[124:127], v9 offset:26624
    ds_read_b128 a[28:31], v11 offset:2048
    v_mfma_f32_16x16x32_bf16 v[48:51], v[232:235], a[8:11], v[48:51]
    s_add_u32 m0, s78, 90112
    v_mfma_f32_16x16x32_bf16 v[56:59], v[236:239], a[8:11], v[56:59]
    buffer_load_dwordx4 v1, s[4:7], s68 offen offset:0 lds
    v_mfma_f32_16x16x32_bf16 v[80:83], v[156:159], v[232:235], v[80:83]
    v_mfma_f32_16x16x32_bf16 v[44:47], v[236:239], v[108:111], v[44:47]
    s_add_u32 m0, s78, 76544
    v_mfma_f32_16x16x32_bf16 v[36:39], v[232:235], v[108:111], v[36:39]
    buffer_load_dwordx4 v1, s[4:7], s68 offen offset:1280 lds
    v_mfma_f32_16x16x32_bf16 v[60:63], v[236:239], a[12:15], v[60:63]
    v_mfma_f32_16x16x32_bf16 v[52:55], v[232:235], a[12:15], v[52:55]
    v_mfma_f32_16x16x32_bf16 v[84:87], v[156:159], v[236:239], v[84:87]
    s_waitcnt vmcnt(12) lgkmcnt(0)
    s_barrier
    v_mfma_f32_16x16x32_bf16 v[32:35], v[240:243], v[112:115], v[32:35]
    ds_read_b64_tr_b16 a[192:193], v5 offset:32768
    ds_read_b64_tr_b16 a[194:195], v5 offset:33280
    v_mfma_f32_16x16x32_bf16 v[40:43], v[244:247], v[112:115], v[40:43]
    buffer_load_dwordx4 v[144:147], v22, s[8:11], s76 offen sc1
    v_mfma_f32_16x16x32_bf16 v[48:51], v[240:243], a[16:19], v[48:51]
    ds_read_b64_tr_b16 a[196:197], v5 offset:33792
    ds_read_b64_tr_b16 a[198:199], v5 offset:34304
    v_mfma_f32_16x16x32_bf16 v[56:59], v[244:247], a[16:19], v[56:59]
    s_mul_i32 s58, s69, 1536
    s_add_u32 m0, s83, 114688
    ds_read_b128 v[96:99], v8 offset:28672
    ds_read_b128 a[0:3], v10 offset:4096
    v_mfma_f32_16x16x32_bf16 v[80:83], v[156:159], v[240:243], v[80:83]
    buffer_load_dwordx4 v2, s[12:15], s58 offen lds
    v_mfma_f32_16x16x32_bf16 v[44:47], v[244:247], v[116:119], v[44:47]
    ds_read_b128 v[100:103], v8 offset:30720
    ds_read_b128 a[4:7], v10 offset:6144
    v_mfma_f32_16x16x32_bf16 v[36:39], v[240:243], v[116:119], v[36:39]
    s_add_u32 m0, s83, 115712
    ds_read_b64_tr_b16 a[200:201], v5 offset:40960
    ds_read_b64_tr_b16 a[202:203], v5 offset:41472
    v_mfma_f32_16x16x32_bf16 v[60:63], v[244:247], a[20:23], v[60:63]
    buffer_load_dwordx4 v2, s[16:19], s58 offen lds
    v_mfma_f32_16x16x32_bf16 v[52:55], v[240:243], a[20:23], v[52:55]
    ds_read_b64_tr_b16 a[204:205], v5 offset:41984
    ds_read_b64_tr_b16 a[206:207], v5 offset:42496
    v_mfma_f32_16x16x32_bf16 v[84:87], v[156:159], v[244:247], v[84:87]
    s_add_u32 m0, s83, 116736
    ds_read_b128 v[104:107], v9 offset:28672
    ds_read_b128 a[8:11], v11 offset:4096
    v_mfma_f32_16x16x32_bf16 v[32:35], v[248:251], v[120:123], v[32:35]
    buffer_load_dwordx4 v3, s[12:15], s58 offen lds
    v_mfma_f32_16x16x32_bf16 v[40:43], v[252:255], v[120:123], v[40:43]
    ds_read_b128 v[108:111], v9 offset:30720
    ds_read_b128 a[12:15], v11 offset:6144
    v_mfma_f32_16x16x32_bf16 v[48:51], v[248:251], a[24:27], v[48:51]
    s_add_u32 m0, s83, 117760
    v_mfma_f32_16x16x32_bf16 v[56:59], v[252:255], a[24:27], v[56:59]
    buffer_load_dwordx4 v3, s[16:19], s58 offen lds
    v_mfma_f32_16x16x32_bf16 v[80:83], v[156:159], v[248:251], v[80:83]
    v_mfma_f32_16x16x32_bf16 v[44:47], v[252:255], v[124:127], v[44:47]
    s_add_u32 m0, s78, 94208
    v_mfma_f32_16x16x32_bf16 v[36:39], v[248:251], v[124:127], v[36:39]
    buffer_load_dwordx4 v1, s[4:7], s69 offen offset:0 lds
    v_mfma_f32_16x16x32_bf16 v[60:63], v[252:255], a[28:31], v[60:63]
    v_mfma_f32_16x16x32_bf16 v[52:55], v[248:251], a[28:31], v[52:55]
    v_mfma_f32_16x16x32_bf16 v[84:87], v[156:159], v[252:255], v[84:87]
    s_waitcnt vmcnt(12) lgkmcnt(0)
    s_barrier
    v_mfma_f32_16x16x32_bf16 v[32:35], a[192:195], v[96:99], v[32:35]
    s_add_u32 m0, s78, 80640
    ds_read_b64_tr_b16 a[208:209], v5 offset:49152
    ds_read_b64_tr_b16 a[210:211], v5 offset:49664
    v_mfma_f32_16x16x32_bf16 v[40:43], a[196:199], v[96:99], v[40:43]
    buffer_load_dwordx4 v1, s[4:7], s69 offen offset:1280 lds
    v_mfma_f32_16x16x32_bf16 v[48:51], a[192:195], a[0:3], v[48:51]
    ds_read_b64_tr_b16 a[212:213], v5 offset:50176
    ds_read_b64_tr_b16 a[214:215], v5 offset:50688
    v_mfma_f32_16x16x32_bf16 v[56:59], a[196:199], a[0:3], v[56:59]
    v_add_u32 v1, 655360, v1
    s_add_u32 m0, s78, 4096
    ds_read_b128 v[112:115], v10 offset:20480
    ds_read_b128 a[16:19], v10 offset:8192
    v_mfma_f32_16x16x32_bf16 v[80:83], v[156:159], a[192:195], v[80:83]
    buffer_load_dwordx4 v1, s[4:7], s60 offen offset:0 lds
    v_mfma_f32_16x16x32_bf16 v[44:47], a[196:199], v[100:103], v[44:47]
    ds_read_b128 v[116:119], v10 offset:22528
    ds_read_b128 a[20:23], v10 offset:10240
    v_mfma_f32_16x16x32_bf16 v[36:39], a[192:195], v[100:103], v[36:39]
    s_add_u32 m0, s78, 8192
    ds_read_b64_tr_b16 a[216:217], v5 offset:57344
    ds_read_b64_tr_b16 a[218:219], v5 offset:57856
    v_mfma_f32_16x16x32_bf16 v[60:63], a[196:199], a[4:7], v[60:63]
    buffer_load_dwordx4 v1, s[4:7], s61 offen offset:0 lds
    v_mfma_f32_16x16x32_bf16 v[52:55], a[192:195], a[4:7], v[52:55]
    ds_read_b64_tr_b16 a[220:221], v5 offset:58368
    ds_read_b64_tr_b16 a[222:223], v5 offset:58880
    v_mfma_f32_16x16x32_bf16 v[84:87], v[156:159], a[196:199], v[84:87]
    s_add_u32 m0, s78, 12288
    ds_read_b128 v[120:123], v11 offset:20480
    ds_read_b128 a[24:27], v11 offset:8192
    v_mfma_f32_16x16x32_bf16 v[32:35], a[200:203], v[104:107], v[32:35]
    buffer_load_dwordx4 v1, s[4:7], s62 offen offset:0 lds
    v_mfma_f32_16x16x32_bf16 v[40:43], a[204:207], v[104:107], v[40:43]
    ds_read_b128 v[124:127], v11 offset:22528
    ds_read_b128 a[28:31], v11 offset:10240
    v_mfma_f32_16x16x32_bf16 v[48:51], a[200:203], a[8:11], v[48:51]
    s_add_u32 m0, s78, 16384
    v_mfma_f32_16x16x32_bf16 v[56:59], a[204:207], a[8:11], v[56:59]
    buffer_load_dwordx4 v1, s[4:7], s63 offen offset:0 lds
    v_mfma_f32_16x16x32_bf16 v[80:83], v[156:159], a[200:203], v[80:83]
    v_mfma_f32_16x16x32_bf16 v[44:47], a[204:207], v[108:111], v[44:47]
    s_add_u32 m0, s78, 20480
    v_mfma_f32_16x16x32_bf16 v[36:39], a[200:203], v[108:111], v[36:39]
    buffer_load_dwordx4 v1, s[4:7], s64 offen offset:0 lds
    v_mfma_f32_16x16x32_bf16 v[60:63], a[204:207], a[12:15], v[60:63]
    v_mfma_f32_16x16x32_bf16 v[52:55], a[200:203], a[12:15], v[52:55]
    v_mfma_f32_16x16x32_bf16 v[84:87], v[156:159], a[204:207], v[84:87]
    s_waitcnt vmcnt(12) lgkmcnt(0)
    s_barrier
    v_mfma_f32_16x16x32_bf16 v[32:35], a[208:211], v[112:115], v[32:35]
    s_add_u32 m0, s78, 24576
    ds_read_b64_tr_b16 a[224:225], v5 offset:0
    ds_read_b64_tr_b16 a[226:227], v5 offset:512
    v_mfma_f32_16x16x32_bf16 v[40:43], a[212:215], v[112:115], v[40:43]
    buffer_load_dwordx4 v1, s[4:7], s65 offen offset:0 lds
    v_mfma_f32_16x16x32_bf16 v[48:51], a[208:211], a[16:19], v[48:51]
    ds_read_b64_tr_b16 a[228:229], v5 offset:1024
    ds_read_b64_tr_b16 a[230:231], v5 offset:1536
    v_mfma_f32_16x16x32_bf16 v[56:59], a[212:215], a[16:19], v[56:59]
    s_add_u32 m0, s78, 28672
    ds_read_b128 v[96:99], v10 offset:24576
    ds_read_b128 a[0:3], v10 offset:12288
    v_mfma_f32_16x16x32_bf16 v[80:83], v[156:159], a[208:211], v[80:83]
    buffer_load_dwordx4 v1, s[4:7], s66 offen offset:0 lds
    v_mfma_f32_16x16x32_bf16 v[44:47], a[212:215], v[116:119], v[44:47]
    ds_read_b128 v[100:103], v10 offset:26624
    ds_read_b128 a[4:7], v10 offset:14336
    v_mfma_f32_16x16x32_bf16 v[36:39], a[208:211], v[116:119], v[36:39]
    s_add_u32 m0, s78, 32768
    ds_read_b64_tr_b16 a[232:233], v5 offset:8192
    ds_read_b64_tr_b16 a[234:235], v5 offset:8704
    v_mfma_f32_16x16x32_bf16 v[60:63], a[212:215], a[20:23], v[60:63]
    buffer_load_dwordx4 v1, s[4:7], s67 offen offset:0 lds
    v_mfma_f32_16x16x32_bf16 v[52:55], a[208:211], a[20:23], v[52:55]
    ds_read_b64_tr_b16 a[236:237], v5 offset:9216
    ds_read_b64_tr_b16 a[238:239], v5 offset:9728
    v_mfma_f32_16x16x32_bf16 v[84:87], v[156:159], a[212:215], v[84:87]
    s_add_u32 m0, s78, 36864
    ds_read_b128 v[104:107], v11 offset:24576
    ds_read_b128 a[8:11], v11 offset:12288
    v_mfma_f32_16x16x32_bf16 v[32:35], a[216:219], v[120:123], v[32:35]
    buffer_load_dwordx4 v1, s[4:7], s68 offen offset:0 lds
    v_mfma_f32_16x16x32_bf16 v[40:43], a[220:223], v[120:123], v[40:43]
    ds_read_b128 v[108:111], v11 offset:26624
    ds_read_b128 a[12:15], v11 offset:14336
    v_mfma_f32_16x16x32_bf16 v[48:51], a[216:219], a[24:27], v[48:51]
    s_add_u32 m0, s78, 40960
    v_mfma_f32_16x16x32_bf16 v[56:59], a[220:223], a[24:27], v[56:59]
    buffer_load_dwordx4 v1, s[4:7], s69 offen offset:0 lds
    v_mfma_f32_16x16x32_bf16 v[80:83], v[156:159], a[216:219], v[80:83]
    v_mfma_f32_16x16x32_bf16 v[44:47], a[220:223], v[124:127], v[44:47]
    v_mfma_f32_16x16x32_bf16 v[36:39], a[216:219], v[124:127], v[36:39]
    v_mfma_f32_16x16x32_bf16 v[60:63], a[220:223], a[28:31], v[60:63]
    v_mfma_f32_16x16x32_bf16 v[52:55], a[216:219], a[28:31], v[52:55]
    v_mfma_f32_16x16x32_bf16 v[84:87], v[156:159], a[220:223], v[84:87]
    s_waitcnt vmcnt(10) lgkmcnt(0)
    s_barrier
    v_mfma_f32_16x16x32_bf16 v[32:35], a[224:227], v[96:99], v[32:35]
    s_add_u32 m0, s78, 43776
    ds_read_b64_tr_b16 a[240:241], v5 offset:16384
    ds_read_b64_tr_b16 a[242:243], v5 offset:16896
    v_mfma_f32_16x16x32_bf16 v[40:43], a[228:231], v[96:99], v[40:43]
    buffer_load_dwordx4 v1, s[4:7], s60 offen offset:1280 lds
    v_mfma_f32_16x16x32_bf16 v[48:51], a[224:227], a[0:3], v[48:51]
    ds_read_b64_tr_b16 a[244:245], v5 offset:17408
    ds_read_b64_tr_b16 a[246:247], v5 offset:17920
    v_mfma_f32_16x16x32_bf16 v[56:59], a[228:231], a[0:3], v[56:59]
    s_add_u32 m0, s78, 47872
    ds_read_b128 v[112:115], v10 offset:28672
    ds_read_b128 a[16:19], v10 offset:16384
    v_mfma_f32_16x16x32_bf16 v[80:83], v[156:159], a[224:227], v[80:83]
    buffer_load_dwordx4 v1, s[4:7], s61 offen offset:1280 lds
    v_mfma_f32_16x16x32_bf16 v[44:47], a[228:231], v[100:103], v[44:47]
    ds_read_b128 v[116:119], v10 offset:30720
    ds_read_b128 a[20:23], v10 offset:18432
    v_mfma_f32_16x16x32_bf16 v[36:39], a[224:227], v[100:103], v[36:39]
    s_add_u32 m0, s78, 51968
    ds_read_b64_tr_b16 a[248:249], v5 offset:24576
    ds_read_b64_tr_b16 a[250:251], v5 offset:25088
    v_mfma_f32_16x16x32_bf16 v[60:63], a[228:231], a[4:7], v[60:63]
    buffer_load_dwordx4 v1, s[4:7], s62 offen offset:1280 lds
    v_mfma_f32_16x16x32_bf16 v[52:55], a[224:227], a[4:7], v[52:55]
    ds_read_b64_tr_b16 a[252:253], v5 offset:25600
    ds_read_b64_tr_b16 a[254:255], v5 offset:26112
    v_mfma_f32_16x16x32_bf16 v[84:87], v[156:159], a[228:231], v[84:87]
    ds_read_b128 v[120:123], v11 offset:28672
    ds_read_b128 a[24:27], v11 offset:16384
    v_mfma_f32_16x16x32_bf16 v[32:35], a[232:235], v[104:107], v[32:35]
    ds_read_b128 v[124:127], v11 offset:30720
    ds_read_b128 a[28:31], v11 offset:18432
    v_mfma_f32_16x16x32_bf16 v[40:43], a[236:239], v[104:107], v[40:43]
    v_cmp_ne_u64 vcc, s[86:87], v[146:147]
    s_cbranch_vccnz L_slow_st
L_back_st:
    v_mfma_f32_16x16x32_bf16 v[48:51], a[232:235], a[8:11], v[48:51]
    v_cvt_pk_bf16_f32 v148, v144, v144
    v_mfma_f32_16x16x32_bf16 v[56:59], a[236:239], a[8:11], v[56:59]
    v_mul_f32 v146, v145, v145
    v_mul_f32 v145, 0xc0135761, v145
    v_mfma_f32_16x16x32_bf16 v[80:83], v[156:159], a[232:235], v[80:83]
    v_rcp_f32 v147, v146
    v_and_b32 v148, 0xffff0000, v148
    v_mfma_f32_16x16x32_bf16 v[44:47], a[236:239], v[108:111], v[44:47]
    v_mul_f32 v146, v146, v145
    v_mfma_f32_16x16x32_bf16 v[36:39], a[232:235], v[108:111], v[36:39]
    v_sub_f32 v148, v144, v148
    v_mul_f32 v146, 0x3d372713, v146
    v_mfma_f32_16x16x32_bf16 v[60:63], a[236:239], a[12:15], v[60:63]
    v_cvt_pk_bf16_f32 v144, v144, v148
    v_and_b32 v145, 0xffffff7f, v145
    v_mfma_f32_16x16x32_bf16 v[52:55], a[232:235], a[12:15], v[52:55]
    v_and_b32 v146, 0xffffff7f, v146
    v_and_b32 v147, 0xffffff7f, v147
    v_mfma_f32_16x16x32_bf16 v[84:87], v[156:159], a[236:239], v[84:87]
    ds_write_b128 v21, v[144:147]
    s_waitcnt lgkmcnt(12)
    v_mfma_f32_16x16x32_bf16 v[32:35], a[240:243], v[112:115], v[32:35]
    s_add_u32 m0, s78, 56064
    s_waitcnt lgkmcnt(0)
    s_barrier
    v_mfma_f32_16x16x32_bf16 v[40:43], a[244:247], v[112:115], v[40:43]
    s_add_u32 s57, s81, 0
    v_cmp_gt_u32 s[58:59], 32, v0
    s_mul_i32 s56, s32, 24
    v_mfma_f32_16x16x32_bf16 v[48:51], a[240:243], a[16:19], v[48:51]
    s_add_u32 s83, s83, 102400
    v_lshrrev_b32 v26, 4, v0
    v_lshl_add_u32 v26, v26, 8, v4
    v_mfma_f32_16x16x32_bf16 v[56:59], a[244:247], a[16:19], v[56:59]
    s_mov_b32 s91, 0xffff0000
    ds_read_b128 v[128:131], v20 offset:0
    ds_read_b128 v[132:135], v20 offset:256
    v_mfma_f32_16x16x32_bf16 v[80:83], v[156:159], a[240:243], v[80:83]
L_gbody_h1:
    s_cbranch_execz L_gbody_h5
    s_lshl_b32 s92, s32, 14
    ds_read_b128 v[136:139], v20 offset:512
    ds_read_b128 v[140:143], v20 offset:768
    v_mfma_f32_16x16x32_bf16 v[44:47], a[244:247], v[116:119], v[44:47]
    s_add_u32 s92, s92, 12582912
    v_add_u32 v2, s88, v26
    v_and_b32 v26, 15, v0
    v_mfma_f32_16x16x32_bf16 v[36:39], a[240:243], v[116:119], v[36:39]
    s_waitcnt vmcnt(3)
    s_barrier
    v_lshrrev_b32 v27, 4, v0
    v_mfma_f32_16x16x32_bf16 v[60:63], a[244:247], a[20:23], v[60:63]
    buffer_load_dwordx4 v1, s[4:7], s63 offen offset:1280 lds
    v_mfma_f32_16x16x32_bf16 v[52:55], a[240:243], a[20:23], v[52:55]
    s_add_u32 m0, s78, 60160
    v_and_b32 v28, 7, v0
    v_xor_b32 v29, v27, v28
    v_mfma_f32_16x16x32_bf16 v[84:87], v[156:159], a[244:247], v[84:87]
    ds_read_b128 v[96:99], v8 offset:4096
    ds_read_b128 v[100:103], v8 offset:6144
    v_mfma_f32_16x16x32_bf16 v[32:35], a[248:251], v[120:123], v[32:35]
    ds_read_b128 v[104:107], v9 offset:4096
    ds_read_b128 v[108:111], v9 offset:6144
    v_mfma_f32_16x16x32_bf16 v[40:43], a[252:255], v[120:123], v[40:43]
    ds_read_b128 v[112:115], v8 offset:8192
    ds_read_b128 v[116:119], v8 offset:10240
    v_mfma_f32_16x16x32_bf16 v[48:51], a[248:251], a[24:27], v[48:51]
    ds_read_b128 v[120:123], v9 offset:8192
    v_lshlrev_b32 v29, 4, v29
    v_mfma_f32_16x16x32_bf16 v[56:59], a[252:255], a[24:27], v[56:59]
    s_waitcnt lgkmcnt(9)
    v_lshl_add_u32 v29, v26, 8, v29
    v_lshrrev_b32 v26, 3, v0
    v_mfma_f32_16x16x32_bf16 v[80:83], v[156:159], a[248:251], v[80:83]
    s_waitcnt lgkmcnt(7)
    v_mul_u32_u24 v27, 40960, v27
    v_and_b32 v24, 15, v0
    v_mfma_f32_16x16x32_bf16 v[44:47], a[252:255], v[124:127], v[44:47]
    s_nop 0
    v_lshlrev_b32 v24, 10, v24
    s_nop 0
    v_mfma_f32_16x16x32_bf16 v[36:39], a[248:251], v[124:127], v[36:39]
    buffer_load_dwordx4 v1, s[4:7], s64 offen offset:1280 lds
    v_mfma_f32_16x16x32_bf16 v[60:63], a[252:255], a[28:31], v[60:63]
    s_add_u32 m0, s78, 64256
    ds_read_b128 v[124:127], v9 offset:10240
    v_cvt_pk_bf16_f32 v81, v80, v80
    v_mfma_f32_16x16x32_bf16 v[52:55], a[248:251], a[28:31], v[52:55]
    buffer_load_dwordx4 v1, s[4:7], s65 offen offset:1280 lds
    v_mfma_f32_16x16x32_bf16 v[84:87], v[156:159], a[252:255], v[84:87]
    s_add_u32 m0, s78, 68352
    v_and_b32 v82, 0xffff0000, v81
    v_sub_f32 v82, v80, v82
    v_cvt_pk_bf16_f32 v82, v82, v82
    v_mov_b32 v156, s86
    v_mov_b32 v157, s87
    v_cndmask_b32 v82, 0, v82, s[58:59]
    v_cndmask_b32 v80, v82, v81, s[30:31]
    s_waitcnt lgkmcnt(2)
    v_mfma_f32_16x16x32_bf16 v[64:67], v[160:163], v[96:99], 0
    s_waitcnt lgkmcnt(1)
    v_mov_b32 v81, 0
    v_mov_b32 v82, 0
    v_mfma_f32_16x16x32_bf16 v[72:75], v[164:167], v[96:99], 0
    buffer_load_dwordx4 v1, s[4:7], s66 offen offset:1280 lds
    s_add_u32 m0, s78, 72448
    v_mov_b32 v83, 0
    v_cvt_pk_bf16_f32 v85, v84, v84
    v_and_b32 v86, 0xffff0000, v85
    v_mfma_f32_16x16x32_bf16 v[32:35], v[80:83], v[128:131], v[32:35]
    s_nop 0
    ds_read_b128 v[96:99], v8 offset:12288
    v_sub_f32 v86, v84, v86
    v_mfma_f32_16x16x32_bf16 v[36:39], v[80:83], v[132:135], v[36:39]
    s_nop 0
    v_cvt_pk_bf16_f32 v86, v86, v86
    v_cndmask_b32 v86, 0, v86, s[58:59]
    v_mfma_f32_16x16x32_bf16 v[76:79], v[164:167], v[100:103], 0
    s_mul_i32 s58, s35, 384
    v_cndmask_b32 v84, v86, v85, s[30:31]
    v_mov_b32 v85, 0
    v_mfma_f32_16x16x32_bf16 v[68:71], v[160:163], v[100:103], 0
    s_add_u32 s58, s58, s56
    v_mov_b32 v86, 0
    v_mov_b32 v87, 0
    v_mfma_f32_16x16x32_bf16 v[64:67], v[168:171], v[104:107], v[64:67]
    s_lshl_b32 s58, s58, 10
    ds_read_b128 v[100:103], v8 offset:14336
    v_mul_f32 v88, v32, v32
    v_mfma_f32_16x16x32_bf16 v[40:43], v[84:87], v[128:131], v[40:43]
    s_add_u32 s58, s58, 6291456
    v_mul_f32 v89, v33, v33
    v_mul_f32 v90, v34, v34
    v_mfma_f32_16x16x32_bf16 v[44:47], v[84:87], v[132:135], v[44:47]
    s_sub_u32 s14, 16777216, s58
    v_mul_f32 v91, v35, v35
    v_fma_f32 v88, v88, v130, v129
    v_mfma_f32_16x16x32_bf16 v[72:75], v[172:175], v[104:107], v[72:75]
    s_sub_u32 s56, s79, 122880
    v_fma_f32 v89, v89, v130, v129
    v_fma_f32 v90, v90, v130, v129
    v_mfma_f32_16x16x32_bf16 v[76:79], v[172:175], v[108:111], v[76:79]
    s_add_u32 s12, s8, s58
    s_addc_u32 s13, s9, 0
    ds_read_b128 v[104:107], v9 offset:12288
    buffer_load_dwordx4 v1, s[4:7], s67 offen offset:1280 lds
    s_add_u32 m0, s78, 76544
    v_mfma_f32_16x16x32_bf16 v[68:71], v[168:171], v[108:111], v[68:71]
    s_waitcnt lgkmcnt(2)
    v_fma_f32 v91, v91, v130, v129
    v_mul_f32 v88, v88, v32
    v_mfma_f32_16x16x32_bf16 v[64:67], v[176:179], v[112:115], v[64:67]
    ds_read_b128 v[108:111], v9 offset:14336
    v_mul_f32 v89, v89, v33
    v_mfma_f32_16x16x32_bf16 v[72:75], v[180:183], v[112:115], v[72:75]
    buffer_load_dwordx4 v1, s[4:7], s68 offen offset:1280 lds
    s_add_u32 m0, s78, 80640
    v_mul_f32 v90, v90, v34
    v_mul_f32 v91, v91, v35
    v_exp_f32 v88, v88
    v_mul_f32 v32, v32, v40
    v_mfma_f32_16x16x32_bf16 v[76:79], v[180:183], v[116:119], v[76:79]
    s_mov_b32 s68, 0xbfb8aa3b
    ds_read_b128 v[112:115], v8 offset:16384
    v_mul_f32 v33, v33, v41
    v_exp_f32 v89, v89
    v_mfma_f32_16x16x32_bf16 v[68:71], v[176:179], v[116:119], v[68:71]
    s_waitcnt lgkmcnt(3)
    v_exp_f32 v90, v90
    v_mul_f32 v34, v34, v42
    v_exp_f32 v91, v91
    v_mul_f32 v35, v35, v43
    v_mfma_f32_16x16x32_bf16 v[64:67], v[184:187], v[120:123], v[64:67]
    s_waitcnt lgkmcnt(2)
    ds_read_b128 v[116:119], v8 offset:18432
    v_fma_f32 v88, v88, v131, v131
    v_mfma_f32_16x16x32_bf16 v[72:75], v[188:191], v[120:123], v[72:75]
    buffer_load_dwordx4 v1, s[4:7], s69 offen offset:1280 lds
    s_add_u32 m0, s79, 0
    v_add_u32 v1, 655360, v1
    v_fma_f32 v89, v89, v131, v131
    v_fma_f32 v90, v90, v131, v131
    v_fma_f32 v91, v91, v131, v131
    v_rcp_f32 v88, v88
    v_rcp_f32 v89, v89
    v_rcp_f32 v90, v90
    v_rcp_f32 v91, v91
    v_mul_f32 v32, v32, v88
    v_mul_f32 v33, v33, v89
    v_mul_f32 v34, v34, v90
    v_mul_f32 v35, v35, v91
    v_mfma_f32_16x16x32_bf16 v[76:79], v[188:191], v[124:127], v[76:79]
    s_mov_b32 s69, 0x49200000
    ds_read_b128 v[120:123], v9 offset:16384
    buffer_load_dwordx4 v16, s[20:23], 0 offen offset:0 lds
    s_add_u32 m0, s79, 0
    v_mfma_f32_16x16x32_bf16 v[68:71], v[184:187], v[124:127], v[68:71]
    s_waitcnt lgkmcnt(2)
    ds_read_b128 v[128:131], v20 offset:1024
    buffer_load_dwordx4 v17, s[20:23], 0 offen offset:1024 lds
    s_add_u32 m0, s79, 0
    v_cvt_pk_bf16_f32 v144, v32, v33
    v_cvt_pk_bf16_f32 v145, v34, v35
    v_mfma_f32_16x16x32_bf16 v[64:67], v[192:195], v[96:99], v[64:67]
    s_waitcnt lgkmcnt(2)
    ds_read_b128 v[124:127], v9 offset:18432
    buffer_load_dwordx4 v18, s[20:23], 0 offen offset:2048 lds
    s_add_u32 m0, s79, 0
    v_mul_f32 v92, v36, v36
    v_mfma_f32_16x16x32_bf16 v[72:75], v[196:199], v[96:99], v[72:75]
    buffer_load_dwordx4 v19, s[20:23], 0 offen offset:3072 lds
    s_sub_u32 s22, s22, 40960
    s_add_u32 s20, s20, 40960
    s_addc_u32 s21, s21, 0
    v_mul_f32 v93, v37, v37
    v_mul_f32 v94, v38, v38
    v_mfma_f32_16x16x32_bf16 v[76:79], v[196:199], v[100:103], v[76:79]
    s_add_u32 m0, s79, 4096
    ds_read_b128 v[96:99], v8 offset:20480
    buffer_load_dwordx4 v16, s[20:23], 0 offen offset:0 lds
    v_mul_f32 v95, v39, v39
    v_mfma_f32_16x16x32_bf16 v[68:71], v[192:195], v[100:103], v[68:71]
    s_add_u32 m0, s79, 4096
    v_fma_f32 v92, v92, v134, v133
    v_fma_f32 v93, v93, v134, v133
    v_mfma_f32_16x16x32_bf16 v[64:67], v[200:203], v[104:107], v[64:67]
    ds_read_b128 v[100:103], v8 offset:22528
    buffer_load_dwordx4 v17, s[20:23], 0 offen offset:1024 lds
    v_fma_f32 v94, v94, v134, v133
    v_mfma_f32_16x16x32_bf16 v[72:75], v[204:207], v[104:107], v[72:75]
    s_waitcnt lgkmcnt(4)
    v_fma_f32 v95, v95, v134, v133
    v_mul_f32 v92, v92, v36
    v_mfma_f32_16x16x32_bf16 v[76:79], v[204:207], v[108:111], v[76:79]
    s_add_u32 m0, s79, 4096
    ds_read_b128 v[104:107], v9 offset:20480
    v_mul_f32 v93, v93, v37
    v_mfma_f32_16x16x32_bf16 v[68:71], v[200:203], v[108:111], v[68:71]
    s_waitcnt lgkmcnt(4)
    v_mul_f32 v94, v94, v38
    v_mul_f32 v95, v95, v39
    v_exp_f32 v92, v92
    v_mfma_f32_16x16x32_bf16 v[64:67], v[208:211], v[112:115], v[64:67]
    s_waitcnt lgkmcnt(3)
    ds_read_b128 v[108:111], v9 offset:22528
    buffer_load_dwordx4 v18, s[20:23], 0 offen offset:2048 lds
    v_mul_f32 v36, v36, v44
    v_mfma_f32_16x16x32_bf16 v[72:75], v[212:215], v[112:115], v[72:75]
    s_add_u32 m0, s79, 4096
    v_exp_f32 v93, v93
    v_mfma_f32_16x16x32_bf16 v[48:51], v[80:83], v[136:139], v[48:51]
    s_waitcnt lgkmcnt(3)
    ds_read_b128 v[112:115], v8 offset:24576
    buffer_load_dwordx4 v19, s[20:23], 0 offen offset:3072 lds
    v_mfma_f32_16x16x32_bf16 v[56:59], v[84:87], v[136:139], v[56:59]
    s_add_u32 s20, s20, 40960
    s_addc_u32 s21, s21, 0
    s_sub_u32 s22, s22, 40960
    v_mfma_f32_16x16x32_bf16 v[52:55], v[80:83], v[140:143], v[52:55]
    v_mul_f32 v37, v37, v45
    v_mul_f32 v38, v38, v46
    v_mfma_f32_16x16x32_bf16 v[76:79], v[212:215], v[116:119], v[76:79]
    s_add_u32 m0, s70, 86016
    v_exp_f32 v94, v94
    v_mfma_f32_16x16x32_bf16 v[68:71], v[208:211], v[116:119], v[68:71]
    s_waitcnt lgkmcnt(3)
    v_exp_f32 v95, v95
    v_mfma_f32_16x16x32_bf16 v[60:63], v[84:87], v[140:143], v[60:63]
    s_waitcnt lgkmcnt(2)
    ds_read_b128 v[116:119], v8 offset:26624
    buffer_load_dwordx4 v1, s[4:7], 0 offen offset:0 lds
    v_mfma_f32_16x16x32_bf16 v[64:67], v[216:219], v[120:123], v[64:67]
    v_mul_f32 v39, v39, v47
    v_fma_f32 v92, v92, v135, v135
    v_mfma_f32_16x16x32_bf16 v[72:75], v[220:223], v[120:123], v[72:75]
    s_add_u32 m0, s71, 85888
    v_fma_f32 v93, v93, v135, v135
    v_fma_f32 v94, v94, v135, v135
    v_mfma_f32_16x16x32_bf16 v[76:79], v[220:223], v[124:127], v[76:79]
    s_waitcnt lgkmcnt(2)
    ds_read_b128 v[120:123], v9 offset:24576
    buffer_load_dwordx4 v1, s[4:7], 0 offen offset:128 lds
    v_mfma_f32_16x16x32_bf16 v[68:71], v[216:219], v[124:127], v[68:71]
    v_fma_f32 v95, v95, v135, v135
    v_mul_f32 v88, v48, v48
    v_mfma_f32_16x16x32_bf16 v[64:67], v[224:227], v[96:99], v[64:67]
    s_waitcnt lgkmcnt(2)
    ds_read_b128 v[124:127], v9 offset:26624
    ds_read_b128 v[132:135], v20 offset:1280
    v_mfma_f32_16x16x32_bf16 v[72:75], v[228:231], v[96:99], v[72:75]
    s_add_u32 m0, s72, 85760
    v_rcp_f32 v92, v92
    v_mfma_f32_16x16x32_bf16 v[76:79], v[228:231], v[100:103], v[76:79]
    ds_read_b128 v[96:99], v8 offset:28672
    buffer_load_dwordx4 v1, s[4:7], 0 offen offset:256 lds
    v_mfma_f32_16x16x32_bf16 v[68:71], v[224:227], v[100:103], v[68:71]
    v_rcp_f32 v93, v93
    v_rcp_f32 v94, v94
    v_rcp_f32 v95, v95
    v_mfma_f32_16x16x32_bf16 v[64:67], v[232:235], v[104:107], v[64:67]
    s_add_u32 m0, s73, 85632
    ds_read_b128 v[100:103], v8 offset:30720
    v_mul_f32 v36, v36, v92
    v_mfma_f32_16x16x32_bf16 v[72:75], v[236:239], v[104:107], v[72:75]
    s_waitcnt lgkmcnt(5)
    v_mul_f32 v37, v37, v93
    v_mul_f32 v38, v38, v94
    v_mfma_f32_16x16x32_bf16 v[76:79], v[236:239], v[108:111], v[76:79]
    ds_read_b128 v[104:107], v9 offset:28672
    buffer_load_dwordx4 v1, s[4:7], 0 offen offset:384 lds
    v_mfma_f32_16x16x32_bf16 v[68:71], v[232:235], v[108:111], v[68:71]
    s_waitcnt lgkmcnt(5)
    v_mul_f32 v39, v39, v95
    v_cvt_pk_bf16_f32 v146, v36, v37
    v_cvt_pk_bf16_f32 v147, v38, v39
    v_mfma_f32_16x16x32_bf16 v[64:67], v[240:243], v[112:115], v[64:67]
    s_add_u32 m0, s74, 85504
    ds_read_b128 v[108:111], v9 offset:30720
    buffer_load_dwordx4 v1, s[4:7], 0 offen offset:512 lds
    v_permlane16_swap_b32 v144, v146
    v_permlane16_swap_b32 v145, v147
    v_mfma_f32_16x16x32_bf16 v[72:75], v[244:247], v[112:115], v[72:75]
    s_waitcnt lgkmcnt(4)
    v_mul_f32 v89, v49, v49
    v_mul_f32 v90, v50, v50
    v_mfma_f32_16x16x32_bf16 v[76:79], v[244:247], v[116:119], v[76:79]
    s_waitcnt lgkmcnt(3)
    ds_read_b128 v[112:115], v8 offset:32768
    v_mul_f32 v91, v51, v51
    v_mfma_f32_16x16x32_bf16 v[68:71], v[240:243], v[116:119], v[68:71]
    v_fma_f32 v88, v88, v138, v137
    v_fma_f32 v89, v89, v138, v137
    v_fma_f32 v90, v90, v138, v137
    v_fma_f32 v91, v91, v138, v137
    v_mul_f32 v88, v88, v48
    v_mfma_f32_16x16x32_bf16 v[64:67], v[248:251], v[120:123], v[64:67]
    s_waitcnt lgkmcnt(3)
    ds_read_b128 v[116:119], v8 offset:34816
    v_mul_f32 v89, v89, v49
    v_mfma_f32_16x16x32_bf16 v[72:75], v[252:255], v[120:123], v[72:75]
    v_mul_f32 v90, v90, v50
    v_mul_f32 v91, v91, v51
    v_mfma_f32_16x16x32_bf16 v[76:79], v[252:255], v[124:127], v[76:79]
    s_waitcnt lgkmcnt(3)
    ds_read_b128 v[120:123], v9 offset:32768
    v_mul_f32 v48, v48, v56
    v_exp_f32 v88, v88
    v_mfma_f32_16x16x32_bf16 v[68:71], v[248:251], v[124:127], v[68:71]
    v_exp_f32 v89, v89
    v_mul_f32 v49, v49, v57
    v_mfma_f32_16x16x32_bf16 v[64:67], a[192:195], v[96:99], v[64:67]
    s_waitcnt lgkmcnt(3)
    ds_read_b128 v[124:127], v9 offset:34816
    v_mul_f32 v50, v50, v58
    v_exp_f32 v90, v90
    v_mfma_f32_16x16x32_bf16 v[72:75], a[196:199], v[96:99], v[72:75]
    v_exp_f32 v91, v91
    v_mfma_f32_16x16x32_bf16 v[76:79], a[196:199], v[100:103], v[76:79]
    s_waitcnt lgkmcnt(3)
    ds_read_b128 v[96:99], v8 offset:36864
    v_mul_f32 v51, v51, v59
    v_mfma_f32_16x16x32_bf16 v[68:71], a[192:195], v[100:103], v[68:71]
    v_fma_f32 v88, v88, v139, v139
    v_fma_f32 v89, v89, v139, v139
    v_mfma_f32_16x16x32_bf16 v[64:67], a[200:203], v[104:107], v[64:67]
    s_waitcnt lgkmcnt(3)
    ds_read_b128 v[100:103], v8 offset:38912
    v_add_u32 v21, s56, v4
    v_mfma_f32_16x16x32_bf16 v[72:75], a[204:207], v[104:107], v[72:75]
    s_waitcnt vmcnt(9)
    ds_read_b64_tr_b16 a[0:1], v12 offset:0
    ds_read_b64_tr_b16 a[2:3], v12 offset:512
    ds_read_b64_tr_b16 a[4:5], v13 offset:0
    ds_read_b64_tr_b16 a[6:7], v13 offset:512
    ds_read_b64_tr_b16 a[8:9], v14 offset:0
    ds_read_b64_tr_b16 a[10:11], v14 offset:512
    ds_read_b64_tr_b16 a[12:13], v15 offset:0
    ds_read_b64_tr_b16 a[14:15], v15 offset:512
    v_mfma_f32_16x16x32_bf16 v[76:79], a[204:207], v[108:111], v[76:79]
    s_sub_u32 s56, s79, 122880
    ds_read_b128 v[104:107], v9 offset:36864
    v_fma_f32 v90, v90, v139, v139
    v_mfma_f32_16x16x32_bf16 v[68:71], a[200:203], v[108:111], v[68:71]
    s_waitcnt lgkmcnt(12)
    v_fma_f32 v91, v91, v139, v139
    v_mul_f32 v92, v52, v52
    v_mfma_f32_16x16x32_bf16 v[64:67], a[208:211], v[112:115], v[64:67]
    s_waitcnt lgkmcnt(11)
    ds_read_b128 v[108:111], v9 offset:38912
    ds_read_b128 v[136:139], v20 offset:1536
    v_mfma_f32_16x16x32_bf16 v[72:75], a[212:215], v[112:115], v[72:75]
    v_rcp_f32 v88, v88
    v_rcp_f32 v89, v89
    v_mfma_f32_16x16x32_bf16 v[76:79], a[212:215], v[116:119], v[76:79]
    s_waitcnt lgkmcnt(12)
    ds_read_b128 v[112:115], v8 offset:40960
    v_mul_f32 v48, v48, v88
    v_rcp_f32 v90, v90
    v_mfma_f32_16x16x32_bf16 v[68:71], a[208:211], v[116:119], v[68:71]
    s_waitcnt lgkmcnt(12)
    v_rcp_f32 v91, v91
    v_mfma_f32_16x16x32_bf16 v[64:67], a[216:219], v[120:123], v[64:67]
    s_waitcnt lgkmcnt(10)
    ds_read_b128 v[116:119], v8 offset:43008
    v_mul_f32 v49, v49, v89
    v_mfma_f32_16x16x32_bf16 v[72:75], a[220:223], v[120:123], v[72:75]
    s_add_u32 m0, s79, 0
    v_mul_f32 v50, v50, v90
    v_mul_f32 v51, v51, v91
    v_mfma_f32_16x16x32_bf16 v[76:79], a[220:223], v[124:127], v[76:79]
    s_waitcnt lgkmcnt(5)
    buffer_load_dwordx4 v16, s[20:23], 0 offen offset:0 lds
    ds_read_b128 v[120:123], v9 offset:40960
    s_add_u32 m0, s79, 0
    v_mfma_f32_16x16x32_bf16 v[68:71], a[216:219], v[124:127], v[68:71]
    s_waitcnt lgkmcnt(5)
    v_cvt_pk_bf16_f32 v148, v48, v49
    v_cvt_pk_bf16_f32 v149, v50, v51
    v_mfma_f32_16x16x32_bf16 v[64:67], a[224:227], v[96:99], v[64:67]
    s_waitcnt lgkmcnt(4)
    ds_read_b128 v[124:127], v9 offset:43008
    buffer_load_dwordx4 v17, s[20:23], 0 offen offset:1024 lds
    s_add_u32 m0, s79, 0
    v_mfma_f32_16x16x32_bf16 v[72:75], a[228:231], v[96:99], v[72:75]
    s_barrier
    v_mul_f32 v93, v53, v53
    v_mfma_f32_16x16x32_bf16 v[76:79], a[228:231], v[100:103], v[76:79]
    s_waitcnt vmcnt(7)
    ds_read_b64_tr_b16 a[16:17], v12 offset:4096
    buffer_load_dwordx4 v18, s[20:23], 0 offen offset:2048 lds
    s_add_u32 m0, s79, 0
    ds_read_b64_tr_b16 a[18:19], v12 offset:4608
    buffer_load_dwordx4 v19, s[20:23], 0 offen offset:3072 lds
    s_add_u32 m0, s75, 85376
    s_add_u32 s20, s20, 40960
    s_addc_u32 s21, s21, 0
    s_sub_u32 s22, s22, 40960
    ds_read_b64_tr_b16 a[20:21], v13 offset:4096
    buffer_load_dwordx4 v1, s[4:7], 0 offen offset:640 lds
    ds_read_b64_tr_b16 a[22:23], v13 offset:4608
    s_add_u32 m0, s82, 85248
    ds_read_b64_tr_b16 a[24:25], v14 offset:4096
    buffer_load_dwordx4 v1, s[4:7], 0 offen offset:768 lds
    ds_read_b64_tr_b16 a[26:27], v14 offset:4608
    ds_read_b64_tr_b16 a[28:29], v15 offset:4096
    ds_read_b64_tr_b16 a[30:31], v15 offset:4608
    v_mfma_f32_16x16x32_bf16 v[68:71], a[224:227], v[100:103], v[68:71]
    s_waitcnt lgkmcnt(9)
    ds_read_b128 v[96:99], v8 offset:45056
    v_mul_f32 v94, v54, v54
    v_mfma_f32_16x16x32_bf16 v[64:67], a[232:235], v[104:107], v[64:67]
    s_add_u32 m0, s84, 85120
    ds_read_b128 v[100:103], v8 offset:47104
    v_mul_f32 v95, v55, v55
    v_mfma_f32_16x16x32_bf16 v[72:75], a[236:239], v[104:107], v[72:75]
    s_waitcnt lgkmcnt(10)
    v_fma_f32 v92, v92, v142, v141
    v_fma_f32 v93, v93, v142, v141
    v_mfma_f32_16x16x32_bf16 v[76:79], a[236:239], v[108:111], v[76:79]
    ds_read_b128 v[104:107], v9 offset:45056
    buffer_load_dwordx4 v1, s[4:7], 0 offen offset:896 lds
    v_mfma_f32_16x16x32_bf16 v[68:71], a[232:235], v[108:111], v[68:71]
    v_fma_f32 v94, v94, v142, v141
    v_fma_f32 v95, v95, v142, v141
    v_mfma_f32_16x16x32_bf16 v[64:67], a[240:243], v[112:115], v[64:67]
    s_add_u32 m0, s85, 84992
    ds_read_b128 v[108:111], v9 offset:47104
    v_mul_f32 v92, v92, v52
    v_mfma_f32_16x16x32_bf16 v[72:75], a[244:247], v[112:115], v[72:75]
    s_waitcnt lgkmcnt(10)
    v_mul_f32 v93, v93, v53
    v_mul_f32 v94, v94, v54
    v_mfma_f32_16x16x32_bf16 v[76:79], a[244:247], v[116:119], v[76:79]
    s_waitcnt lgkmcnt(8)
    ds_read_b128 v[112:115], v8 offset:49152
    buffer_load_dwordx4 v1, s[4:7], 0 offen offset:1024 lds
    v_mfma_f32_16x16x32_bf16 v[68:71], a[240:243], v[116:119], v[68:71]
    s_waitcnt lgkmcnt(7)
    v_mul_f32 v95, v95, v55
    v_mul_f32 v52, v52, v60
    v_mfma_f32_16x16x32_bf16 v[64:67], a[248:251], v[120:123], v[64:67]
    s_add_u32 m0, s90, 84864
    ds_read_b128 v[116:119], v8 offset:51200
    v_mul_f32 v53, v53, v61
    v_mfma_f32_16x16x32_bf16 v[72:75], a[252:255], v[120:123], v[72:75]
    s_waitcnt lgkmcnt(5)
    v_exp_f32 v92, v92
    v_mfma_f32_16x16x32_bf16 v[76:79], a[252:255], v[124:127], v[76:79]
    s_waitcnt lgkmcnt(4)
    ds_read_b128 v[120:123], v9 offset:49152
    buffer_load_dwordx4 v1, s[4:7], 0 offen offset:1152 lds
    v_mfma_f32_16x16x32_bf16 v[68:71], a[248:251], v[124:127], v[68:71]
    s_barrier
    v_add_u32 v1, 1280, v1
    v_mfma_f32_16x16x32_bf16 v[32:35], v[160:163], v[96:99], 0
    s_add_u32 m0, s79, 4096
    ds_read_b128 v[124:127], v9 offset:51200
    v_mul_f32 v54, v54, v62
    v_mfma_f32_16x16x32_bf16 v[40:43], v[164:167], v[96:99], 0
    s_waitcnt lgkmcnt(5)
    v_exp_f32 v93, v93
    v_exp_f32 v94, v94
    v_mfma_f32_16x16x32_bf16 v[64:67], v[80:83], v[128:131], v[64:67]
    s_waitcnt lgkmcnt(4)
    ds_read_b128 v[96:99], v8 offset:53248
    buffer_load_dwordx4 v16, s[20:23], 0 offen offset:0 lds
    v_mfma_f32_16x16x32_bf16 v[44:47], v[164:167], v[100:103], 0
    s_add_u32 m0, s79, 4096
    v_exp_f32 v95, v95
    v_mfma_f32_16x16x32_bf16 v[36:39], v[160:163], v[100:103], 0
    s_waitcnt lgkmcnt(4)
    v_mul_f32 v55, v55, v63
    v_fma_f32 v92, v92, v143, v143
    v_mfma_f32_16x16x32_bf16 v[72:75], v[84:87], v[128:131], v[72:75]
    s_waitcnt lgkmcnt(3)
    ds_read_b128 v[100:103], v8 offset:55296
    buffer_load_dwordx4 v17, s[20:23], 0 offen offset:1024 lds
    v_mfma_f32_16x16x32_bf16 v[68:71], v[80:83], v[132:135], v[68:71]
    v_fma_f32 v93, v93, v143, v143
    v_fma_f32 v94, v94, v143, v143
    v_mfma_f32_16x16x32_bf16 v[32:35], v[168:171], v[104:107], v[32:35]
    s_add_u32 m0, s79, 4096
    v_fma_f32 v95, v95, v143, v143
    v_mul_f32 v88, v64, v64
    v_mfma_f32_16x16x32_bf16 v[40:43], v[172:175], v[104:107], v[40:43]
    s_waitcnt lgkmcnt(3)
    ds_read_b128 v[140:143], v20 offset:1792
    buffer_load_dwordx4 v18, s[20:23], 0 offen offset:2048 lds
    v_mfma_f32_16x16x32_bf16 v[76:79], v[84:87], v[132:135], v[76:79]
    s_waitcnt lgkmcnt(3)
    ds_read_b128 v[104:107], v9 offset:53248
    v_mul_f32 v89, v65, v65
    v_mfma_f32_16x16x32_bf16 v[44:47], v[172:175], v[108:111], v[44:47]
    v_rcp_f32 v92, v92
    v_mfma_f32_16x16x32_bf16 v[36:39], v[168:171], v[108:111], v[36:39]
    s_add_u32 m0, s79, 4096
    v_rcp_f32 v93, v93
    v_mfma_f32_16x16x32_bf16 v[32:35], v[176:179], v[112:115], v[32:35]
    s_waitcnt lgkmcnt(3)
    ds_read_b128 v[108:111], v9 offset:55296
    buffer_load_dwordx4 v19, s[20:23], 0 offen offset:3072 lds
    v_mfma_f32_16x16x32_bf16 v[40:43], v[180:183], v[112:115], v[40:43]
    s_add_u32 s20, s20, 40960
    s_addc_u32 s21, s21, 0
    s_sub_u32 s22, s22, 40960
    v_rcp_f32 v94, v94
    v_rcp_f32 v95, v95
    v_mul_f32 v52, v52, v92
    v_mfma_f32_16x16x32_bf16 v[44:47], v[180:183], v[116:119], v[44:47]
    s_waitcnt lgkmcnt(3)
    ds_read_b128 v[112:115], v8 offset:57344
    v_mul_f32 v53, v53, v93
    v_mfma_f32_16x16x32_bf16 v[36:39], v[176:179], v[116:119], v[36:39]
    buffer_store_dwordx4 v[144:147], v4, s[8:11], s57 offen sc1
    v_mul_f32 v54, v54, v94
    v_mul_f32 v55, v55, v95
    v_mfma_f32_16x16x32_bf16 v[32:35], v[184:187], v[120:123], v[32:35]
    s_add_u32 s57, s81, 393216
    ds_read_b128 v[116:119], v8 offset:59392
    v_cvt_pk_bf16_f32 v150, v52, v53
    v_mfma_f32_16x16x32_bf16 v[40:43], v[188:191], v[120:123], v[40:43]
    s_waitcnt lgkmcnt(3)
    v_cvt_pk_bf16_f32 v151, v54, v55
    v_permlane16_swap_b32 v148, v150
    v_mfma_f32_16x16x32_bf16 v[44:47], v[188:191], v[124:127], v[44:47]
    ds_read_b128 v[120:123], v9 offset:57344
    v_permlane16_swap_b32 v149, v151
    v_mfma_f32_16x16x32_bf16 v[36:39], v[184:187], v[124:127], v[36:39]
    s_waitcnt lgkmcnt(3)
    v_mul_f32 v90, v66, v66
    v_mul_f32 v91, v67, v67
    v_mfma_f32_16x16x32_bf16 v[32:35], v[192:195], v[96:99], v[32:35]
    ds_read_b128 v[124:127], v9 offset:59392
    v_fma_f32 v88, v88, v130, v129
    v_mfma_f32_16x16x32_bf16 v[40:43], v[196:199], v[96:99], v[40:43]
    buffer_store_dwordx4 v[148:151], v4, s[8:11], s57 offen sc1
    v_mfma_f32_16x16x32_bf16 v[44:47], v[196:199], v[100:103], v[44:47]
    s_add_u32 s57, s81, 98304
    ds_read_b128 v[96:99], v8 offset:61440
    v_fma_f32 v89, v89, v130, v129
    v_mfma_f32_16x16x32_bf16 v[36:39], v[192:195], v[100:103], v[36:39]
    s_waitcnt lgkmcnt(4)
    v_fma_f32 v90, v90, v130, v129
    v_fma_f32 v91, v91, v130, v129
    v_mfma_f32_16x16x32_bf16 v[32:35], v[200:203], v[104:107], v[32:35]
    s_waitcnt vmcnt(11)
    ds_read_b64_tr_b16 a[32:33], v12 offset:0
    v_mfma_f32_16x16x32_bf16 v[40:43], v[204:207], v[104:107], v[40:43]
    s_waitcnt lgkmcnt(4)
    ds_read_b128 v[100:103], v8 offset:63488
    ds_read_b64_tr_b16 a[34:35], v12 offset:512
    v_mfma_f32_16x16x32_bf16 v[44:47], v[204:207], v[108:111], v[44:47]
    ds_read_b128 v[104:107], v9 offset:61440
    ds_read_b64_tr_b16 a[36:37], v13 offset:0
    v_mfma_f32_16x16x32_bf16 v[36:39], v[200:203], v[108:111], v[36:39]
    s_waitcnt lgkmcnt(7)
    ds_read_b64_tr_b16 a[38:39], v13 offset:512
    ds_read_b64_tr_b16 a[40:41], v14 offset:0
    v_mfma_f32_16x16x32_bf16 v[32:35], v[208:211], v[112:115], v[32:35]
    ds_read_b128 v[108:111], v9 offset:63488
    ds_read_b64_tr_b16 a[42:43], v14 offset:512
    v_mfma_f32_16x16x32_bf16 v[40:43], v[212:215], v[112:115], v[40:43]
    s_waitcnt lgkmcnt(10)
    ds_read_b64_tr_b16 a[44:45], v15 offset:0
    ds_read_b64_tr_b16 a[46:47], v15 offset:512
    v_mfma_f32_16x16x32_bf16 v[44:47], v[212:215], v[116:119], v[44:47]
    ds_read_b128 v[112:115], v10 offset:0
    v_mul_f32 v88, v88, v64
    v_mfma_f32_16x16x32_bf16 v[36:39], v[208:211], v[116:119], v[36:39]
    v_mul_f32 v89, v89, v65
    v_mul_f32 v90, v90, v66
    v_mfma_f32_16x16x32_bf16 v[32:35], v[216:219], v[120:123], v[32:35]
    s_waitcnt lgkmcnt(12)
    ds_read_b128 v[116:119], v10 offset:2048
    v_mul_f32 v91, v91, v67
    v_mfma_f32_16x16x32_bf16 v[40:43], v[220:223], v[120:123], v[40:43]
    v_exp_f32 v88, v88
    v_mfma_f32_16x16x32_bf16 v[44:47], v[220:223], v[124:127], v[44:47]
    s_waitcnt lgkmcnt(12)
    ds_read_b128 v[120:123], v11 offset:0
    v_mul_f32 v64, v64, v72
    v_mfma_f32_16x16x32_bf16 v[36:39], v[216:219], v[124:127], v[36:39]
    s_waitcnt lgkmcnt(11)
    v_exp_f32 v89, v89
    v_mfma_f32_16x16x32_bf16 v[32:35], v[224:227], v[96:99], v[32:35]
    s_add_u32 m0, s70, 4096
    ds_read_b128 v[124:127], v11 offset:2048
    v_mul_f32 v65, v65, v73
    v_mfma_f32_16x16x32_bf16 v[40:43], v[228:231], v[96:99], v[40:43]
    s_waitcnt lgkmcnt(8)
    v_exp_f32 v90, v90
    v_mfma_f32_16x16x32_bf16 v[44:47], v[228:231], v[100:103], v[44:47]
    s_waitcnt lgkmcnt(6)
    ds_read_b128 v[96:99], v10 offset:4096
    buffer_load_dwordx4 v1, s[4:7], 0 offen offset:0 lds
    v_mfma_f32_16x16x32_bf16 v[36:39], v[224:227], v[100:103], v[36:39]
    s_waitcnt lgkmcnt(5)
    v_mul_f32 v66, v66, v74
    v_mul_f32 v67, v67, v75
    v_mfma_f32_16x16x32_bf16 v[32:35], v[232:235], v[104:107], v[32:35]
    s_add_u32 m0, s71, 3968
    ds_read_b128 v[100:103], v10 offset:6144
    v_fma_f32 v88, v88, v131, v131
    v_mfma_f32_16x16x32_bf16 v[40:43], v[236:239], v[104:107], v[40:43]
    s_waitcnt lgkmcnt(5)
    v_exp_f32 v91, v91
    v_mfma_f32_16x16x32_bf16 v[44:47], v[236:239], v[108:111], v[44:47]
    s_waitcnt lgkmcnt(4)
    ds_read_b128 v[104:107], v11 offset:4096
    buffer_load_dwordx4 v1, s[4:7], 0 offen offset:128 lds
    v_mfma_f32_16x16x32_bf16 v[36:39], v[232:235], v[108:111], v[36:39]
    v_fma_f32 v89, v89, v131, v131
    v_fma_f32 v90, v90, v131, v131
    v_mfma_f32_16x16x32_bf16 v[32:35], v[240:243], v[112:115], v[32:35]
    s_add_u32 m0, s72, 3840
    ds_read_b128 v[108:111], v11 offset:6144
    v_fma_f32 v91, v91, v131, v131
    v_mfma_f32_16x16x32_bf16 v[40:43], v[244:247], v[112:115], v[40:43]
    s_waitcnt lgkmcnt(5)
    ds_read_b128 v[128:131], v20 offset:2048
    buffer_load_dwordx4 v1, s[4:7], 0 offen offset:256 lds
    v_mfma_f32_16x16x32_bf16 v[44:47], v[244:247], v[116:119], v[44:47]
    s_waitcnt lgkmcnt(5)
    ds_read_b128 v[112:115], v10 offset:8192
    v_mul_f32 v92, v68, v68
    v_mfma_f32_16x16x32_bf16 v[36:39], v[240:243], v[116:119], v[36:39]
L_gbody_h2:
    s_cbranch_execz L_gbody_h6
    v_rcp_f32 v88, v88
    v_mfma_f32_16x16x32_bf16 v[32:35], v[248:251], v[120:123], v[32:35]
    s_add_u32 m0, s73, 3712
    ds_read_b128 v[116:119], v10 offset:10240
    v_mul_f32 v64, v64, v88
    v_mfma_f32_16x16x32_bf16 v[40:43], v[252:255], v[120:123], v[40:43]
    s_waitcnt lgkmcnt(6)
    v_rcp_f32 v89, v89
    v_rcp_f32 v90, v90
    v_mfma_f32_16x16x32_bf16 v[44:47], v[252:255], v[124:127], v[44:47]
    s_waitcnt lgkmcnt(5)
    ds_read_b128 v[120:123], v11 offset:8192
    buffer_load_dwordx4 v1, s[4:7], 0 offen offset:384 lds
    v_mfma_f32_16x16x32_bf16 v[36:39], v[248:251], v[124:127], v[36:39]
    s_add_u32 m0, s74, 3584
    v_rcp_f32 v91, v91
    v_mfma_f32_16x16x32_bf16 v[32:35], a[192:195], v[96:99], v[32:35]
    s_waitcnt lgkmcnt(5)
    ds_read_b128 v[124:127], v11 offset:10240
    buffer_load_dwordx4 v1, s[4:7], 0 offen offset:512 lds
    v_mfma_f32_16x16x32_bf16 v[40:43], a[196:199], v[96:99], v[40:43]
    s_waitcnt lgkmcnt(5)
    v_mul_f32 v65, v65, v89
    v_mul_f32 v66, v66, v90
    v_mfma_f32_16x16x32_bf16 v[44:47], a[196:199], v[100:103], v[44:47]
    s_waitcnt lgkmcnt(4)
    ds_read_b128 v[96:99], v10 offset:12288
    v_mul_f32 v67, v67, v91
    v_mfma_f32_16x16x32_bf16 v[36:39], a[192:195], v[100:103], v[36:39]
    s_add_u32 m0, s79, 0
    v_cvt_pk_bf16_f32 v152, v64, v65
    v_cvt_pk_bf16_f32 v153, v66, v67
    v_mfma_f32_16x16x32_bf16 v[32:35], a[200:203], v[104:107], v[32:35]
    s_waitcnt lgkmcnt(4)
    ds_read_b128 v[100:103], v10 offset:14336
    buffer_load_dwordx4 v16, s[20:23], 0 offen offset:0 lds
    v_mfma_f32_16x16x32_bf16 v[40:43], a[204:207], v[104:107], v[40:43]
    s_waitcnt lgkmcnt(4)
    v_mul_f32 v93, v69, v69
    v_mul_f32 v94, v70, v70
    v_mfma_f32_16x16x32_bf16 v[44:47], a[204:207], v[108:111], v[44:47]
    ds_read_b128 v[104:107], v11 offset:12288
    v_mul_f32 v95, v71, v71
    v_mfma_f32_16x16x32_bf16 v[36:39], a[200:203], v[108:111], v[36:39]
    s_add_u32 m0, s79, 0
    s_waitcnt vmcnt(8)
    ds_read_b64_tr_b16 a[48:49], v12 offset:4096
    v_mfma_f32_16x16x32_bf16 v[32:35], a[208:211], v[112:115], v[32:35]
    s_waitcnt lgkmcnt(5)
    ds_read_b128 v[108:111], v11 offset:14336
    buffer_load_dwordx4 v17, s[20:23], 0 offen offset:1024 lds
    v_mfma_f32_16x16x32_bf16 v[40:43], a[212:215], v[112:115], v[40:43]
    ds_read_b64_tr_b16 a[50:51], v12 offset:4608
    ds_read_b64_tr_b16 a[52:53], v13 offset:4096
    v_mfma_f32_16x16x32_bf16 v[44:47], a[212:215], v[116:119], v[44:47]
    s_waitcnt lgkmcnt(7)
    ds_read_b128 v[112:115], v10 offset:16384
    ds_read_b64_tr_b16 a[54:55], v13 offset:4608
    v_mfma_f32_16x16x32_bf16 v[36:39], a[208:211], v[116:119], v[36:39]
    s_add_u32 m0, s79, 0
    ds_read_b64_tr_b16 a[56:57], v14 offset:4096
    ds_read_b64_tr_b16 a[58:59], v14 offset:4608
    v_fma_f32 v92, v92, v134, v133
    v_fma_f32 v93, v93, v134, v133
    v_mfma_f32_16x16x32_bf16 v[32:35], a[216:219], v[120:123], v[32:35]
    s_waitcnt lgkmcnt(10)
    ds_read_b128 v[116:119], v10 offset:18432
    buffer_load_dwordx4 v18, s[20:23], 0 offen offset:2048 lds
    v_mfma_f32_16x16x32_bf16 v[40:43], a[220:223], v[120:123], v[40:43]
    s_waitcnt lgkmcnt(10)
    ds_read_b64_tr_b16 a[60:61], v15 offset:4096
    ds_read_b64_tr_b16 a[62:63], v15 offset:4608
    v_fma_f32 v94, v94, v134, v133
    v_fma_f32 v95, v95, v134, v133
    v_mfma_f32_16x16x32_bf16 v[44:47], a[220:223], v[124:127], v[44:47]
    s_add_u32 m0, s79, 0
    ds_read_b128 v[120:123], v11 offset:16384
    v_mul_f32 v92, v92, v68
    v_mfma_f32_16x16x32_bf16 v[36:39], a[216:219], v[124:127], v[36:39]
    s_waitcnt lgkmcnt(12)
    v_mul_f32 v93, v93, v69
    v_mul_f32 v94, v94, v70
    v_mfma_f32_16x16x32_bf16 v[32:35], a[224:227], v[96:99], v[32:35]
    s_waitcnt lgkmcnt(11)
    ds_read_b128 v[124:127], v11 offset:18432
    buffer_load_dwordx4 v19, s[20:23], 0 offen offset:3072 lds
    v_mfma_f32_16x16x32_bf16 v[40:43], a[228:231], v[96:99], v[40:43]
    s_barrier
    s_sub_u32 s22, s22, 40960
    v_mul_f32 v95, v95, v71
    v_exp_f32 v92, v92
    v_mfma_f32_16x16x32_bf16 v[44:47], a[228:231], v[100:103], v[44:47]
    s_add_u32 m0, s75, 3456
    s_add_u32 s20, s20, 40960
    s_addc_u32 s21, s21, 0
    v_mfma_f32_16x16x32_bf16 v[36:39], a[224:227], v[100:103], v[36:39]
    s_waitcnt lgkmcnt(5)
    ds_read_b128 v[96:99], v10 offset:20480
    buffer_load_dwordx4 v1, s[4:7], 0 offen offset:640 lds
    v_mul_f32 v68, v68, v76
    v_exp_f32 v93, v93
    v_mfma_f32_16x16x32_bf16 v[32:35], a[232:235], v[104:107], v[32:35]
    s_waitcnt lgkmcnt(5)
    ds_read_b128 v[100:103], v10 offset:22528
    v_mul_f32 v69, v69, v77
    v_mfma_f32_16x16x32_bf16 v[40:43], a[236:239], v[104:107], v[40:43]
    s_add_u32 m0, s82, 3328
    v_exp_f32 v94, v94
    v_mfma_f32_16x16x32_bf16 v[44:47], a[236:239], v[108:111], v[44:47]
    s_waitcnt lgkmcnt(3)
    ds_read_b128 v[104:107], v11 offset:20480
    buffer_load_dwordx4 v1, s[4:7], 0 offen offset:768 lds
    v_mfma_f32_16x16x32_bf16 v[36:39], a[232:235], v[108:111], v[36:39]
    v_mul_f32 v70, v70, v78
    v_mul_f32 v71, v71, v79
    v_mfma_f32_16x16x32_bf16 v[32:35], a[240:243], v[112:115], v[32:35]
    s_add_u32 m0, s84, 3200
    ds_read_b128 v[108:111], v11 offset:22528
    v_fma_f32 v92, v92, v135, v135
    v_mfma_f32_16x16x32_bf16 v[40:43], a[244:247], v[112:115], v[40:43]
    s_waitcnt lgkmcnt(4)
    v_exp_f32 v95, v95
    v_mfma_f32_16x16x32_bf16 v[44:47], a[244:247], v[116:119], v[44:47]
    ds_read_b128 v[112:115], v10 offset:24576
    buffer_load_dwordx4 v1, s[4:7], 0 offen offset:896 lds
    v_mfma_f32_16x16x32_bf16 v[36:39], a[240:243], v[116:119], v[36:39]
    v_fma_f32 v93, v93, v135, v135
    v_fma_f32 v94, v94, v135, v135
    v_mfma_f32_16x16x32_bf16 v[32:35], a[248:251], v[120:123], v[32:35]
    s_add_u32 m0, s85, 3072
    ds_read_b128 v[116:119], v10 offset:26624
    v_fma_f32 v95, v95, v135, v135
    v_mfma_f32_16x16x32_bf16 v[40:43], a[252:255], v[120:123], v[40:43]
    s_waitcnt lgkmcnt(5)
    ds_read_b128 v[132:135], v20 offset:2304
    buffer_load_dwordx4 v1, s[4:7], 0 offen offset:1024 lds
    v_mfma_f32_16x16x32_bf16 v[44:47], a[252:255], v[124:127], v[44:47]
    s_waitcnt lgkmcnt(5)
    ds_read_b128 v[120:123], v11 offset:24576
    v_mfma_f32_16x16x32_bf16 v[36:39], a[248:251], v[124:127], v[36:39]
    s_barrier
    v_mfma_f32_16x16x32_bf16 v[48:51], v[160:163], v[96:99], 0
    s_add_u32 m0, s90, 2944
    ds_read_b128 v[124:127], v11 offset:26624
    v_mfma_f32_16x16x32_bf16 v[56:59], v[164:167], v[96:99], 0
    s_waitcnt lgkmcnt(6)
    v_rcp_f32 v92, v92
    v_mfma_f32_16x16x32_bf16 v[32:35], v[80:83], v[136:139], v[32:35]
    s_waitcnt lgkmcnt(5)
    ds_read_b128 v[96:99], v10 offset:28672
    buffer_load_dwordx4 v1, s[4:7], 0 offen offset:1152 lds
    v_mfma_f32_16x16x32_bf16 v[60:63], v[164:167], v[100:103], 0
    s_nop 0
    v_add_u32 v1, 654080, v1
    v_mul_f32 v68, v68, v92
    v_mfma_f32_16x16x32_bf16 v[52:55], v[160:163], v[100:103], 0
    s_add_u32 m0, s79, 4096
    v_rcp_f32 v93, v93
    v_mfma_f32_16x16x32_bf16 v[40:43], v[84:87], v[136:139], v[40:43]
    s_waitcnt lgkmcnt(5)
    ds_read_b128 v[100:103], v10 offset:30720
    buffer_load_dwordx4 v16, s[20:23], 0 offen offset:0 lds
    v_mfma_f32_16x16x32_bf16 v[36:39], v[80:83], v[140:143], v[36:39]
    s_waitcnt lgkmcnt(5)
    v_rcp_f32 v94, v94
    v_mfma_f32_16x16x32_bf16 v[48:51], v[168:171], v[104:107], v[48:51]
    s_waitcnt lgkmcnt(4)
    v_rcp_f32 v95, v95
    v_mfma_f32_16x16x32_bf16 v[56:59], v[172:175], v[104:107], v[56:59]
    s_add_u32 m0, s79, 4096
    v_mul_f32 v69, v69, v93
    v_mul_f32 v70, v70, v94
    v_mfma_f32_16x16x32_bf16 v[44:47], v[84:87], v[140:143], v[44:47]
    s_waitcnt lgkmcnt(3)
    ds_read_b128 v[104:107], v11 offset:28672
    buffer_load_dwordx4 v17, s[20:23], 0 offen offset:1024 lds
    v_mfma_f32_16x16x32_bf16 v[60:63], v[172:175], v[108:111], v[60:63]
    s_waitcnt lgkmcnt(3)
    v_mul_f32 v71, v71, v95
    v_cvt_pk_bf16_f32 v154, v68, v69
    v_mfma_f32_16x16x32_bf16 v[52:55], v[168:171], v[108:111], v[52:55]
    s_nop 0
    v_cvt_pk_bf16_f32 v155, v70, v71
    v_permlane16_swap_b32 v152, v154
    v_mfma_f32_16x16x32_bf16 v[48:51], v[176:179], v[112:115], v[48:51]
    s_add_u32 m0, s79, 4096
    ds_read_b128 v[108:111], v11 offset:30720
    v_permlane16_swap_b32 v153, v155
    v_mfma_f32_16x16x32_bf16 v[56:59], v[180:183], v[112:115], v[56:59]
    s_waitcnt lgkmcnt(3)
    v_mul_f32 v88, v32, v32
    v_mul_f32 v89, v33, v33
    v_mfma_f32_16x16x32_bf16 v[60:63], v[180:183], v[116:119], v[60:63]
    ds_read_b128 v[112:115], v10 offset:32768
    buffer_load_dwordx4 v18, s[20:23], 0 offen offset:2048 lds
    v_mfma_f32_16x16x32_bf16 v[52:55], v[176:179], v[116:119], v[52:55]
    s_waitcnt lgkmcnt(3)
    v_mul_f32 v90, v34, v34
    v_mul_f32 v91, v35, v35
    v_mfma_f32_16x16x32_bf16 v[48:51], v[184:187], v[120:123], v[48:51]
    s_add_u32 m0, s79, 4096
    ds_read_b128 v[116:119], v10 offset:34816
    v_fma_f32 v88, v88, v138, v137
    v_mfma_f32_16x16x32_bf16 v[56:59], v[188:191], v[120:123], v[56:59]
    buffer_load_dwordx4 v19, s[20:23], 0 offen offset:3072 lds
    s_sub_u32 s22, s22, 40960
    v_mfma_f32_16x16x32_bf16 v[60:63], v[188:191], v[124:127], v[60:63]
    s_add_u32 s20, s20, 40960
    s_addc_u32 s21, s21, 0
    ds_read_b128 v[120:123], v11 offset:32768
    v_mfma_f32_16x16x32_bf16 v[52:55], v[184:187], v[124:127], v[52:55]
    s_waitcnt lgkmcnt(4)
    v_fma_f32 v89, v89, v138, v137
    v_fma_f32 v90, v90, v138, v137
    v_mfma_f32_16x16x32_bf16 v[48:51], v[192:195], v[96:99], v[48:51]
    s_add_u32 m0, s70, 45056
    ds_read_b128 v[124:127], v11 offset:34816
    v_fma_f32 v91, v91, v138, v137
    v_mfma_f32_16x16x32_bf16 v[56:59], v[196:199], v[96:99], v[56:59]
    buffer_load_dwordx4 v1, s[4:7], 0 offen offset:0 lds
    v_mul_f32 v88, v88, v32
    v_mfma_f32_16x16x32_bf16 v[60:63], v[196:199], v[100:103], v[60:63]
    s_waitcnt lgkmcnt(4)
    ds_read_b128 v[96:99], v10 offset:36864
    v_mul_f32 v89, v89, v33
    v_mfma_f32_16x16x32_bf16 v[52:55], v[192:195], v[100:103], v[52:55]
    v_mul_f32 v90, v90, v34
    v_mul_f32 v91, v91, v35
    v_mfma_f32_16x16x32_bf16 v[48:51], v[200:203], v[104:107], v[48:51]
    s_add_u32 m0, s71, 44928
    ds_read_b128 v[100:103], v10 offset:38912
    v_mul_f32 v32, v32, v40
    v_mfma_f32_16x16x32_bf16 v[56:59], v[204:207], v[104:107], v[56:59]
    s_waitcnt lgkmcnt(5)
    v_exp_f32 v88, v88
    v_mfma_f32_16x16x32_bf16 v[60:63], v[204:207], v[108:111], v[60:63]
    s_waitcnt lgkmcnt(4)
    ds_read_b128 v[104:107], v11 offset:36864
    buffer_load_dwordx4 v1, s[4:7], 0 offen offset:128 lds
    v_mfma_f32_16x16x32_bf16 v[52:55], v[200:203], v[108:111], v[52:55]
    v_exp_f32 v89, v89
    v_mfma_f32_16x16x32_bf16 v[48:51], v[208:211], v[112:115], v[48:51]
    s_add_u32 m0, s72, 44800
    ds_read_b128 v[108:111], v11 offset:38912
    v_mul_f32 v33, v33, v41
    v_mfma_f32_16x16x32_bf16 v[56:59], v[212:215], v[112:115], v[56:59]
    s_waitcnt lgkmcnt(5)
    v_exp_f32 v90, v90
    v_mfma_f32_16x16x32_bf16 v[60:63], v[212:215], v[116:119], v[60:63]
    s_waitcnt lgkmcnt(4)
    ds_read_b128 v[112:115], v10 offset:40960
    buffer_load_dwordx4 v1, s[4:7], 0 offen offset:256 lds
    v_mfma_f32_16x16x32_bf16 v[52:55], v[208:211], v[116:119], v[52:55]
    v_mul_f32 v34, v34, v42
    v_mul_f32 v35, v35, v43
    v_mfma_f32_16x16x32_bf16 v[48:51], v[216:219], v[120:123], v[48:51]
    s_add_u32 m0, s73, 44672
    ds_read_b128 v[116:119], v10 offset:43008
    buffer_load_dwordx4 v1, s[4:7], 0 offen offset:384 lds
    v_mfma_f32_16x16x32_bf16 v[56:59], v[220:223], v[120:123], v[56:59]
    s_waitcnt lgkmcnt(5)
    v_exp_f32 v91, v91
    v_mfma_f32_16x16x32_bf16 v[60:63], v[220:223], v[124:127], v[60:63]
    s_waitcnt vmcnt(13)
    ds_read_b64_tr_b16 a[64:65], v12 offset:0
    ds_read_b128 v[120:123], v11 offset:40960
    ds_read_b64_tr_b16 a[66:67], v12 offset:512
    ds_read_b64_tr_b16 a[68:69], v13 offset:0
    ds_read_b64_tr_b16 a[70:71], v13 offset:512
    ds_read_b64_tr_b16 a[72:73], v14 offset:0
    ds_read_b64_tr_b16 a[74:75], v14 offset:512
    v_mfma_f32_16x16x32_bf16 v[52:55], v[216:219], v[124:127], v[52:55]
    s_add_u32 m0, s74, 44544
    ds_read_b64_tr_b16 a[76:77], v15 offset:0
    buffer_load_dwordx4 v1, s[4:7], 0 offen offset:512 lds
    ds_read_b64_tr_b16 a[78:79], v15 offset:512
    v_mfma_f32_16x16x32_bf16 v[48:51], v[224:227], v[96:99], v[48:51]
    s_waitcnt lgkmcnt(11)
    ds_read_b128 v[124:127], v11 offset:43008
    v_fma_f32 v88, v88, v139, v139
    v_mfma_f32_16x16x32_bf16 v[56:59], v[228:231], v[96:99], v[56:59]
    v_fma_f32 v89, v89, v139, v139
    v_fma_f32 v90, v90, v139, v139
    v_mfma_f32_16x16x32_bf16 v[60:63], v[228:231], v[100:103], v[60:63]
    s_waitcnt lgkmcnt(11)
    ds_read_b128 v[96:99], v10 offset:45056
    v_fma_f32 v91, v91, v139, v139
    v_mfma_f32_16x16x32_bf16 v[52:55], v[224:227], v[100:103], v[52:55]
    ds_read_b128 v[136:139], v20 offset:2560
    v_mul_f32 v92, v36, v36
    v_mfma_f32_16x16x32_bf16 v[48:51], v[232:235], v[104:107], v[48:51]
    s_waitcnt lgkmcnt(12)
    ds_read_b128 v[100:103], v10 offset:47104
    v_mul_f32 v93, v37, v37
    v_mfma_f32_16x16x32_bf16 v[56:59], v[236:239], v[104:107], v[56:59]
    v_rcp_f32 v88, v88
    v_mfma_f32_16x16x32_bf16 v[60:63], v[236:239], v[108:111], v[60:63]
    s_waitcnt lgkmcnt(11)
    ds_read_b128 v[104:107], v11 offset:45056
    v_mul_f32 v32, v32, v88
    v_mfma_f32_16x16x32_bf16 v[52:55], v[232:235], v[108:111], v[52:55]
    s_waitcnt lgkmcnt(8)
    v_rcp_f32 v89, v89
    v_mfma_f32_16x16x32_bf16 v[48:51], v[240:243], v[112:115], v[48:51]
    s_add_u32 m0, s79, 0
    ds_read_b128 v[108:111], v11 offset:47104
    v_mul_f32 v33, v33, v89
    v_mfma_f32_16x16x32_bf16 v[56:59], v[244:247], v[112:115], v[56:59]
    s_waitcnt lgkmcnt(6)
    buffer_load_dwordx4 v16, s[20:23], 0 offen offset:0 lds
    s_add_u32 m0, s79, 0
    v_mfma_f32_16x16x32_bf16 v[60:63], v[244:247], v[116:119], v[60:63]
    s_waitcnt lgkmcnt(5)
    ds_read_b128 v[112:115], v10 offset:49152
    buffer_load_dwordx4 v17, s[20:23], 0 offen offset:1024 lds
    s_add_u32 m0, s79, 0
    v_mfma_f32_16x16x32_bf16 v[52:55], v[240:243], v[116:119], v[52:55]
    s_waitcnt lgkmcnt(5)
    v_rcp_f32 v90, v90
    v_mfma_f32_16x16x32_bf16 v[48:51], v[248:251], v[120:123], v[48:51]
    s_waitcnt lgkmcnt(4)
    ds_read_b128 v[116:119], v10 offset:51200
    buffer_load_dwordx4 v18, s[20:23], 0 offen offset:2048 lds
    v_mfma_f32_16x16x32_bf16 v[56:59], v[252:255], v[120:123], v[56:59]
    s_waitcnt lgkmcnt(4)
    v_rcp_f32 v91, v91
    v_mfma_f32_16x16x32_bf16 v[60:63], v[252:255], v[124:127], v[60:63]
    s_add_u32 m0, s79, 0
    ds_read_b128 v[120:123], v11 offset:49152
    buffer_load_dwordx4 v19, s[20:23], 0 offen offset:3072 lds
    v_mfma_f32_16x16x32_bf16 v[52:55], v[248:251], v[124:127], v[52:55]
    s_add_u32 s20, s20, 40960
    s_addc_u32 s21, s21, 0
    s_sub_u32 s22, s22, 40960
    v_mfma_f32_16x16x32_bf16 v[48:51], a[192:195], v[96:99], v[48:51]
    s_waitcnt lgkmcnt(4)
    ds_read_b128 v[124:127], v11 offset:51200
    v_mul_f32 v34, v34, v90
    v_mfma_f32_16x16x32_bf16 v[56:59], a[196:199], v[96:99], v[56:59]
    s_waitcnt lgkmcnt(4)
    v_mul_f32 v35, v35, v91
    v_cvt_pk_bf16_f32 v144, v32, v33
    v_mfma_f32_16x16x32_bf16 v[60:63], a[196:199], v[100:103], v[60:63]
    s_add_u32 m0, s75, 44416
    ds_read_b128 v[96:99], v10 offset:53248
    buffer_load_dwordx4 v1, s[4:7], 0 offen offset:640 lds
    v_mfma_f32_16x16x32_bf16 v[52:55], a[192:195], v[100:103], v[52:55]
    s_waitcnt lgkmcnt(4)
    v_cvt_pk_bf16_f32 v145, v34, v35
    v_mul_f32 v94, v38, v38
    v_mfma_f32_16x16x32_bf16 v[48:51], a[200:203], v[104:107], v[48:51]
    ds_read_b128 v[100:103], v10 offset:55296
    v_mul_f32 v95, v39, v39
    v_mfma_f32_16x16x32_bf16 v[56:59], a[204:207], v[104:107], v[56:59]
    v_fma_f32 v92, v92, v142, v141
    v_fma_f32 v93, v93, v142, v141
    v_mfma_f32_16x16x32_bf16 v[60:63], a[204:207], v[108:111], v[60:63]
    s_add_u32 m0, s82, 44288
    ds_read_b128 v[104:107], v11 offset:53248
    buffer_load_dwordx4 v1, s[4:7], 0 offen offset:768 lds
    v_mfma_f32_16x16x32_bf16 v[52:55], a[200:203], v[108:111], v[52:55]
    s_waitcnt lgkmcnt(5)
    v_fma_f32 v94, v94, v142, v141
    v_fma_f32 v95, v95, v142, v141
    v_mfma_f32_16x16x32_bf16 v[48:51], a[208:211], v[112:115], v[48:51]
    s_waitcnt lgkmcnt(4)
    ds_read_b128 v[108:111], v11 offset:55296
    v_mul_f32 v92, v92, v36
    v_mfma_f32_16x16x32_bf16 v[56:59], a[212:215], v[112:115], v[56:59]
    s_add_u32 m0, s84, 44160
    v_mul_f32 v93, v93, v37
    v_mul_f32 v94, v94, v38
    v_mfma_f32_16x16x32_bf16 v[60:63], a[212:215], v[116:119], v[60:63]
    s_waitcnt lgkmcnt(4)
    ds_read_b128 v[112:115], v10 offset:57344
    buffer_load_dwordx4 v1, s[4:7], 0 offen offset:896 lds
    v_mfma_f32_16x16x32_bf16 v[52:55], a[208:211], v[116:119], v[52:55]
    v_mul_f32 v95, v95, v39
    v_mul_f32 v36, v36, v44
    v_mfma_f32_16x16x32_bf16 v[48:51], a[216:219], v[120:123], v[48:51]
    s_waitcnt lgkmcnt(4)
    ds_read_b128 v[116:119], v10 offset:59392
    v_mul_f32 v37, v37, v45
    v_mfma_f32_16x16x32_bf16 v[56:59], a[220:223], v[120:123], v[56:59]
    s_add_u32 m0, s85, 44032
    s_waitcnt vmcnt(12)
    ds_read_b64_tr_b16 a[80:81], v12 offset:4096
    ds_read_b64_tr_b16 a[82:83], v12 offset:4608
    ds_read_b64_tr_b16 a[84:85], v13 offset:4096
    buffer_load_dwordx4 v1, s[4:7], 0 offen offset:1024 lds
    ds_read_b64_tr_b16 a[86:87], v13 offset:4608
    ds_read_b64_tr_b16 a[88:89], v14 offset:4096
    ds_read_b64_tr_b16 a[90:91], v14 offset:4608
    ds_read_b64_tr_b16 a[92:93], v15 offset:4096
    ds_read_b64_tr_b16 a[94:95], v15 offset:4608
    v_mfma_f32_16x16x32_bf16 v[60:63], a[220:223], v[124:127], v[60:63]
    s_waitcnt lgkmcnt(11)
    ds_read_b128 v[120:123], v11 offset:57344
    v_mul_f32 v38, v38, v46
    v_mfma_f32_16x16x32_bf16 v[52:55], a[216:219], v[124:127], v[52:55]
    s_add_u32 m0, s90, 43904
    v_exp_f32 v92, v92
    v_mfma_f32_16x16x32_bf16 v[48:51], a[224:227], v[96:99], v[48:51]
    s_waitcnt lgkmcnt(11)
    ds_read_b128 v[124:127], v11 offset:59392
    buffer_load_dwordx4 v1, s[4:7], 0 offen offset:1152 lds
    v_mfma_f32_16x16x32_bf16 v[56:59], a[228:231], v[96:99], v[56:59]
    s_barrier
    v_add_u32 v1, 1280, v1
    v_mfma_f32_16x16x32_bf16 v[60:63], a[228:231], v[100:103], v[60:63]
    s_waitcnt lgkmcnt(11)
    v_exp_f32 v93, v93
    v_mfma_f32_16x16x32_bf16 v[52:55], a[224:227], v[100:103], v[52:55]
    v_exp_f32 v94, v94
    v_mfma_f32_16x16x32_bf16 v[48:51], a[232:235], v[104:107], v[48:51]
    s_waitcnt lgkmcnt(10)
    ds_read_b128 v[96:99], v8 offset:4096
    ds_read_b128 v[100:103], v8 offset:6144
    v_mfma_f32_16x16x32_bf16 v[56:59], a[236:239], v[104:107], v[56:59]
    s_waitcnt lgkmcnt(9)
    v_exp_f32 v95, v95
    v_mfma_f32_16x16x32_bf16 v[60:63], a[236:239], v[108:111], v[60:63]
    s_add_u32 m0, s79, 4096
    ds_read_b128 v[104:107], v9 offset:4096
    v_mul_f32 v39, v39, v47
    v_mfma_f32_16x16x32_bf16 v[52:55], a[232:235], v[108:111], v[52:55]
    s_waitcnt lgkmcnt(5)
    buffer_load_dwordx4 v16, s[20:23], 0 offen offset:0 lds
    v_fma_f32 v92, v92, v143, v143
    v_mfma_f32_16x16x32_bf16 v[48:51], a[240:243], v[112:115], v[48:51]
    s_add_u32 m0, s79, 4096
    ds_read_b128 v[108:111], v9 offset:6144
    buffer_load_dwordx4 v17, s[20:23], 0 offen offset:1024 lds
    v_mfma_f32_16x16x32_bf16 v[56:59], a[244:247], v[112:115], v[56:59]
    s_waitcnt lgkmcnt(5)
    v_fma_f32 v93, v93, v143, v143
    v_fma_f32 v94, v94, v143, v143
    v_mfma_f32_16x16x32_bf16 v[60:63], a[244:247], v[116:119], v[60:63]
    s_waitcnt lgkmcnt(4)
    ds_read_b128 v[112:115], v8 offset:8192
    v_fma_f32 v95, v95, v143, v143
    v_mfma_f32_16x16x32_bf16 v[52:55], a[240:243], v[116:119], v[52:55]
    s_add_u32 m0, s79, 4096
    ds_read_b128 v[140:143], v20 offset:2816
    v_mfma_f32_16x16x32_bf16 v[48:51], a[248:251], v[120:123], v[48:51]
    ds_read_b128 v[116:119], v8 offset:10240
    buffer_load_dwordx4 v18, s[20:23], 0 offen offset:2048 lds
    v_mfma_f32_16x16x32_bf16 v[56:59], a[252:255], v[120:123], v[56:59]
    v_rcp_f32 v92, v92
    v_mfma_f32_16x16x32_bf16 v[60:63], a[252:255], v[124:127], v[60:63]
    s_waitcnt lgkmcnt(5)
    ds_read_b128 v[120:123], v9 offset:8192
    v_mul_f32 v36, v36, v92
    v_mfma_f32_16x16x32_bf16 v[52:55], a[248:251], v[124:127], v[52:55]
    s_add_u32 m0, s79, 4096
    s_barrier
    v_mfma_f32_16x16x32_bf16 v[64:67], v[160:163], v[96:99], 0
    s_waitcnt lgkmcnt(5)
    ds_read_b128 v[124:127], v9 offset:10240
    buffer_load_dwordx4 v19, s[20:23], 0 offen offset:3072 lds
    v_mfma_f32_16x16x32_bf16 v[72:75], v[164:167], v[96:99], 0
    s_add_u32 s20, s20, 40960
    s_addc_u32 s21, s21, 0
    s_sub_u32 s22, s22, 40960
    v_mfma_f32_16x16x32_bf16 v[48:51], v[80:83], v[128:131], v[48:51]
    s_waitcnt lgkmcnt(5)
    ds_read_b128 v[96:99], v8 offset:12288
    s_nop 0
    v_mfma_f32_16x16x32_bf16 v[76:79], v[164:167], v[100:103], 0
    s_nop 0
    v_rcp_f32 v93, v93
    v_mfma_f32_16x16x32_bf16 v[68:71], v[160:163], v[100:103], 0
    s_waitcnt lgkmcnt(5)
    v_rcp_f32 v94, v94
    v_mfma_f32_16x16x32_bf16 v[56:59], v[84:87], v[128:131], v[56:59]
    s_waitcnt lgkmcnt(4)
    ds_read_b128 v[100:103], v8 offset:14336
    v_mul_f32 v37, v37, v93
    v_mfma_f32_16x16x32_bf16 v[52:55], v[80:83], v[132:135], v[52:55]
    s_waitcnt lgkmcnt(4)
    v_rcp_f32 v95, v95
    v_mfma_f32_16x16x32_bf16 v[64:67], v[168:171], v[104:107], v[64:67]
    s_nop 0
    v_mul_f32 v38, v38, v94
    v_mul_f32 v39, v39, v95
    v_mfma_f32_16x16x32_bf16 v[72:75], v[172:175], v[104:107], v[72:75]
    s_waitcnt lgkmcnt(3)
    v_cvt_pk_bf16_f32 v146, v36, v37
    v_cvt_pk_bf16_f32 v147, v38, v39
    v_mfma_f32_16x16x32_bf16 v[60:63], v[84:87], v[132:135], v[60:63]
    s_nop 0
    ds_read_b128 v[104:107], v9 offset:12288
    v_permlane16_swap_b32 v144, v146
    v_mfma_f32_16x16x32_bf16 v[76:79], v[172:175], v[108:111], v[76:79]
    s_waitcnt lgkmcnt(3)
    v_permlane16_swap_b32 v145, v147
    v_mul_f32 v88, v48, v48
    v_mfma_f32_16x16x32_bf16 v[68:71], v[168:171], v[108:111], v[68:71]
    buffer_store_dwordx2 v[156:157], v7, s[8:11], s28 offen sc1
    v_mfma_f32_16x16x32_bf16 v[64:67], v[176:179], v[112:115], v[64:67]
    s_waitcnt lgkmcnt(2)
    ds_read_b128 v[108:111], v9 offset:14336
    v_mul_f32 v89, v49, v49
    v_mfma_f32_16x16x32_bf16 v[72:75], v[180:183], v[112:115], v[72:75]
    buffer_store_dwordx4 v[152:155], v4, s[8:11], s57 offen sc1
    v_mfma_f32_16x16x32_bf16 v[76:79], v[180:183], v[116:119], v[76:79]
    s_add_u32 s57, s81, 491520
    ds_read_b128 v[112:115], v8 offset:16384
    v_mul_f32 v90, v50, v50
    v_mfma_f32_16x16x32_bf16 v[68:71], v[176:179], v[116:119], v[68:71]
    s_waitcnt vmcnt(11)
    ds_read_b64_tr_b16 a[96:97], v12 offset:0
    ds_read_b64_tr_b16 a[98:99], v12 offset:512
    v_mfma_f32_16x16x32_bf16 v[64:67], v[184:187], v[120:123], v[64:67]
    s_waitcnt lgkmcnt(5)
    ds_read_b128 v[116:119], v8 offset:18432
    ds_read_b64_tr_b16 a[100:101], v13 offset:0
    v_mfma_f32_16x16x32_bf16 v[72:75], v[188:191], v[120:123], v[72:75]
    buffer_store_dwordx4 v[144:147], v4, s[8:11], s57 offen sc1
    v_mfma_f32_16x16x32_bf16 v[76:79], v[188:191], v[124:127], v[76:79]
    s_add_u32 s57, s81, 196608
    ds_read_b128 v[120:123], v9 offset:16384
    ds_read_b64_tr_b16 a[102:103], v13 offset:512
    v_mfma_f32_16x16x32_bf16 v[68:71], v[184:187], v[124:127], v[68:71]
    s_waitcnt lgkmcnt(8)
    ds_read_b64_tr_b16 a[104:105], v14 offset:0
    ds_read_b64_tr_b16 a[106:107], v14 offset:512
    v_mfma_f32_16x16x32_bf16 v[64:67], v[192:195], v[96:99], v[64:67]
    ds_read_b128 v[124:127], v9 offset:18432
    ds_read_b64_tr_b16 a[108:109], v15 offset:0
    v_mfma_f32_16x16x32_bf16 v[72:75], v[196:199], v[96:99], v[72:75]
    s_waitcnt lgkmcnt(11)
    ds_read_b64_tr_b16 a[110:111], v15 offset:512
    v_mul_f32 v91, v51, v51
    v_mfma_f32_16x16x32_bf16 v[76:79], v[196:199], v[100:103], v[76:79]
    ds_read_b128 v[96:99], v8 offset:20480
    v_fma_f32 v88, v88, v130, v129
    v_mfma_f32_16x16x32_bf16 v[68:71], v[192:195], v[100:103], v[68:71]
    s_waitcnt lgkmcnt(12)
    v_fma_f32 v89, v89, v130, v129
    v_fma_f32 v90, v90, v130, v129
    v_mfma_f32_16x16x32_bf16 v[64:67], v[200:203], v[104:107], v[64:67]
    s_waitcnt lgkmcnt(10)
    ds_read_b128 v[100:103], v8 offset:22528
    v_fma_f32 v91, v91, v130, v129
    v_mfma_f32_16x16x32_bf16 v[72:75], v[204:207], v[104:107], v[72:75]
    s_waitcnt lgkmcnt(9)
    v_mul_f32 v88, v88, v48
    v_mul_f32 v89, v89, v49
    v_mfma_f32_16x16x32_bf16 v[76:79], v[204:207], v[108:111], v[76:79]
    ds_read_b128 v[104:107], v9 offset:20480
    v_mul_f32 v90, v90, v50
    v_mfma_f32_16x16x32_bf16 v[68:71], v[200:203], v[108:111], v[68:71]
    v_mul_f32 v91, v91, v51
    v_mul_f32 v48, v48, v56
    v_mfma_f32_16x16x32_bf16 v[64:67], v[208:211], v[112:115], v[64:67]
    s_waitcnt lgkmcnt(8)
    ds_read_b128 v[108:111], v9 offset:22528
    v_mul_f32 v49, v49, v57
    v_mfma_f32_16x16x32_bf16 v[72:75], v[212:215], v[112:115], v[72:75]
    s_waitcnt lgkmcnt(7)
    v_exp_f32 v88, v88
    v_mfma_f32_16x16x32_bf16 v[76:79], v[212:215], v[116:119], v[76:79]
    s_waitcnt lgkmcnt(5)
    ds_read_b128 v[112:115], v8 offset:24576
    v_mul_f32 v50, v50, v58
    v_mfma_f32_16x16x32_bf16 v[68:71], v[208:211], v[116:119], v[68:71]
    s_waitcnt lgkmcnt(5)
    v_exp_f32 v89, v89
    v_mfma_f32_16x16x32_bf16 v[64:67], v[216:219], v[120:123], v[64:67]
    s_waitcnt lgkmcnt(4)
    ds_read_b128 v[116:119], v8 offset:26624
    v_mul_f32 v51, v51, v59
    v_mfma_f32_16x16x32_bf16 v[72:75], v[220:223], v[120:123], v[72:75]
    s_add_u32 m0, s70, 86016
    v_exp_f32 v90, v90
    v_mfma_f32_16x16x32_bf16 v[76:79], v[220:223], v[124:127], v[76:79]
    s_waitcnt lgkmcnt(4)
    ds_read_b128 v[120:123], v9 offset:24576
    buffer_load_dwordx4 v1, s[4:7], 0 offen offset:0 lds
    v_mfma_f32_16x16x32_bf16 v[68:71], v[216:219], v[124:127], v[68:71]
    v_exp_f32 v91, v91
    v_mfma_f32_16x16x32_bf16 v[64:67], v[224:227], v[96:99], v[64:67]
    s_waitcnt lgkmcnt(4)
    ds_read_b128 v[124:127], v9 offset:26624
    v_fma_f32 v88, v88, v131, v131
    v_mfma_f32_16x16x32_bf16 v[72:75], v[228:231], v[96:99], v[72:75]
    s_add_u32 m0, s71, 85888
    v_fma_f32 v89, v89, v131, v131
    v_fma_f32 v90, v90, v131, v131
    v_mfma_f32_16x16x32_bf16 v[76:79], v[228:231], v[100:103], v[76:79]
    s_waitcnt lgkmcnt(4)
    ds_read_b128 v[96:99], v8 offset:28672
    buffer_load_dwordx4 v1, s[4:7], 0 offen offset:128 lds
    v_mfma_f32_16x16x32_bf16 v[68:71], v[224:227], v[100:103], v[68:71]
    v_fma_f32 v91, v91, v131, v131
    v_mul_f32 v92, v52, v52
    v_mfma_f32_16x16x32_bf16 v[64:67], v[232:235], v[104:107], v[64:67]
    s_waitcnt lgkmcnt(4)
    ds_read_b128 v[100:103], v8 offset:30720
    ds_read_b128 v[128:131], v20 offset:3072
    v_mfma_f32_16x16x32_bf16 v[72:75], v[236:239], v[104:107], v[72:75]
    s_add_u32 m0, s72, 85760
    v_rcp_f32 v88, v88
    v_mfma_f32_16x16x32_bf16 v[76:79], v[236:239], v[108:111], v[76:79]
    s_waitcnt lgkmcnt(5)
    ds_read_b128 v[104:107], v9 offset:28672
    buffer_load_dwordx4 v1, s[4:7], 0 offen offset:256 lds
    v_mfma_f32_16x16x32_bf16 v[68:71], v[232:235], v[108:111], v[68:71]
    v_rcp_f32 v89, v89
    v_mfma_f32_16x16x32_bf16 v[64:67], v[240:243], v[112:115], v[64:67]
    s_waitcnt lgkmcnt(5)
    ds_read_b128 v[108:111], v9 offset:30720
    v_mul_f32 v48, v48, v88
    v_mfma_f32_16x16x32_bf16 v[72:75], v[244:247], v[112:115], v[72:75]
    s_add_u32 m0, s73, 85632
    v_rcp_f32 v90, v90
    v_mfma_f32_16x16x32_bf16 v[76:79], v[244:247], v[116:119], v[76:79]
    s_waitcnt lgkmcnt(5)
    ds_read_b128 v[112:115], v8 offset:32768
    buffer_load_dwordx4 v1, s[4:7], 0 offen offset:384 lds
    v_mfma_f32_16x16x32_bf16 v[68:71], v[240:243], v[116:119], v[68:71]
L_gbody_h3:
    s_cbranch_execz L_gbody_hr
    v_rcp_f32 v91, v91
    v_mfma_f32_16x16x32_bf16 v[64:67], v[248:251], v[120:123], v[64:67]
    s_waitcnt lgkmcnt(5)
    ds_read_b128 v[116:119], v8 offset:34816
    v_mul_f32 v49, v49, v89
    v_mfma_f32_16x16x32_bf16 v[72:75], v[252:255], v[120:123], v[72:75]
    s_add_u32 m0, s74, 85504
    s_waitcnt vmcnt(7)
    ds_read_b64_tr_b16 a[112:113], v12 offset:4096
    buffer_load_dwordx4 v1, s[4:7], 0 offen offset:512 lds
    v_mfma_f32_16x16x32_bf16 v[76:79], v[252:255], v[124:127], v[76:79]
    s_waitcnt lgkmcnt(5)
    ds_read_b128 v[120:123], v9 offset:32768
    ds_read_b64_tr_b16 a[114:115], v12 offset:4608
    v_mfma_f32_16x16x32_bf16 v[68:71], v[248:251], v[124:127], v[68:71]
    s_waitcnt lgkmcnt(6)
    ds_read_b64_tr_b16 a[116:117], v13 offset:4096
    ds_read_b64_tr_b16 a[118:119], v13 offset:4608
    v_mfma_f32_16x16x32_bf16 v[64:67], a[192:195], v[96:99], v[64:67]
    s_add_u32 m0, s79, 0
    ds_read_b128 v[124:127], v9 offset:34816
    ds_read_b64_tr_b16 a[120:121], v14 offset:4096
    v_mfma_f32_16x16x32_bf16 v[72:75], a[196:199], v[96:99], v[72:75]
    s_waitcnt lgkmcnt(9)
    ds_read_b64_tr_b16 a[122:123], v14 offset:4608
    buffer_load_dwordx4 v16, s[20:23], 0 offen offset:0 lds
    v_mul_f32 v50, v50, v90
    v_mfma_f32_16x16x32_bf16 v[76:79], a[196:199], v[100:103], v[76:79]
    ds_read_b128 v[96:99], v8 offset:36864
    ds_read_b64_tr_b16 a[124:125], v15 offset:4096
    v_mfma_f32_16x16x32_bf16 v[68:71], a[192:195], v[100:103], v[68:71]
    s_waitcnt lgkmcnt(11)
    ds_read_b64_tr_b16 a[126:127], v15 offset:4608
    v_mul_f32 v51, v51, v91
    v_cvt_pk_bf16_f32 v148, v48, v49
    v_cvt_pk_bf16_f32 v149, v50, v51
    v_mfma_f32_16x16x32_bf16 v[64:67], a[200:203], v[104:107], v[64:67]
    s_add_u32 m0, s79, 0
    ds_read_b128 v[100:103], v8 offset:38912
    buffer_load_dwordx4 v17, s[20:23], 0 offen offset:1024 lds
    v_mfma_f32_16x16x32_bf16 v[72:75], a[204:207], v[104:107], v[72:75]
    s_waitcnt lgkmcnt(12)
    v_mul_f32 v93, v53, v53
    v_mul_f32 v94, v54, v54
    v_mfma_f32_16x16x32_bf16 v[76:79], a[204:207], v[108:111], v[76:79]
    s_waitcnt lgkmcnt(11)
    ds_read_b128 v[104:107], v9 offset:36864
    v_mul_f32 v95, v55, v55
    v_mfma_f32_16x16x32_bf16 v[68:71], a[200:203], v[108:111], v[68:71]
    s_add_u32 m0, s79, 0
    v_fma_f32 v92, v92, v134, v133
    v_fma_f32 v93, v93, v134, v133
    v_mfma_f32_16x16x32_bf16 v[64:67], a[208:211], v[112:115], v[64:67]
    s_waitcnt lgkmcnt(8)
    ds_read_b128 v[108:111], v9 offset:38912
    buffer_load_dwordx4 v18, s[20:23], 0 offen offset:2048 lds
    v_mfma_f32_16x16x32_bf16 v[72:75], a[212:215], v[112:115], v[72:75]
    s_waitcnt lgkmcnt(7)
    v_fma_f32 v94, v94, v134, v133
    v_fma_f32 v95, v95, v134, v133
    v_mfma_f32_16x16x32_bf16 v[76:79], a[212:215], v[116:119], v[76:79]
    s_waitcnt lgkmcnt(6)
    ds_read_b128 v[112:115], v8 offset:40960
    v_mul_f32 v92, v92, v52
    v_mfma_f32_16x16x32_bf16 v[68:71], a[208:211], v[116:119], v[68:71]
    s_add_u32 m0, s79, 0
    v_mul_f32 v93, v93, v53
    v_mul_f32 v94, v94, v54
    v_mfma_f32_16x16x32_bf16 v[64:67], a[216:219], v[120:123], v[64:67]
    s_waitcnt lgkmcnt(4)
    ds_read_b128 v[116:119], v8 offset:43008
    buffer_load_dwordx4 v19, s[20:23], 0 offen offset:3072 lds
    v_mfma_f32_16x16x32_bf16 v[72:75], a[220:223], v[120:123], v[72:75]
    s_add_u32 s20, s20, 40960
    s_addc_u32 s21, s21, 0
    s_sub_u32 s22, s22, 40960
    v_mfma_f32_16x16x32_bf16 v[76:79], a[220:223], v[124:127], v[76:79]
    s_waitcnt lgkmcnt(4)
    ds_read_b128 v[120:123], v9 offset:40960
    v_mul_f32 v95, v95, v55
    v_mfma_f32_16x16x32_bf16 v[68:71], a[216:219], v[124:127], v[68:71]
    s_add_u32 m0, s75, 85376
    v_exp_f32 v92, v92
    v_mfma_f32_16x16x32_bf16 v[64:67], a[224:227], v[96:99], v[64:67]
    s_waitcnt lgkmcnt(4)
    ds_read_b128 v[124:127], v9 offset:43008
    buffer_load_dwordx4 v1, s[4:7], 0 offen offset:640 lds
    v_mfma_f32_16x16x32_bf16 v[72:75], a[228:231], v[96:99], v[72:75]
    s_barrier
    v_mul_f32 v52, v52, v60
    v_mfma_f32_16x16x32_bf16 v[76:79], a[228:231], v[100:103], v[76:79]
    s_waitcnt lgkmcnt(4)
    v_exp_f32 v93, v93
    v_mfma_f32_16x16x32_bf16 v[68:71], a[224:227], v[100:103], v[68:71]
    s_add_u32 m0, s82, 85248
    v_mul_f32 v53, v53, v61
    v_mul_f32 v54, v54, v62
    v_mfma_f32_16x16x32_bf16 v[64:67], a[232:235], v[104:107], v[64:67]
    s_waitcnt lgkmcnt(3)
    ds_read_b128 v[96:99], v8 offset:45056
    ds_read_b128 v[100:103], v8 offset:47104
    buffer_load_dwordx4 v1, s[4:7], 0 offen offset:768 lds
    v_mfma_f32_16x16x32_bf16 v[72:75], a[236:239], v[104:107], v[72:75]
    s_mul_i32 s82, s35, 1280
    v_exp_f32 v94, v94
    v_mfma_f32_16x16x32_bf16 v[76:79], a[236:239], v[108:111], v[76:79]
    s_waitcnt lgkmcnt(4)
    ds_read_b128 v[104:107], v9 offset:45056
    v_mul_f32 v55, v55, v63
    v_mfma_f32_16x16x32_bf16 v[68:71], a[232:235], v[108:111], v[68:71]
    s_add_u32 m0, s84, 85120
    v_exp_f32 v95, v95
    v_mfma_f32_16x16x32_bf16 v[64:67], a[240:243], v[112:115], v[64:67]
    s_waitcnt lgkmcnt(4)
    ds_read_b128 v[108:111], v9 offset:47104
    buffer_load_dwordx4 v1, s[4:7], 0 offen offset:896 lds
    v_mfma_f32_16x16x32_bf16 v[72:75], a[244:247], v[112:115], v[72:75]
    s_waitcnt lgkmcnt(4)
    v_fma_f32 v92, v92, v135, v135
    v_fma_f32 v93, v93, v135, v135
    v_mfma_f32_16x16x32_bf16 v[76:79], a[244:247], v[116:119], v[76:79]
    ds_read_b128 v[112:115], v8 offset:49152
    v_fma_f32 v94, v94, v135, v135
    v_mfma_f32_16x16x32_bf16 v[68:71], a[240:243], v[116:119], v[68:71]
    s_add_u32 m0, s85, 84992
    v_fma_f32 v95, v95, v135, v135
    v_mfma_f32_16x16x32_bf16 v[64:67], a[248:251], v[120:123], v[64:67]
    ds_read_b128 v[116:119], v8 offset:51200
    buffer_load_dwordx4 v1, s[4:7], 0 offen offset:1024 lds
    v_mfma_f32_16x16x32_bf16 v[72:75], a[252:255], v[120:123], v[72:75]
    s_waitcnt lgkmcnt(5)
    ds_read_b128 v[132:135], v20 offset:3328
    v_mfma_f32_16x16x32_bf16 v[76:79], a[252:255], v[124:127], v[76:79]
    s_waitcnt lgkmcnt(5)
    ds_read_b128 v[120:123], v9 offset:49152
    v_mfma_f32_16x16x32_bf16 v[68:71], a[248:251], v[124:127], v[68:71]
    s_add_u32 m0, s90, 84864
    v_rcp_f32 v92, v92
    v_mfma_f32_16x16x32_bf16 v[32:35], v[160:163], v[96:99], 0
    s_waitcnt lgkmcnt(5)
    ds_read_b128 v[124:127], v9 offset:51200
    buffer_load_dwordx4 v1, s[4:7], 0 offen offset:1152 lds
    v_mfma_f32_16x16x32_bf16 v[40:43], v[164:167], v[96:99], 0
    v_rcp_f32 v93, v93
    v_mfma_f32_16x16x32_bf16 v[64:67], v[80:83], v[136:139], v[64:67]
    s_waitcnt lgkmcnt(5)
    ds_read_b128 v[96:99], v8 offset:53248
    v_mul_f32 v52, v52, v92
    v_mfma_f32_16x16x32_bf16 v[72:75], v[84:87], v[136:139], v[72:75]
    s_add_u32 m0, s79, 4096
    v_rcp_f32 v94, v94
    v_mfma_f32_16x16x32_bf16 v[44:47], v[164:167], v[100:103], 0
    s_waitcnt lgkmcnt(5)
    v_rcp_f32 v95, v95
    v_mfma_f32_16x16x32_bf16 v[36:39], v[160:163], v[100:103], 0
    buffer_load_dwordx4 v16, s[20:23], 0 offen offset:0 lds
    v_mul_f32 v53, v53, v93
    v_mfma_f32_16x16x32_bf16 v[68:71], v[80:83], v[140:143], v[68:71]
    s_waitcnt lgkmcnt(4)
    ds_read_b128 v[100:103], v8 offset:55296
    v_mul_f32 v54, v54, v94
    v_mfma_f32_16x16x32_bf16 v[76:79], v[84:87], v[140:143], v[76:79]
    s_add_u32 m0, s79, 4096
    v_mul_f32 v55, v55, v95
    v_cvt_pk_bf16_f32 v150, v52, v53
    v_mfma_f32_16x16x32_bf16 v[32:35], v[168:171], v[104:107], v[32:35]
    s_waitcnt lgkmcnt(3)
    v_cvt_pk_bf16_f32 v151, v54, v55
    v_permlane16_swap_b32 v148, v150
    v_mfma_f32_16x16x32_bf16 v[40:43], v[172:175], v[104:107], v[40:43]
    buffer_load_dwordx4 v17, s[20:23], 0 offen offset:1024 lds
    v_permlane16_swap_b32 v149, v151
    v_mfma_f32_16x16x32_bf16 v[44:47], v[172:175], v[108:111], v[44:47]
    s_waitcnt lgkmcnt(2)
    ds_read_b128 v[104:107], v9 offset:53248
    v_mul_f32 v88, v64, v64
    v_mfma_f32_16x16x32_bf16 v[36:39], v[168:171], v[108:111], v[36:39]
    s_add_u32 m0, s79, 4096
    v_mul_f32 v89, v65, v65
    v_mul_f32 v90, v66, v66
    v_mfma_f32_16x16x32_bf16 v[32:35], v[176:179], v[112:115], v[32:35]
    s_waitcnt lgkmcnt(2)
    ds_read_b128 v[108:111], v9 offset:55296
    buffer_load_dwordx4 v18, s[20:23], 0 offen offset:2048 lds
    v_mfma_f32_16x16x32_bf16 v[40:43], v[180:183], v[112:115], v[40:43]
    v_mul_f32 v91, v67, v67
    v_fma_f32 v88, v88, v138, v137
    v_mfma_f32_16x16x32_bf16 v[44:47], v[180:183], v[116:119], v[44:47]
    ds_read_b128 v[112:115], v8 offset:57344
    v_fma_f32 v89, v89, v138, v137
    v_mfma_f32_16x16x32_bf16 v[36:39], v[176:179], v[116:119], v[36:39]
    s_add_u32 m0, s79, 4096
    v_fma_f32 v90, v90, v138, v137
    v_fma_f32 v91, v91, v138, v137
    v_mfma_f32_16x16x32_bf16 v[32:35], v[184:187], v[120:123], v[32:35]
    s_waitcnt lgkmcnt(3)
    ds_read_b128 v[116:119], v8 offset:59392
    buffer_load_dwordx4 v19, s[20:23], 0 offen offset:3072 lds
    v_mfma_f32_16x16x32_bf16 v[40:43], v[188:191], v[120:123], v[40:43]
    s_add_u32 s20, s20, 40960
    s_addc_u32 s21, s21, 0
    s_sub_u32 s22, s22, 40960
    v_mfma_f32_16x16x32_bf16 v[44:47], v[188:191], v[124:127], v[44:47]
    ds_read_b128 v[120:123], v9 offset:57344
    v_mul_f32 v88, v88, v64
    v_mfma_f32_16x16x32_bf16 v[36:39], v[184:187], v[124:127], v[36:39]
    v_mul_f32 v89, v89, v65
    v_mul_f32 v90, v90, v66
    v_mfma_f32_16x16x32_bf16 v[32:35], v[192:195], v[96:99], v[32:35]
    s_waitcnt lgkmcnt(4)
    ds_read_b128 v[124:127], v9 offset:59392
    v_mul_f32 v91, v91, v67
    v_mfma_f32_16x16x32_bf16 v[40:43], v[196:199], v[96:99], v[40:43]
    buffer_load_dwordx2 v[158:159], v25, s[8:11], s28 offen sc1
    v_mfma_f32_16x16x32_bf16 v[44:47], v[196:199], v[100:103], v[44:47]
    s_waitcnt lgkmcnt(4)
    ds_read_b128 v[96:99], v8 offset:61440
    v_mul_f32 v64, v64, v72
    v_mfma_f32_16x16x32_bf16 v[36:39], v[192:195], v[100:103], v[36:39]
    v_exp_f32 v88, v88
    v_mfma_f32_16x16x32_bf16 v[32:35], v[200:203], v[104:107], v[32:35]
    s_waitcnt lgkmcnt(4)
    ds_read_b128 v[100:103], v8 offset:63488
    v_mul_f32 v65, v65, v73
    v_mfma_f32_16x16x32_bf16 v[40:43], v[204:207], v[104:107], v[40:43]
    v_exp_f32 v89, v89
    v_mfma_f32_16x16x32_bf16 v[44:47], v[204:207], v[108:111], v[44:47]
    s_waitcnt lgkmcnt(4)
    ds_read_b128 v[104:107], v9 offset:61440
    v_mul_f32 v66, v66, v74
    v_mfma_f32_16x16x32_bf16 v[36:39], v[200:203], v[108:111], v[36:39]
    v_exp_f32 v90, v90
    v_mfma_f32_16x16x32_bf16 v[32:35], v[208:211], v[112:115], v[32:35]
    s_waitcnt lgkmcnt(4)
    ds_read_b128 v[108:111], v9 offset:63488
    v_mul_f32 v67, v67, v75
    v_mfma_f32_16x16x32_bf16 v[40:43], v[212:215], v[112:115], v[40:43]
    v_exp_f32 v91, v91
    v_mfma_f32_16x16x32_bf16 v[44:47], v[212:215], v[116:119], v[44:47]
    s_waitcnt lgkmcnt(4)
    ds_read_b128 v[112:115], v10 offset:0
    v_fma_f32 v88, v88, v139, v139
    v_mfma_f32_16x16x32_bf16 v[36:39], v[208:211], v[116:119], v[36:39]
    v_fma_f32 v89, v89, v139, v139
    v_fma_f32 v90, v90, v139, v139
    v_mfma_f32_16x16x32_bf16 v[32:35], v[216:219], v[120:123], v[32:35]
    s_waitcnt lgkmcnt(4)
    ds_read_b128 v[116:119], v10 offset:2048
    v_fma_f32 v91, v91, v139, v139
    v_mfma_f32_16x16x32_bf16 v[40:43], v[220:223], v[120:123], v[40:43]
    s_waitcnt vmcnt(19)
    buffer_store_dwordx2 v[156:157], v7, s[8:11], s29 offen sc1
    v_rcp_f32 v88, v88
    v_rcp_f32 v89, v89
    v_rcp_f32 v90, v90
    v_mfma_f32_16x16x32_bf16 v[44:47], v[220:223], v[124:127], v[44:47]
    s_waitcnt vmcnt(11)
    ds_read_b64_tr_b16 a[128:129], v12 offset:0
    ds_read_b128 v[120:123], v11 offset:0
    v_rcp_f32 v91, v91
    v_mfma_f32_16x16x32_bf16 v[36:39], v[216:219], v[124:127], v[36:39]
    s_waitcnt lgkmcnt(5)
    ds_read_b64_tr_b16 a[130:131], v12 offset:512
    ds_read_b64_tr_b16 a[132:133], v13 offset:0
    ds_read_b64_tr_b16 a[134:135], v13 offset:512
    ds_read_b64_tr_b16 a[136:137], v14 offset:0
    v_mfma_f32_16x16x32_bf16 v[32:35], v[224:227], v[96:99], v[32:35]
    s_waitcnt lgkmcnt(8)
    ds_read_b128 v[124:127], v11 offset:2048
    ds_read_b64_tr_b16 a[138:139], v14 offset:512
    v_mfma_f32_16x16x32_bf16 v[40:43], v[228:231], v[96:99], v[40:43]
    s_waitcnt lgkmcnt(9)
    ds_read_b64_tr_b16 a[140:141], v15 offset:0
    ds_read_b64_tr_b16 a[142:143], v15 offset:512
    v_mfma_f32_16x16x32_bf16 v[44:47], v[228:231], v[100:103], v[44:47]
    ds_read_b128 v[96:99], v10 offset:4096
    ds_read_b128 v[136:139], v20 offset:3584
    v_mfma_f32_16x16x32_bf16 v[36:39], v[224:227], v[100:103], v[36:39]
    s_waitcnt lgkmcnt(12)
    v_mul_f32 v64, v64, v88
    v_mul_f32 v65, v65, v89
    v_mfma_f32_16x16x32_bf16 v[32:35], v[232:235], v[104:107], v[32:35]
    ds_read_b128 v[100:103], v10 offset:6144
    v_mul_f32 v66, v66, v90
    v_mfma_f32_16x16x32_bf16 v[40:43], v[236:239], v[104:107], v[40:43]
    v_mul_f32 v67, v67, v91
    v_cvt_pk_bf16_f32 v152, v64, v65
    v_mfma_f32_16x16x32_bf16 v[44:47], v[236:239], v[108:111], v[44:47]
    ds_read_b128 v[104:107], v11 offset:4096
    v_cvt_pk_bf16_f32 v153, v66, v67
    v_mfma_f32_16x16x32_bf16 v[36:39], v[232:235], v[108:111], v[36:39]
    s_waitcnt lgkmcnt(12)
    v_mul_f32 v92, v68, v68
    v_mul_f32 v93, v69, v69
    v_mul_f32 v94, v70, v70
    v_mfma_f32_16x16x32_bf16 v[32:35], v[240:243], v[112:115], v[32:35]
    s_waitcnt lgkmcnt(9)
    ds_read_b128 v[108:111], v11 offset:6144
    v_mul_f32 v95, v71, v71
    v_mfma_f32_16x16x32_bf16 v[40:43], v[244:247], v[112:115], v[40:43]
    s_add_u32 m0, s79, 0
    v_fma_f32 v92, v92, v142, v141
    v_fma_f32 v93, v93, v142, v141
    v_fma_f32 v94, v94, v142, v141
    v_mfma_f32_16x16x32_bf16 v[44:47], v[244:247], v[116:119], v[44:47]
    s_waitcnt lgkmcnt(5)
    buffer_load_dwordx4 v16, s[20:23], 0 offen offset:0 lds
    ds_read_b128 v[112:115], v10 offset:8192
    s_add_u32 m0, s79, 0
    v_mfma_f32_16x16x32_bf16 v[36:39], v[240:243], v[116:119], v[36:39]
    s_waitcnt lgkmcnt(4)
    v_fma_f32 v95, v95, v142, v141
    v_mul_f32 v92, v92, v68
    v_mul_f32 v93, v93, v69
    v_mfma_f32_16x16x32_bf16 v[32:35], v[248:251], v[120:123], v[32:35]
    ds_read_b128 v[116:119], v10 offset:10240
    buffer_load_dwordx4 v17, s[20:23], 0 offen offset:1024 lds
    s_add_u32 m0, s79, 0
    v_mfma_f32_16x16x32_bf16 v[40:43], v[252:255], v[120:123], v[40:43]
    s_waitcnt lgkmcnt(4)
    v_mul_f32 v94, v94, v70
    v_mul_f32 v95, v95, v71
    v_mfma_f32_16x16x32_bf16 v[44:47], v[252:255], v[124:127], v[44:47]
    s_waitcnt lgkmcnt(3)
    ds_read_b128 v[120:123], v11 offset:8192
    buffer_load_dwordx4 v18, s[20:23], 0 offen offset:2048 lds
    s_add_u32 m0, s79, 0
    v_mfma_f32_16x16x32_bf16 v[36:39], v[248:251], v[124:127], v[36:39]
    buffer_load_dwordx4 v19, s[20:23], 0 offen offset:3072 lds
    s_sub_u32 s22, s22, 40960
    s_add_u32 s20, s20, 40960
    s_addc_u32 s21, s21, 0
    v_mfma_f32_16x16x32_bf16 v[32:35], a[192:195], v[96:99], v[32:35]
    s_waitcnt lgkmcnt(3)
    ds_read_b128 v[124:127], v11 offset:10240
    v_mul_f32 v68, v68, v76
    v_mfma_f32_16x16x32_bf16 v[40:43], a[196:199], v[96:99], v[40:43]
    v_exp_f32 v92, v92
    v_mfma_f32_16x16x32_bf16 v[44:47], a[196:199], v[100:103], v[44:47]
    s_waitcnt lgkmcnt(3)
    ds_read_b128 v[96:99], v10 offset:12288
    v_mul_f32 v69, v69, v77
    v_mfma_f32_16x16x32_bf16 v[36:39], a[192:195], v[100:103], v[36:39]
    v_exp_f32 v93, v93
    v_mfma_f32_16x16x32_bf16 v[32:35], a[200:203], v[104:107], v[32:35]
    ds_read_b128 v[100:103], v10 offset:14336
    v_mul_f32 v70, v70, v78
    v_mfma_f32_16x16x32_bf16 v[40:43], a[204:207], v[104:107], v[40:43]
    s_waitcnt lgkmcnt(4)
    v_exp_f32 v94, v94
    v_mfma_f32_16x16x32_bf16 v[44:47], a[204:207], v[108:111], v[44:47]
    ds_read_b128 v[104:107], v11 offset:12288
    v_mul_f32 v71, v71, v79
    v_mfma_f32_16x16x32_bf16 v[36:39], a[200:203], v[108:111], v[36:39]
    s_waitcnt lgkmcnt(4)
    v_exp_f32 v95, v95
    v_mfma_f32_16x16x32_bf16 v[32:35], a[208:211], v[112:115], v[32:35]
    ds_read_b128 v[108:111], v11 offset:14336
    v_fma_f32 v92, v92, v143, v143
    v_mfma_f32_16x16x32_bf16 v[40:43], a[212:215], v[112:115], v[40:43]
    s_waitcnt vmcnt(6)
    ds_read_b64_tr_b16 a[144:145], v12 offset:4096
    ds_read_b64_tr_b16 a[146:147], v12 offset:4608
    ds_read_b64_tr_b16 a[148:149], v13 offset:4096
    ds_read_b64_tr_b16 a[150:151], v13 offset:4608
    ds_read_b64_tr_b16 a[152:153], v14 offset:4096
    ds_read_b64_tr_b16 a[154:155], v14 offset:4608
    ds_read_b64_tr_b16 a[156:157], v15 offset:4096
    ds_read_b64_tr_b16 a[158:159], v15 offset:4608
    v_mfma_f32_16x16x32_bf16 v[44:47], a[212:215], v[116:119], v[44:47]
    s_waitcnt vmcnt(5)
    v_cmp_ne_u64 vcc, s[86:87], v[158:159]
    s_cbranch_vccnz L_slow_hf0
L_back_hf0:
    v_mfma_f32_16x16x32_bf16 v[36:39], a[208:211], v[116:119], v[36:39]
    s_waitcnt lgkmcnt(11)
    ds_read_b128 v[112:115], v10 offset:16384
    v_fma_f32 v93, v93, v143, v143
    v_mfma_f32_16x16x32_bf16 v[32:35], a[216:219], v[120:123], v[32:35]
    s_waitcnt lgkmcnt(11)
    ds_read_b128 v[116:119], v10 offset:18432
    v_fma_f32 v94, v94, v143, v143
    v_mfma_f32_16x16x32_bf16 v[40:43], a[220:223], v[120:123], v[40:43]
    v_fma_f32 v95, v95, v143, v143
    v_add_u32 v8, s56, v29
    v_mfma_f32_16x16x32_bf16 v[44:47], a[220:223], v[124:127], v[44:47]
    s_lshl_b32 s56, s32, 11
    ds_read_b128 v[120:123], v11 offset:16384
    ds_read_b128 v[140:143], v20 offset:3840
    v_mfma_f32_16x16x32_bf16 v[36:39], a[216:219], v[124:127], v[36:39]
    s_add_u32 s56, s56, 4096
    v_rcp_f32 v92, v92
    v_mfma_f32_16x16x32_bf16 v[32:35], a[224:227], v[96:99], v[32:35]
    s_waitcnt lgkmcnt(12)
    ds_read_b128 v[124:127], v11 offset:18432
    v_mul_f32 v68, v68, v92
    v_mfma_f32_16x16x32_bf16 v[40:43], a[228:231], v[96:99], v[40:43]
    s_add_u32 m0, s79, 4096
    s_barrier
    v_mfma_f32_16x16x32_bf16 v[44:47], a[228:231], v[100:103], v[44:47]
    s_waitcnt lgkmcnt(5)
    buffer_load_dwordx4 v16, s[20:23], 0 offen offset:0 lds
    s_add_u32 m0, s79, 4096
    v_mfma_f32_16x16x32_bf16 v[36:39], a[224:227], v[100:103], v[36:39]
    buffer_load_dwordx4 v17, s[20:23], 0 offen offset:1024 lds
    s_add_u32 m0, s79, 4096
    v_mfma_f32_16x16x32_bf16 v[32:35], a[232:235], v[104:107], v[32:35]
    ds_read_b128 v[96:99], v10 offset:20480
    ds_read_b128 v[100:103], v10 offset:22528
    buffer_load_dwordx4 v18, s[20:23], 0 offen offset:2048 lds
    s_add_u32 m0, s79, 4096
    v_mfma_f32_16x16x32_bf16 v[40:43], a[236:239], v[104:107], v[40:43]
    s_waitcnt lgkmcnt(5)
    v_rcp_f32 v93, v93
    v_mfma_f32_16x16x32_bf16 v[44:47], a[236:239], v[108:111], v[44:47]
    ds_read_b128 v[104:107], v11 offset:20480
    buffer_load_dwordx4 v19, s[20:23], 0 offen offset:3072 lds
    v_mfma_f32_16x16x32_bf16 v[36:39], a[232:235], v[108:111], v[36:39]
    s_waitcnt lgkmcnt(4)
    v_rcp_f32 v94, v94
    v_mfma_f32_16x16x32_bf16 v[32:35], a[240:243], v[112:115], v[32:35]
    ds_read_b128 v[108:111], v11 offset:22528
    v_mul_f32 v69, v69, v93
    v_mfma_f32_16x16x32_bf16 v[40:43], a[244:247], v[112:115], v[40:43]
    s_waitcnt lgkmcnt(4)
    v_rcp_f32 v95, v95
    v_mfma_f32_16x16x32_bf16 v[44:47], a[244:247], v[116:119], v[44:47]
    ds_read_b128 v[112:115], v10 offset:24576
    v_mul_f32 v70, v70, v94
    v_mfma_f32_16x16x32_bf16 v[36:39], a[240:243], v[116:119], v[36:39]
    buffer_store_dwordx4 v[148:151], v4, s[8:11], s57 offen sc1
    v_mfma_f32_16x16x32_bf16 v[32:35], a[248:251], v[120:123], v[32:35]
    s_add_u32 s57, s81, 589824
    ds_read_b128 v[116:119], v10 offset:26624
    v_mul_f32 v71, v71, v95
    v_mfma_f32_16x16x32_bf16 v[40:43], a[252:255], v[120:123], v[40:43]
    s_waitcnt lgkmcnt(4)
    v_cvt_pk_bf16_f32 v154, v68, v69
    v_cvt_pk_bf16_f32 v155, v70, v71
    v_mfma_f32_16x16x32_bf16 v[44:47], a[252:255], v[124:127], v[44:47]
    s_nop 0
    ds_read_b128 v[120:123], v11 offset:24576
    v_permlane16_swap_b32 v152, v154
    v_mfma_f32_16x16x32_bf16 v[36:39], a[248:251], v[124:127], v[36:39]
    s_waitcnt lgkmcnt(4)
    v_permlane16_swap_b32 v153, v155
    v_xor_b32 v9, 64, v8
    v_mfma_f32_16x16x32_bf16 v[48:51], v[160:163], v[96:99], 0
    ds_read_b128 v[124:127], v11 offset:26624
    v_lshlrev_b32 v29, 1, v28
    v_mfma_f32_16x16x32_bf16 v[56:59], v[164:167], v[96:99], 0
    s_waitcnt lgkmcnt(4)
    v_xor_b32 v29, v29, v26
    v_lshlrev_b32 v29, 4, v29
    v_mfma_f32_16x16x32_bf16 v[32:35], v[80:83], v[128:131], v[32:35]
    s_nop 0
    ds_read_b128 v[96:99], v10 offset:28672
    v_lshl_add_u32 v29, v26, 8, v29
    v_mfma_f32_16x16x32_bf16 v[60:63], v[164:167], v[100:103], 0
    s_waitcnt lgkmcnt(4)
    s_nop 1
    v_mfma_f32_16x16x32_bf16 v[52:55], v[160:163], v[100:103], 0
    buffer_store_dwordx4 v[152:155], v4, s[8:11], s57 offen sc1
    v_mfma_f32_16x16x32_bf16 v[40:43], v[84:87], v[128:131], v[40:43]
    s_add_u32 s57, s81, 294912
    ds_read_b128 v[100:103], v10 offset:30720
    v_mul_f32 v88, v32, v32
    v_mfma_f32_16x16x32_bf16 v[36:39], v[80:83], v[132:135], v[36:39]
    s_waitcnt lgkmcnt(4)
    v_mul_f32 v89, v33, v33
    v_mul_f32 v90, v34, v34
    v_mfma_f32_16x16x32_bf16 v[48:51], v[168:171], v[104:107], v[48:51]
    s_waitcnt lgkmcnt(3)
    v_mul_f32 v91, v35, v35
    v_fma_f32 v88, v88, v130, v129
    v_mfma_f32_16x16x32_bf16 v[56:59], v[172:175], v[104:107], v[56:59]
    v_fma_f32 v89, v89, v130, v129
    v_fma_f32 v90, v90, v130, v129
    v_mfma_f32_16x16x32_bf16 v[44:47], v[84:87], v[132:135], v[44:47]
    s_waitcnt lgkmcnt(2)
    ds_read_b128 v[104:107], v11 offset:28672
    v_fma_f32 v91, v91, v130, v129
    v_mfma_f32_16x16x32_bf16 v[60:63], v[172:175], v[108:111], v[60:63]
    v_mul_f32 v88, v88, v32
    v_mul_f32 v89, v89, v33
    v_mfma_f32_16x16x32_bf16 v[52:55], v[168:171], v[108:111], v[52:55]
    s_waitcnt lgkmcnt(2)
    v_mul_f32 v90, v90, v34
    v_mul_f32 v91, v91, v35
    v_mfma_f32_16x16x32_bf16 v[48:51], v[176:179], v[112:115], v[48:51]
    ds_read_b128 v[108:111], v11 offset:30720
    buffer_load_dwordx4 v[160:163], v2, s[12:15], 0 offen offset:0 sc1
    v_mfma_f32_16x16x32_bf16 v[56:59], v[180:183], v[112:115], v[56:59]
    v_exp_f32 v88, v88
    v_mfma_f32_16x16x32_bf16 v[60:63], v[180:183], v[116:119], v[60:63]
    ds_read_b128 v[112:115], v10 offset:32768
    v_mul_f32 v32, v32, v40
    v_mfma_f32_16x16x32_bf16 v[52:55], v[176:179], v[116:119], v[52:55]
    s_waitcnt lgkmcnt(3)
    v_exp_f32 v89, v89
    v_mfma_f32_16x16x32_bf16 v[48:51], v[184:187], v[120:123], v[48:51]
    ds_read_b128 v[116:119], v10 offset:34816
    buffer_load_dwordx4 v[164:167], v2, s[12:15], 0 offen offset:256 sc1
    v_mfma_f32_16x16x32_bf16 v[56:59], v[188:191], v[120:123], v[56:59]
    v_mul_f32 v33, v33, v41
    v_mul_f32 v34, v34, v42
    v_mfma_f32_16x16x32_bf16 v[60:63], v[188:191], v[124:127], v[60:63]
    ds_read_b128 v[120:123], v11 offset:32768
    v_mul_f32 v35, v35, v43
    v_mfma_f32_16x16x32_bf16 v[52:55], v[184:187], v[124:127], v[52:55]
    s_waitcnt lgkmcnt(4)
    v_exp_f32 v90, v90
    v_mfma_f32_16x16x32_bf16 v[48:51], v[192:195], v[96:99], v[48:51]
    ds_read_b128 v[124:127], v11 offset:34816
    buffer_load_dwordx4 v[168:171], v2, s[12:15], 0 offen offset:2048 sc1
    v_mfma_f32_16x16x32_bf16 v[56:59], v[196:199], v[96:99], v[56:59]
    v_exp_f32 v91, v91
    v_mfma_f32_16x16x32_bf16 v[60:63], v[196:199], v[100:103], v[60:63]
    s_waitcnt lgkmcnt(4)
    ds_read_b128 v[96:99], v10 offset:36864
    v_fma_f32 v88, v88, v131, v131
    v_mfma_f32_16x16x32_bf16 v[52:55], v[192:195], v[100:103], v[52:55]
    v_fma_f32 v89, v89, v131, v131
    v_fma_f32 v90, v90, v131, v131
    v_mfma_f32_16x16x32_bf16 v[48:51], v[200:203], v[104:107], v[48:51]
    s_waitcnt lgkmcnt(4)
    ds_read_b128 v[100:103], v10 offset:38912
    v_fma_f32 v91, v91, v131, v131
    v_mfma_f32_16x16x32_bf16 v[56:59], v[204:207], v[104:107], v[56:59]
    buffer_load_dwordx4 v[172:175], v2, s[12:15], 0 offen offset:2304 sc1
    s_sub_u32 s14, s14, 4096
    v_mfma_f32_16x16x32_bf16 v[60:63], v[204:207], v[108:111], v[60:63]
    s_add_u32 s12, s12, 4096
    s_addc_u32 s13, s13, 0
    ds_read_b128 v[104:107], v11 offset:36864
    v_mfma_f32_16x16x32_bf16 v[52:55], v[200:203], v[108:111], v[52:55]
    s_waitcnt lgkmcnt(5)
    v_rcp_f32 v88, v88
    v_mfma_f32_16x16x32_bf16 v[48:51], v[208:211], v[112:115], v[48:51]
    s_waitcnt lgkmcnt(4)
    ds_read_b128 v[108:111], v11 offset:38912
    v_mul_f32 v32, v32, v88
    v_mfma_f32_16x16x32_bf16 v[56:59], v[212:215], v[112:115], v[56:59]
    buffer_load_dwordx4 v[176:179], v2, s[12:15], 0 offen offset:0 sc1
    v_mul_f32 v92, v36, v36
    v_mfma_f32_16x16x32_bf16 v[60:63], v[212:215], v[116:119], v[60:63]
    s_waitcnt lgkmcnt(4)
    ds_read_b128 v[112:115], v10 offset:40960
    v_mul_f32 v93, v37, v37
    v_mfma_f32_16x16x32_bf16 v[52:55], v[208:211], v[116:119], v[52:55]
    v_rcp_f32 v89, v89
    v_mfma_f32_16x16x32_bf16 v[48:51], v[216:219], v[120:123], v[48:51]
    s_waitcnt lgkmcnt(4)
    ds_read_b128 v[116:119], v10 offset:43008
    v_mul_f32 v33, v33, v89
    v_mfma_f32_16x16x32_bf16 v[56:59], v[220:223], v[120:123], v[56:59]
    buffer_load_dwordx4 v[180:183], v2, s[12:15], 0 offen offset:256 sc1
    v_cvt_pk_bf16_f32 v144, v32, v33
    v_mfma_f32_16x16x32_bf16 v[60:63], v[220:223], v[124:127], v[60:63]
    s_waitcnt lgkmcnt(4)
    ds_read_b128 v[120:123], v11 offset:40960
    v_mul_f32 v94, v38, v38
    v_mfma_f32_16x16x32_bf16 v[52:55], v[216:219], v[124:127], v[52:55]
    v_rcp_f32 v90, v90
    v_mfma_f32_16x16x32_bf16 v[48:51], v[224:227], v[96:99], v[48:51]
    s_waitcnt lgkmcnt(4)
    ds_read_b128 v[124:127], v11 offset:43008
    v_mul_f32 v34, v34, v90
    v_mfma_f32_16x16x32_bf16 v[56:59], v[228:231], v[96:99], v[56:59]
    v_rcp_f32 v91, v91
    v_mfma_f32_16x16x32_bf16 v[60:63], v[228:231], v[100:103], v[60:63]
    s_waitcnt lgkmcnt(4)
    ds_read_b128 v[96:99], v10 offset:45056
    buffer_load_dwordx4 v[184:187], v2, s[12:15], 0 offen offset:2048 sc1
    v_mfma_f32_16x16x32_bf16 v[52:55], v[224:227], v[100:103], v[52:55]
    v_mul_f32 v35, v35, v91
    v_cvt_pk_bf16_f32 v145, v34, v35
    v_mfma_f32_16x16x32_bf16 v[48:51], v[232:235], v[104:107], v[48:51]
    s_waitcnt lgkmcnt(4)
    ds_read_b128 v[100:103], v10 offset:47104
    v_mul_f32 v95, v39, v39
    v_mfma_f32_16x16x32_bf16 v[56:59], v[236:239], v[104:107], v[56:59]
    v_fma_f32 v92, v92, v134, v133
    v_fma_f32 v93, v93, v134, v133
    v_mfma_f32_16x16x32_bf16 v[60:63], v[236:239], v[108:111], v[60:63]
    s_waitcnt lgkmcnt(4)
    ds_read_b128 v[104:107], v11 offset:45056
    buffer_load_dwordx4 v[188:191], v2, s[12:15], 0 offen offset:2304 sc1
    s_add_u32 s12, s12, 4096
    s_addc_u32 s13, s13, 0
    s_sub_u32 s14, s14, 4096
    v_mfma_f32_16x16x32_bf16 v[52:55], v[232:235], v[108:111], v[52:55]
    s_waitcnt lgkmcnt(4)
    v_fma_f32 v94, v94, v134, v133
    v_fma_f32 v95, v95, v134, v133
    v_mfma_f32_16x16x32_bf16 v[48:51], v[240:243], v[112:115], v[48:51]
    ds_read_b128 v[108:111], v11 offset:47104
    v_mul_f32 v92, v92, v36
    v_mfma_f32_16x16x32_bf16 v[56:59], v[244:247], v[112:115], v[56:59]
    s_waitcnt lgkmcnt(4)
    v_mul_f32 v93, v93, v37
    v_mul_f32 v94, v94, v38
    v_mfma_f32_16x16x32_bf16 v[60:63], v[244:247], v[116:119], v[60:63]
    ds_read_b128 v[112:115], v10 offset:49152
    buffer_load_dwordx4 v[192:195], v2, s[12:15], 0 offen offset:0 sc1
    v_mfma_f32_16x16x32_bf16 v[52:55], v[240:243], v[116:119], v[52:55]
    s_waitcnt lgkmcnt(4)
    v_mul_f32 v95, v95, v39
    v_mul_f32 v36, v36, v44
    v_mfma_f32_16x16x32_bf16 v[48:51], v[248:251], v[120:123], v[48:51]
    ds_read_b128 v[116:119], v10 offset:51200
    v_mul_f32 v37, v37, v45
    v_mfma_f32_16x16x32_bf16 v[56:59], v[252:255], v[120:123], v[56:59]
    s_waitcnt lgkmcnt(4)
    v_exp_f32 v92, v92
    v_mfma_f32_16x16x32_bf16 v[60:63], v[252:255], v[124:127], v[60:63]
    ds_read_b128 v[120:123], v11 offset:49152
    buffer_load_dwordx4 v[196:199], v2, s[12:15], 0 offen offset:256 sc1
    v_mfma_f32_16x16x32_bf16 v[52:55], v[248:251], v[124:127], v[52:55]
    s_waitcnt lgkmcnt(4)
    v_exp_f32 v93, v93
    v_mfma_f32_16x16x32_bf16 v[48:51], a[192:195], v[96:99], v[48:51]
    ds_read_b128 v[124:127], v11 offset:51200
    v_mul_f32 v38, v38, v46
    v_mfma_f32_16x16x32_bf16 v[56:59], a[196:199], v[96:99], v[56:59]
L_gbody_h4:
    s_cbranch_execz L_gbody_hr
    v_exp_f32 v94, v94
    v_mfma_f32_16x16x32_bf16 v[60:63], a[196:199], v[100:103], v[60:63]
    s_waitcnt lgkmcnt(4)
    ds_read_b128 v[96:99], v10 offset:53248
    buffer_load_dwordx4 v[200:203], v2, s[12:15], 0 offen offset:2048 sc1
    v_mfma_f32_16x16x32_bf16 v[52:55], a[192:195], v[100:103], v[52:55]
    v_exp_f32 v95, v95
    v_mfma_f32_16x16x32_bf16 v[48:51], a[200:203], v[104:107], v[48:51]
    s_waitcnt vmcnt(17)
    ds_read_b64_tr_b16 a[192:193], v12 offset:0
    ds_read_b128 v[100:103], v10 offset:55296
    v_mfma_f32_16x16x32_bf16 v[56:59], a[204:207], v[104:107], v[56:59]
    s_waitcnt lgkmcnt(6)
    ds_read_b64_tr_b16 a[194:195], v12 offset:512
    ds_read_b64_tr_b16 a[196:197], v13 offset:0
    v_mfma_f32_16x16x32_bf16 v[60:63], a[204:207], v[108:111], v[60:63]
    s_waitcnt lgkmcnt(7)
    ds_read_b128 v[104:107], v11 offset:53248
    ds_read_b64_tr_b16 a[198:199], v13 offset:512
    buffer_load_dwordx2 v[158:159], v25, s[8:11], s29 offen sc1
    v_mfma_f32_16x16x32_bf16 v[52:55], a[200:203], v[108:111], v[52:55]
    s_waitcnt lgkmcnt(8)
    v_mul_f32 v39, v39, v47
    v_fma_f32 v92, v92, v135, v135
    v_mfma_f32_16x16x32_bf16 v[48:51], a[208:211], v[112:115], v[48:51]
    ds_read_b128 v[108:111], v11 offset:55296
    ds_read_b64_tr_b16 a[200:201], v14 offset:0
    v_mfma_f32_16x16x32_bf16 v[56:59], a[212:215], v[112:115], v[56:59]
    s_waitcnt lgkmcnt(9)
    ds_read_b64_tr_b16 a[202:203], v14 offset:512
    ds_read_b64_tr_b16 a[204:205], v15 offset:0
    v_mfma_f32_16x16x32_bf16 v[60:63], a[212:215], v[116:119], v[60:63]
    ds_read_b128 v[112:115], v10 offset:57344
    ds_read_b64_tr_b16 a[206:207], v15 offset:512
    v_mfma_f32_16x16x32_bf16 v[52:55], a[208:211], v[116:119], v[52:55]
    s_waitcnt lgkmcnt(12)
    v_fma_f32 v93, v93, v135, v135
    v_fma_f32 v94, v94, v135, v135
    v_mfma_f32_16x16x32_bf16 v[48:51], a[216:219], v[120:123], v[48:51]
    s_waitcnt vmcnt(14)
    ds_read_b64_tr_b16 a[208:209], v12 offset:4096
    ds_read_b128 v[116:119], v10 offset:59392
    buffer_load_dwordx4 v[204:207], v2, s[12:15], 0 offen offset:2304 sc1
    s_add_u32 s12, s12, 4096
    s_addc_u32 s13, s13, 0
    s_sub_u32 s14, s14, 4096
    v_mfma_f32_16x16x32_bf16 v[56:59], a[220:223], v[120:123], v[56:59]
    s_waitcnt lgkmcnt(10)
    ds_read_b64_tr_b16 a[210:211], v12 offset:4608
    ds_read_b64_tr_b16 a[212:213], v13 offset:4096
    v_mfma_f32_16x16x32_bf16 v[60:63], a[220:223], v[124:127], v[60:63]
    s_waitcnt lgkmcnt(10)
    ds_read_b128 v[120:123], v11 offset:57344
    ds_read_b64_tr_b16 a[214:215], v13 offset:4608
    v_mfma_f32_16x16x32_bf16 v[52:55], a[216:219], v[124:127], v[52:55]
    v_fma_f32 v95, v95, v135, v135
    v_add_u32 v10, s56, v29
    v_mfma_f32_16x16x32_bf16 v[48:51], a[224:227], v[96:99], v[48:51]
    s_sub_u32 s56, 102400, s79
    ds_read_b128 v[124:127], v11 offset:59392
    buffer_load_dwordx4 v[208:211], v2, s[12:15], 0 offen offset:0 sc1
    v_mfma_f32_16x16x32_bf16 v[56:59], a[228:231], v[96:99], v[56:59]
    s_waitcnt lgkmcnt(11)
    ds_read_b64_tr_b16 a[216:217], v14 offset:4096
    ds_read_b64_tr_b16 a[218:219], v14 offset:4608
    v_mfma_f32_16x16x32_bf16 v[60:63], a[228:231], v[100:103], v[60:63]
    s_waitcnt lgkmcnt(11)
    ds_read_b64_tr_b16 a[220:221], v15 offset:4096
    ds_read_b64_tr_b16 a[222:223], v15 offset:4608
    v_mfma_f32_16x16x32_bf16 v[52:55], a[224:227], v[100:103], v[52:55]
    s_waitcnt lgkmcnt(11)
    v_rcp_f32 v92, v92
    v_mfma_f32_16x16x32_bf16 v[48:51], a[232:235], v[104:107], v[48:51]
    buffer_load_dwordx4 v[212:215], v2, s[12:15], 0 offen offset:256 sc1
    v_mul_f32 v36, v36, v92
    v_mfma_f32_16x16x32_bf16 v[56:59], a[236:239], v[104:107], v[56:59]
    s_waitcnt lgkmcnt(9)
    v_rcp_f32 v93, v93
    v_mfma_f32_16x16x32_bf16 v[60:63], a[236:239], v[108:111], v[60:63]
    v_rcp_f32 v94, v94
    v_mfma_f32_16x16x32_bf16 v[52:55], a[232:235], v[108:111], v[52:55]
    s_waitcnt lgkmcnt(7)
    v_rcp_f32 v95, v95
    v_mfma_f32_16x16x32_bf16 v[48:51], a[240:243], v[112:115], v[48:51]
    s_waitcnt lgkmcnt(5)
    v_mul_f32 v37, v37, v93
    v_mul_f32 v38, v38, v94
    v_mfma_f32_16x16x32_bf16 v[56:59], a[244:247], v[112:115], v[56:59]
    buffer_load_dwordx4 v[216:219], v2, s[12:15], 0 offen offset:2048 sc1
    v_mul_f32 v39, v39, v95
    v_mfma_f32_16x16x32_bf16 v[60:63], a[244:247], v[116:119], v[60:63]
    s_waitcnt lgkmcnt(4)
    v_cvt_pk_bf16_f32 v146, v36, v37
    v_cvt_pk_bf16_f32 v147, v38, v39
    v_mfma_f32_16x16x32_bf16 v[52:55], a[240:243], v[116:119], v[52:55]
    s_waitcnt lgkmcnt(2)
    v_permlane16_swap_b32 v144, v146
    v_permlane16_swap_b32 v145, v147
    v_mfma_f32_16x16x32_bf16 v[48:51], a[248:251], v[120:123], v[48:51]
    s_waitcnt lgkmcnt(0)
    v_xor_b32 v11, 16, v10
    v_mul_u32_u24 v29, 20480, v26
    v_mfma_f32_16x16x32_bf16 v[56:59], a[252:255], v[120:123], v[56:59]
    v_lshl_add_u32 v3, v28, 4, v29
    v_and_b32 v29, 2, v26
    v_mfma_f32_16x16x32_bf16 v[60:63], a[252:255], v[124:127], v[60:63]
    v_xor_b32 v29, v29, v28
    v_lshlrev_b32 v29, 4, v29
    v_mfma_f32_16x16x32_bf16 v[52:55], a[248:251], v[124:127], v[52:55]
    v_and_b32 v26, 1, v26
    v_mul_u32_u24 v26, 1280, v26
    v_mfma_f32_16x16x32_bf16 v[48:51], v[80:83], v[136:139], v[48:51]
    s_nop 0
    v_add3_u32 v5, v26, v27, v29
    v_xor_b32 v6, 64, v5
    v_mfma_f32_16x16x32_bf16 v[56:59], v[84:87], v[136:139], v[56:59]
    s_nop 0
    v_add_u32 v16, s56, v12
    v_add_u32 v17, s56, v13
    v_mfma_f32_16x16x32_bf16 v[52:55], v[80:83], v[140:143], v[52:55]
    s_nop 0
    v_mul_f32 v88, v48, v48
    v_mul_f32 v89, v49, v49
    v_mfma_f32_16x16x32_bf16 v[60:63], v[84:87], v[140:143], v[60:63]
    s_nop 0
    v_mul_f32 v90, v50, v50
    v_mul_f32 v91, v51, v51
    v_fma_f32 v88, v88, v138, v137
    v_fma_f32 v89, v89, v138, v137
    v_fma_f32 v90, v90, v138, v137
    v_fma_f32 v91, v91, v138, v137
    v_mul_f32 v88, v88, v48
    v_mul_f32 v89, v89, v49
    v_mul_f32 v90, v90, v50
    v_mul_f32 v91, v91, v51
    v_exp_f32 v88, v88
    v_mul_f32 v48, v48, v56
    v_exp_f32 v89, v89
    v_mul_f32 v49, v49, v57
    v_exp_f32 v90, v90
    v_mul_f32 v50, v50, v58
    v_exp_f32 v91, v91
    v_mul_f32 v51, v51, v59
    v_fma_f32 v88, v88, v139, v139
    v_fma_f32 v89, v89, v139, v139
    s_waitcnt vmcnt(15)
    v_mfma_f32_16x16x32_bf16 v[32:35], a[0:3], v[160:163], 0
    s_waitcnt vmcnt(14)
    v_fma_f32 v90, v90, v139, v139
    v_fma_f32 v91, v91, v139, v139
    v_mfma_f32_16x16x32_bf16 v[36:39], a[4:7], v[160:163], 0
    s_waitcnt vmcnt(13)
    v_rcp_f32 v88, v88
    v_mfma_f32_16x16x32_bf16 v[40:43], a[8:11], v[160:163], 0
    buffer_store_dwordx2 v[156:157], v7, s[8:11], s80 offen sc1
    buffer_load_dwordx4 v[220:223], v2, s[12:15], 0 offen offset:2304 sc1
    s_add_u32 s12, s12, 4096
    s_addc_u32 s13, s13, 0
    s_sub_u32 s14, s14, 4096
    v_mfma_f32_16x16x32_bf16 v[44:47], a[12:15], v[160:163], 0
    buffer_load_dwordx4 v[224:227], v2, s[12:15], 0 offen offset:0 sc1
    v_mul_f32 v48, v48, v88
    v_mfma_f32_16x16x32_bf16 v[76:79], a[12:15], v[164:167], 0
    s_waitcnt vmcnt(15)
    v_rcp_f32 v89, v89
    v_mfma_f32_16x16x32_bf16 v[72:75], a[8:11], v[164:167], 0
    buffer_load_dwordx4 v[228:231], v2, s[12:15], 0 offen offset:256 sc1
    v_mul_f32 v49, v49, v89
    v_mfma_f32_16x16x32_bf16 v[68:71], a[4:7], v[164:167], 0
    v_rcp_f32 v90, v90
    v_mfma_f32_16x16x32_bf16 v[64:67], a[0:3], v[164:167], 0
    v_rcp_f32 v91, v91
    v_mfma_f32_16x16x32_bf16 v[32:35], a[16:19], v[168:171], v[32:35]
    s_waitcnt vmcnt(15)
    v_mul_f32 v50, v50, v90
    v_mul_f32 v51, v51, v91
    v_mfma_f32_16x16x32_bf16 v[36:39], a[20:23], v[168:171], v[36:39]
    buffer_load_dwordx4 v[232:235], v2, s[12:15], 0 offen offset:2048 sc1
    v_cvt_pk_bf16_f32 v148, v48, v49
    v_mfma_f32_16x16x32_bf16 v[40:43], a[24:27], v[168:171], v[40:43]
    v_cvt_pk_bf16_f32 v149, v50, v51
    v_mul_f32 v92, v52, v52
    v_mfma_f32_16x16x32_bf16 v[44:47], a[28:31], v[168:171], v[44:47]
    v_mul_f32 v93, v53, v53
    v_mul_f32 v94, v54, v54
    v_mfma_f32_16x16x32_bf16 v[76:79], a[28:31], v[172:175], v[76:79]
    s_waitcnt vmcnt(15)
    v_mul_f32 v95, v55, v55
    v_fma_f32 v92, v92, v142, v141
    v_mfma_f32_16x16x32_bf16 v[72:75], a[24:27], v[172:175], v[72:75]
    buffer_load_dwordx4 v[236:239], v2, s[12:15], 0 offen offset:2304 sc1
    s_sub_u32 s14, s14, 4096
    s_add_u32 s12, s12, 4096
    s_addc_u32 s13, s13, 0
    v_mfma_f32_16x16x32_bf16 v[68:71], a[20:23], v[172:175], v[68:71]
    v_fma_f32 v93, v93, v142, v141
    v_fma_f32 v94, v94, v142, v141
    v_mfma_f32_16x16x32_bf16 v[64:67], a[16:19], v[172:175], v[64:67]
    v_fma_f32 v95, v95, v142, v141
    v_mul_f32 v92, v92, v52
    v_mfma_f32_16x16x32_bf16 v[32:35], a[32:35], v[176:179], v[32:35]
    s_waitcnt vmcnt(15)
    v_mul_f32 v93, v93, v53
    v_mul_f32 v94, v94, v54
    v_mfma_f32_16x16x32_bf16 v[36:39], a[36:39], v[176:179], v[36:39]
    buffer_load_dwordx4 v[240:243], v2, s[12:15], 0 offen offset:0 sc1
    v_mul_f32 v95, v95, v55
    v_mfma_f32_16x16x32_bf16 v[40:43], a[40:43], v[176:179], v[40:43]
    v_exp_f32 v92, v92
    v_mfma_f32_16x16x32_bf16 v[44:47], a[44:47], v[176:179], v[44:47]
    v_mul_f32 v52, v52, v60
    v_mul_f32 v53, v53, v61
    v_mfma_f32_16x16x32_bf16 v[76:79], a[44:47], v[180:183], v[76:79]
    s_waitcnt vmcnt(15)
    v_exp_f32 v93, v93
    v_mfma_f32_16x16x32_bf16 v[72:75], a[40:43], v[180:183], v[72:75]
    buffer_load_dwordx4 v[244:247], v2, s[12:15], 0 offen offset:256 sc1
    v_mul_f32 v54, v54, v62
    v_mfma_f32_16x16x32_bf16 v[68:71], a[36:39], v[180:183], v[68:71]
    v_exp_f32 v94, v94
    v_mfma_f32_16x16x32_bf16 v[64:67], a[32:35], v[180:183], v[64:67]
    v_exp_f32 v95, v95
    v_mul_f32 v55, v55, v63
    v_fma_f32 v92, v92, v143, v143
    v_fma_f32 v93, v93, v143, v143
    v_fma_f32 v94, v94, v143, v143
    v_fma_f32 v95, v95, v143, v143
    v_mfma_f32_16x16x32_bf16 v[32:35], a[48:51], v[184:187], v[32:35]
    s_waitcnt vmcnt(15)
    v_rcp_f32 v92, v92
    v_mfma_f32_16x16x32_bf16 v[36:39], a[52:55], v[184:187], v[36:39]
    buffer_load_dwordx4 v[248:251], v2, s[12:15], 0 offen offset:2048 sc1
    v_mul_f32 v52, v52, v92
    v_rcp_f32 v93, v93
    v_mfma_f32_16x16x32_bf16 v[40:43], a[56:59], v[184:187], v[40:43]
    v_rcp_f32 v94, v94
    v_mfma_f32_16x16x32_bf16 v[44:47], a[60:63], v[184:187], v[44:47]
    v_rcp_f32 v95, v95
    v_mul_f32 v53, v53, v93
    v_mul_f32 v54, v54, v94
    v_mul_f32 v55, v55, v95
    v_cvt_pk_bf16_f32 v150, v52, v53
    v_cvt_pk_bf16_f32 v151, v54, v55
    v_mfma_f32_16x16x32_bf16 v[76:79], a[60:63], v[188:191], v[76:79]
    s_waitcnt vmcnt(15)
    v_permlane16_swap_b32 v148, v150
    v_permlane16_swap_b32 v149, v151
    v_mfma_f32_16x16x32_bf16 v[72:75], a[56:59], v[188:191], v[72:75]
    buffer_load_dwordx4 v[252:255], v2, s[12:15], 0 offen offset:2304 sc1
    s_sub_u32 s14, s14, 77824
    s_waitcnt vmcnt(14)
    v_cmp_ne_u64 vcc, s[86:87], v[158:159]
    s_cbranch_vccnz L_slow_hf1
L_back_hf1:
    v_mfma_f32_16x16x32_bf16 v[68:71], a[52:55], v[188:191], v[68:71]
    s_add_u32 s12, s12, 77824
    s_addc_u32 s13, s13, 0
    v_add_u32 v18, s56, v14
    v_mfma_f32_16x16x32_bf16 v[64:67], a[48:51], v[188:191], v[64:67]
    buffer_load_dwordx4 v[160:163], v2, s[12:15], 0 offen offset:0 sc1
    v_add_u32 v19, s56, v15
    v_mfma_f32_16x16x32_bf16 v[32:35], a[64:67], v[192:195], v[32:35]
    s_lshl_b32 s56, s3, 7
    s_add_u32 s60, s82, s56
    s_add_u32 s82, s60, s82
    v_mfma_f32_16x16x32_bf16 v[36:39], a[68:71], v[192:195], v[36:39]
    s_mul_i32 s56, s32, 655360
    s_add_u32 s82, s82, s56
    s_add_u32 s64, s82, 3145728
    v_mfma_f32_16x16x32_bf16 v[40:43], a[72:75], v[192:195], v[40:43]
    s_add_u32 s65, s64, 163840
    s_add_u32 s66, s64, 327680
    s_add_u32 s67, s64, 491520
    v_mfma_f32_16x16x32_bf16 v[44:47], a[76:79], v[192:195], v[44:47]
    s_mul_i32 s56, s32, 163840
    s_add_u32 s60, s60, s56
    s_add_u32 s61, s60, 655360
    v_mfma_f32_16x16x32_bf16 v[76:79], a[76:79], v[196:199], v[76:79]
    s_add_u32 s62, s60, 1310720
    s_add_u32 s63, s60, 1966080
    v_add_u32 v26, 65536, v8
    v_mfma_f32_16x16x32_bf16 v[72:75], a[72:75], v[196:199], v[72:75]
    s_waitcnt vmcnt(14)
    v_add_u32 v27, 65536, v9
    v_add_u32 v28, 65536, v10
    v_mfma_f32_16x16x32_bf16 v[68:71], a[68:71], v[196:199], v[68:71]
    buffer_store_dwordx4 v[144:147], v4, s[8:11], s57 offen sc1
    s_add_u32 s57, s81, 688128
    v_mfma_f32_16x16x32_bf16 v[64:67], a[64:67], v[196:199], v[64:67]
    buffer_store_dwordx4 v[148:151], v4, s[8:11], s57 offen sc1
    v_mfma_f32_16x16x32_bf16 v[32:35], a[80:83], v[200:203], v[32:35]
    s_waitcnt vmcnt(15)
    v_add_u32 v29, 65536, v11
    v_mfma_f32_16x16x32_bf16 v[36:39], a[84:87], v[200:203], v[36:39]
    v_mfma_f32_16x16x32_bf16 v[40:43], a[88:91], v[200:203], v[40:43]
    v_mfma_f32_16x16x32_bf16 v[44:47], a[92:95], v[200:203], v[44:47]
    v_mfma_f32_16x16x32_bf16 v[76:79], a[92:95], v[204:207], v[76:79]
    s_waitcnt vmcnt(14)
    v_mfma_f32_16x16x32_bf16 v[72:75], a[88:91], v[204:207], v[72:75]
    v_mfma_f32_16x16x32_bf16 v[68:71], a[84:87], v[204:207], v[68:71]
    v_mfma_f32_16x16x32_bf16 v[64:67], a[80:83], v[204:207], v[64:67]
    v_mfma_f32_16x16x32_bf16 v[32:35], a[96:99], v[208:211], v[32:35]
    s_waitcnt vmcnt(13)
    v_mfma_f32_16x16x32_bf16 v[36:39], a[100:103], v[208:211], v[36:39]
    v_mfma_f32_16x16x32_bf16 v[40:43], a[104:107], v[208:211], v[40:43]
    v_mfma_f32_16x16x32_bf16 v[44:47], a[108:111], v[208:211], v[44:47]
    v_mfma_f32_16x16x32_bf16 v[76:79], a[108:111], v[212:215], v[76:79]
    s_waitcnt vmcnt(11)
    v_mfma_f32_16x16x32_bf16 v[72:75], a[104:107], v[212:215], v[72:75]
    v_mfma_f32_16x16x32_bf16 v[68:71], a[100:103], v[212:215], v[68:71]
    v_mfma_f32_16x16x32_bf16 v[64:67], a[96:99], v[212:215], v[64:67]
    v_mfma_f32_16x16x32_bf16 v[32:35], a[112:115], v[216:219], v[32:35]
    s_waitcnt vmcnt(10)
    buffer_load_dwordx4 v[164:167], v2, s[12:15], 0 offen offset:256 sc1
    v_mfma_f32_16x16x32_bf16 v[36:39], a[116:119], v[216:219], v[36:39]
    v_mfma_f32_16x16x32_bf16 v[40:43], a[120:123], v[216:219], v[40:43]
    v_mfma_f32_16x16x32_bf16 v[44:47], a[124:127], v[216:219], v[44:47]
    v_mfma_f32_16x16x32_bf16 v[76:79], a[124:127], v[220:223], v[76:79]
    s_waitcnt vmcnt(10)
    buffer_load_dwordx4 v[168:171], v2, s[12:15], 0 offen offset:2048 sc1
    v_mfma_f32_16x16x32_bf16 v[72:75], a[120:123], v[220:223], v[72:75]
    v_mfma_f32_16x16x32_bf16 v[68:71], a[116:119], v[220:223], v[68:71]
    v_mfma_f32_16x16x32_bf16 v[64:67], a[112:115], v[220:223], v[64:67]
    v_mfma_f32_16x16x32_bf16 v[32:35], a[128:131], v[224:227], v[32:35]
    s_waitcnt vmcnt(10)
    buffer_load_dwordx4 v[172:175], v2, s[12:15], 0 offen offset:2304 sc1
    s_add_u32 s12, s12, 4096
    s_addc_u32 s13, s13, 0
    s_sub_u32 s14, s14, 4096
    v_mfma_f32_16x16x32_bf16 v[36:39], a[132:135], v[224:227], v[36:39]
    v_mfma_f32_16x16x32_bf16 v[40:43], a[136:139], v[224:227], v[40:43]
    v_mfma_f32_16x16x32_bf16 v[44:47], a[140:143], v[224:227], v[44:47]
    v_mfma_f32_16x16x32_bf16 v[76:79], a[140:143], v[228:231], v[76:79]
    s_waitcnt vmcnt(10)
    buffer_load_dwordx4 v[176:179], v2, s[12:15], 0 offen offset:0 sc1
    v_mfma_f32_16x16x32_bf16 v[72:75], a[136:139], v[228:231], v[72:75]
    v_mfma_f32_16x16x32_bf16 v[68:71], a[132:135], v[228:231], v[68:71]
    v_mfma_f32_16x16x32_bf16 v[64:67], a[128:131], v[228:231], v[64:67]
    v_mfma_f32_16x16x32_bf16 v[32:35], a[144:147], v[232:235], v[32:35]
    s_waitcnt vmcnt(10)
    buffer_load_dwordx4 v[180:183], v2, s[12:15], 0 offen offset:256 sc1
    v_mfma_f32_16x16x32_bf16 v[32:35], a[192:195], v[240:243], v[32:35]
    s_waitcnt vmcnt(9)
    v_mfma_f32_16x16x32_bf16 v[32:35], a[208:211], v[248:251], v[32:35]
    s_nop 2
    v_mfma_f32_16x16x32_bf16 v[36:39], a[148:151], v[232:235], v[36:39]
    s_nop 2
    v_mfma_f32_16x16x32_bf16 v[36:39], a[196:199], v[240:243], v[36:39]
    ds_write_b128 v8, v[32:35] offset:0
    buffer_load_dwordx4 v[184:187], v2, s[12:15], 0 offen offset:2048 sc1
    v_mfma_f32_16x16x32_bf16 v[36:39], a[212:215], v[248:251], v[36:39]
    s_waitcnt vmcnt(8)
    s_nop 1
    v_mfma_f32_16x16x32_bf16 v[40:43], a[152:155], v[232:235], v[40:43]
    s_nop 2
    v_mfma_f32_16x16x32_bf16 v[40:43], a[200:203], v[240:243], v[40:43]
    ds_write_b128 v9, v[36:39] offset:0
    buffer_load_dwordx4 v[188:191], v2, s[12:15], 0 offen offset:2304 sc1
    s_add_u32 s12, s12, 4096
    s_addc_u32 s13, s13, 0
    s_sub_u32 s14, s14, 4096
    v_mfma_f32_16x16x32_bf16 v[40:43], a[216:219], v[248:251], v[40:43]
    s_nop 2
    v_mfma_f32_16x16x32_bf16 v[44:47], a[156:159], v[232:235], v[44:47]
    s_nop 2
    v_mfma_f32_16x16x32_bf16 v[44:47], a[204:207], v[240:243], v[44:47]
    ds_write_b128 v8, v[40:43] offset:128
    buffer_load_dwordx4 v[192:195], v2, s[12:15], 0 offen offset:0 sc1
    v_mfma_f32_16x16x32_bf16 v[44:47], a[220:223], v[248:251], v[44:47]
    s_nop 2
    v_mfma_f32_16x16x32_bf16 v[64:67], a[144:147], v[236:239], v[64:67]
    s_waitcnt lgkmcnt(2)
    s_nop 1
    v_mfma_f32_16x16x32_bf16 v[64:67], a[192:195], v[244:247], v[64:67]
    ds_write_b128 v9, v[44:47] offset:128
    v_mfma_f32_16x16x32_bf16 v[64:67], a[208:211], v[252:255], v[64:67]
    s_nop 1
    buffer_load_dwordx4 v[196:199], v2, s[12:15], 0 offen offset:256 sc1
    v_mfma_f32_16x16x32_bf16 v[68:71], a[148:151], v[236:239], v[68:71]
    s_waitcnt lgkmcnt(2)
    s_nop 1
    v_mfma_f32_16x16x32_bf16 v[68:71], a[196:199], v[244:247], v[68:71]
    ds_write_b128 v8, v[64:67] offset:4096
    v_mfma_f32_16x16x32_bf16 v[68:71], a[212:215], v[252:255], v[68:71]
    s_nop 2
    v_mfma_f32_16x16x32_bf16 v[72:75], a[152:155], v[236:239], v[72:75]
    s_nop 1
    buffer_load_dwordx4 v[200:203], v2, s[12:15], 0 offen offset:2048 sc1
    v_mfma_f32_16x16x32_bf16 v[72:75], a[200:203], v[244:247], v[72:75]
    s_waitcnt lgkmcnt(2)
    ds_write_b128 v9, v[68:71] offset:4096
    v_mfma_f32_16x16x32_bf16 v[72:75], a[216:219], v[252:255], v[72:75]
    s_nop 2
    v_mfma_f32_16x16x32_bf16 v[76:79], a[156:159], v[236:239], v[76:79]
    s_nop 2
    v_mfma_f32_16x16x32_bf16 v[76:79], a[204:207], v[244:247], v[76:79]
    s_waitcnt lgkmcnt(2)
    ds_write_b128 v8, v[72:75] offset:4224
    buffer_load_dwordx4 v[204:207], v2, s[12:15], 0 offen offset:2304 sc1
    s_add_u32 s12, s12, 4096
    s_addc_u32 s13, s13, 0
    s_sub_u32 s14, s14, 4096
    v_mfma_f32_16x16x32_bf16 v[76:79], a[220:223], v[252:255], v[76:79]
    s_nop 2
    v_mfma_f32_16x16x32_bf16 v[48:51], a[0:3], v[160:163], 0
    s_waitcnt lgkmcnt(2)
    s_nop 1
    v_mfma_f32_16x16x32_bf16 v[52:55], a[4:7], v[160:163], 0
    ds_write_b128 v9, v[76:79] offset:4224
    buffer_load_dwordx4 v[208:211], v2, s[12:15], 0 offen offset:0 sc1
    v_mfma_f32_16x16x32_bf16 v[56:59], a[8:11], v[160:163], 0
    v_mfma_f32_16x16x32_bf16 v[60:63], a[12:15], v[160:163], 0
    s_waitcnt lgkmcnt(2)
    buffer_load_dwordx4 v[212:215], v2, s[12:15], 0 offen offset:256 sc1
    buffer_load_dwordx4 v[216:219], v2, s[12:15], 0 offen offset:2048 sc1
    s_waitcnt lgkmcnt(0)
    s_barrier
    ds_read_b128 v[96:99], v10 offset:0
    buffer_load_dwordx4 v[220:223], v2, s[12:15], 0 offen offset:2304 sc1
    s_add_u32 s12, s12, 4096
    s_addc_u32 s13, s13, 0
    s_sub_u32 s14, s14, 4096
    ds_read_b128 v[100:103], v11 offset:0
    ds_read_b128 v[104:107], v10 offset:8192
    ds_read_b128 v[108:111], v11 offset:8192
    ds_read_b128 v[112:115], v10 offset:16384
    ds_read_b128 v[116:119], v11 offset:16384
    ds_read_b128 v[120:123], v10 offset:24576
    ds_read_b128 v[124:127], v11 offset:24576
    buffer_load_dwordx4 v[224:227], v2, s[12:15], 0 offen offset:0 sc1
    buffer_load_dwordx2 v[158:159], v25, s[8:11], s80 offen sc1
    s_waitcnt lgkmcnt(5)
    v_add_f32 v96, v96, v104
    v_add_f32 v97, v97, v105
    v_add_f32 v98, v98, v106
    v_add_f32 v99, v99, v107
    s_waitcnt lgkmcnt(2)
    v_add_f32 v100, v100, v108
    v_add_f32 v101, v101, v109
    v_add_f32 v102, v102, v110
    v_add_f32 v103, v103, v111
    s_waitcnt lgkmcnt(1)
    v_add_f32 v112, v112, v120
    v_add_f32 v113, v113, v121
    v_add_f32 v114, v114, v122
    v_add_f32 v115, v115, v123
    s_waitcnt lgkmcnt(0)
    v_add_f32 v116, v116, v124
    v_add_f32 v117, v117, v125
    v_add_f32 v118, v118, v126
    v_add_f32 v119, v119, v127
    v_add_f32 v128, v96, v112
    v_add_f32 v129, v97, v113
    v_add_f32 v130, v98, v114
    v_add_f32 v131, v99, v115
    v_add_f32 v132, v100, v116
    v_add_f32 v133, v101, v117
    v_add_f32 v134, v102, v118
    v_add_f32 v135, v103, v119
    v_mul_f32 v96, s68, v128
    v_mul_f32 v97, s68, v129
    v_mul_f32 v98, s68, v130
    v_mul_f32 v99, s68, v131
    v_mul_f32 v100, s68, v132
    v_mul_f32 v101, s68, v133
    v_mul_f32 v102, s68, v134
    v_mul_f32 v103, s68, v135
    v_exp_f32 v96, v96
    v_exp_f32 v97, v97
    v_exp_f32 v98, v98
    v_exp_f32 v99, v99
    v_exp_f32 v100, v100
    v_exp_f32 v101, v101
    v_exp_f32 v102, v102
    v_exp_f32 v103, v103
    v_fma_f32 v96, v96, s69, s69
    v_fma_f32 v97, v97, s69, s69
    v_fma_f32 v98, v98, s69, s69
    s_waitcnt vmcnt(16)
    v_mfma_f32_16x16x32_bf16 v[92:95], a[12:15], v[164:167], 0
    s_waitcnt vmcnt(15)
    v_fma_f32 v99, v99, s69, s69
    v_fma_f32 v100, v100, s69, s69
    v_mfma_f32_16x16x32_bf16 v[88:91], a[8:11], v[164:167], 0
    s_waitcnt vmcnt(14)
    v_fma_f32 v101, v101, s69, s69
    v_fma_f32 v102, v102, s69, s69
    v_mfma_f32_16x16x32_bf16 v[84:87], a[4:7], v[164:167], 0
    buffer_load_dwordx4 v[228:231], v2, s[12:15], 0 offen offset:256 sc1
    buffer_load_dwordx4 v[232:235], v2, s[12:15], 0 offen offset:2048 sc1
    v_mfma_f32_16x16x32_bf16 v[80:83], a[0:3], v[164:167], 0
    buffer_load_dwordx4 v[236:239], v2, s[12:15], 0 offen offset:2304 sc1
    s_sub_u32 s14, s14, 4096
    v_mfma_f32_16x16x32_bf16 v[48:51], a[16:19], v[168:171], v[48:51]
    s_add_u32 s12, s12, 4096
    s_addc_u32 s13, s13, 0
    v_fma_f32 v103, v103, s69, s69
    v_mfma_f32_16x16x32_bf16 v[52:55], a[20:23], v[168:171], v[52:55]
    s_waitcnt vmcnt(16)
    v_rcp_f32 v96, v96
    v_mfma_f32_16x16x32_bf16 v[56:59], a[24:27], v[168:171], v[56:59]
    buffer_load_dwordx4 v[240:243], v2, s[12:15], 0 offen offset:0 sc1
    v_mul_f32 v128, v128, v96
    v_mfma_f32_16x16x32_bf16 v[60:63], a[28:31], v[168:171], v[60:63]
    v_rcp_f32 v97, v97
    v_mfma_f32_16x16x32_bf16 v[92:95], a[28:31], v[172:175], v[92:95]
    s_waitcnt vmcnt(16)
    v_rcp_f32 v98, v98
    v_mfma_f32_16x16x32_bf16 v[88:91], a[24:27], v[172:175], v[88:91]
    buffer_store_dwordx2 v[156:157], v7, s[8:11], s89 offen sc1
    v_mfma_f32_16x16x32_bf16 v[84:87], a[20:23], v[172:175], v[84:87]
    s_cmp_ge_u32 s77, 20
    s_cbranch_scc1 L_gdone
    v_mfma_f32_16x16x32_bf16 v[80:83], a[16:19], v[172:175], v[80:83]
    v_rcp_f32 v99, v99
    v_mfma_f32_16x16x32_bf16 v[48:51], a[32:35], v[176:179], v[48:51]
    s_waitcnt vmcnt(16)
    v_rcp_f32 v100, v100
    v_mfma_f32_16x16x32_bf16 v[52:55], a[36:39], v[176:179], v[52:55]
    v_rcp_f32 v101, v101
    v_mfma_f32_16x16x32_bf16 v[56:59], a[40:43], v[176:179], v[56:59]
    v_rcp_f32 v102, v102
    v_mfma_f32_16x16x32_bf16 v[60:63], a[44:47], v[176:179], v[60:63]
    buffer_load_dwordx4 v[244:247], v2, s[12:15], 0 offen offset:256 sc1
    v_mul_f32 v129, v129, v97
    v_mfma_f32_16x16x32_bf16 v[92:95], a[44:47], v[180:183], v[92:95]
    s_waitcnt vmcnt(16)
    v_rcp_f32 v103, v103
    v_mfma_f32_16x16x32_bf16 v[88:91], a[40:43], v[180:183], v[88:91]
    v_mul_f32 v130, v130, v98
    v_mul_f32 v131, v131, v99
    v_mfma_f32_16x16x32_bf16 v[84:87], a[36:39], v[180:183], v[84:87]
    v_mul_f32 v132, v132, v100
    v_mul_f32 v133, v133, v101
    v_mfma_f32_16x16x32_bf16 v[80:83], a[32:35], v[180:183], v[80:83]
    v_mul_f32 v134, v134, v102
    v_mul_f32 v135, v135, v103
    v_mfma_f32_16x16x32_bf16 v[48:51], a[48:51], v[184:187], v[48:51]
    s_waitcnt vmcnt(15)
    buffer_load_dwordx4 v[248:251], v2, s[12:15], 0 offen offset:2048 sc1
    v_mfma_f32_16x16x32_bf16 v[52:55], a[52:55], v[184:187], v[52:55]
    v_mfma_f32_16x16x32_bf16 v[56:59], a[56:59], v[184:187], v[56:59]
    v_mfma_f32_16x16x32_bf16 v[60:63], a[60:63], v[184:187], v[60:63]
    buffer_load_dwordx4 v[252:255], v2, s[12:15], 0 offen offset:2304 sc1
    s_add_u32 s12, s12, 77824
    s_addc_u32 s13, s13, 0
    s_sub_u32 s14, s14, 77824
    v_mfma_f32_16x16x32_bf16 v[92:95], a[60:63], v[188:191], v[92:95]
    s_waitcnt vmcnt(16)
    v_mfma_f32_16x16x32_bf16 v[88:91], a[56:59], v[188:191], v[88:91]
    v_mfma_f32_16x16x32_bf16 v[84:87], a[52:55], v[188:191], v[84:87]
    v_mfma_f32_16x16x32_bf16 v[80:83], a[48:51], v[188:191], v[80:83]
    v_mfma_f32_16x16x32_bf16 v[48:51], a[64:67], v[192:195], v[48:51]
    s_waitcnt vmcnt(15)
    v_mfma_f32_16x16x32_bf16 v[52:55], a[68:71], v[192:195], v[52:55]
    v_mfma_f32_16x16x32_bf16 v[56:59], a[72:75], v[192:195], v[56:59]
    v_mfma_f32_16x16x32_bf16 v[60:63], a[76:79], v[192:195], v[60:63]
    v_mfma_f32_16x16x32_bf16 v[92:95], a[76:79], v[196:199], v[92:95]
    s_waitcnt vmcnt(14)
    v_mfma_f32_16x16x32_bf16 v[88:91], a[72:75], v[196:199], v[88:91]
    v_mfma_f32_16x16x32_bf16 v[84:87], a[68:71], v[196:199], v[84:87]
    v_mfma_f32_16x16x32_bf16 v[80:83], a[64:67], v[196:199], v[80:83]
    v_mfma_f32_16x16x32_bf16 v[48:51], a[80:83], v[200:203], v[48:51]
    s_waitcnt vmcnt(13)
    s_waitcnt vmcnt(8)
    v_cmp_ne_u64 vcc, s[86:87], v[158:159]
    s_cbranch_vccnz L_slow_hf2
L_back_hf2:
    buffer_load_dwordx4 v[160:163], v2, s[12:15], 0 offen offset:0 sc1
    buffer_load_dwordx2 v[22:23], v24, s[8:11], s92 offen offset:640 sc1
    v_mfma_f32_16x16x32_bf16 v[52:55], a[84:87], v[200:203], v[52:55]
    buffer_load_dwordx4 v[164:167], v2, s[12:15], 0 offen offset:256 sc1
    v_mfma_f32_16x16x32_bf16 v[56:59], a[88:91], v[200:203], v[56:59]
    v_mfma_f32_16x16x32_bf16 v[60:63], a[92:95], v[200:203], v[60:63]
    v_mfma_f32_16x16x32_bf16 v[92:95], a[92:95], v[204:207], v[92:95]
    v_mfma_f32_16x16x32_bf16 v[88:91], a[88:91], v[204:207], v[88:91]
    buffer_load_dwordx4 v[168:171], v2, s[12:15], 0 offen offset:2048 sc1
    v_mfma_f32_16x16x32_bf16 v[84:87], a[84:87], v[204:207], v[84:87]
    v_mfma_f32_16x16x32_bf16 v[80:83], a[80:83], v[204:207], v[80:83]
    v_mfma_f32_16x16x32_bf16 v[48:51], a[96:99], v[208:211], v[48:51]
    v_mfma_f32_16x16x32_bf16 v[52:55], a[100:103], v[208:211], v[52:55]
    buffer_load_dwordx4 v[172:175], v2, s[12:15], 0 offen offset:2304 sc1
    s_add_u32 s12, s12, 4096
    s_addc_u32 s13, s13, 0
    s_sub_u32 s14, s14, 4096
    v_mfma_f32_16x16x32_bf16 v[56:59], a[104:107], v[208:211], v[56:59]
    v_mfma_f32_16x16x32_bf16 v[60:63], a[108:111], v[208:211], v[60:63]
    v_mfma_f32_16x16x32_bf16 v[92:95], a[108:111], v[212:215], v[92:95]
    v_mfma_f32_16x16x32_bf16 v[88:91], a[104:107], v[212:215], v[88:91]
    buffer_load_dwordx4 v[176:179], v2, s[12:15], 0 offen offset:0 sc1
    v_mfma_f32_16x16x32_bf16 v[84:87], a[100:103], v[212:215], v[84:87]
    v_mfma_f32_16x16x32_bf16 v[80:83], a[96:99], v[212:215], v[80:83]
    v_mfma_f32_16x16x32_bf16 v[48:51], a[112:115], v[216:219], v[48:51]
    v_mfma_f32_16x16x32_bf16 v[52:55], a[116:119], v[216:219], v[52:55]
    buffer_load_dwordx4 v[180:183], v2, s[12:15], 0 offen offset:256 sc1
    v_mfma_f32_16x16x32_bf16 v[56:59], a[120:123], v[216:219], v[56:59]
    v_mfma_f32_16x16x32_bf16 v[60:63], a[124:127], v[216:219], v[60:63]
    v_mfma_f32_16x16x32_bf16 v[92:95], a[124:127], v[220:223], v[92:95]
    s_waitcnt vmcnt(14)
    v_mfma_f32_16x16x32_bf16 v[88:91], a[120:123], v[220:223], v[88:91]
    buffer_load_dwordx4 v[184:187], v2, s[12:15], 0 offen offset:2048 sc1
    v_mfma_f32_16x16x32_bf16 v[84:87], a[116:119], v[220:223], v[84:87]
    v_mfma_f32_16x16x32_bf16 v[80:83], a[112:115], v[220:223], v[80:83]
    v_mfma_f32_16x16x32_bf16 v[48:51], a[128:131], v[224:227], v[48:51]
    s_waitcnt vmcnt(14)
    v_mfma_f32_16x16x32_bf16 v[52:55], a[132:135], v[224:227], v[52:55]
    buffer_load_dwordx4 v[144:147], v3, s[4:7], s60 offen
    v_mfma_f32_16x16x32_bf16 v[56:59], a[136:139], v[224:227], v[56:59]
    v_mfma_f32_16x16x32_bf16 v[60:63], a[140:143], v[224:227], v[60:63]
    v_mfma_f32_16x16x32_bf16 v[92:95], a[140:143], v[228:231], v[92:95]
    s_waitcnt vmcnt(14)
    v_mfma_f32_16x16x32_bf16 v[88:91], a[136:139], v[228:231], v[88:91]
    buffer_load_dwordx4 v[148:151], v3, s[4:7], s61 offen
    v_mfma_f32_16x16x32_bf16 v[84:87], a[132:135], v[228:231], v[84:87]
    v_mfma_f32_16x16x32_bf16 v[80:83], a[128:131], v[228:231], v[80:83]
    v_mfma_f32_16x16x32_bf16 v[48:51], a[144:147], v[232:235], v[48:51]
    s_waitcnt vmcnt(14)
    v_mfma_f32_16x16x32_bf16 v[48:51], a[192:195], v[240:243], v[48:51]
    s_waitcnt vmcnt(11)
    buffer_load_dwordx4 v[188:191], v2, s[12:15], 0 offen offset:2304 sc1
    s_add_u32 s12, s12, 4096
    s_addc_u32 s13, s13, 0
    s_sub_u32 s14, s14, 4096
    v_mfma_f32_16x16x32_bf16 v[48:51], a[208:211], v[248:251], v[48:51]
    s_nop 2
    v_mfma_f32_16x16x32_bf16 v[52:55], a[148:151], v[232:235], v[52:55]
    s_nop 2
    v_mfma_f32_16x16x32_bf16 v[52:55], a[196:199], v[240:243], v[52:55]
    ds_write_b128 v8, v[48:51] offset:32768
    buffer_load_dwordx4 v[192:195], v2, s[12:15], 0 offen offset:0 sc1
    v_mfma_f32_16x16x32_bf16 v[52:55], a[212:215], v[248:251], v[52:55]
    s_nop 2
    v_mfma_f32_16x16x32_bf16 v[56:59], a[152:155], v[232:235], v[56:59]
    s_waitcnt vmcnt(11)
    s_nop 1
    v_mfma_f32_16x16x32_bf16 v[56:59], a[200:203], v[240:243], v[56:59]
    ds_write_b128 v9, v[52:55] offset:32768
    buffer_load_dwordx4 v[196:199], v2, s[12:15], 0 offen offset:256 sc1
    v_mfma_f32_16x16x32_bf16 v[56:59], a[216:219], v[248:251], v[56:59]
L_gbody_h5:
    s_cbranch_execz L_gbody_hr
    s_nop 2
    v_mfma_f32_16x16x32_bf16 v[60:63], a[156:159], v[232:235], v[60:63]
    s_nop 2
    v_mfma_f32_16x16x32_bf16 v[60:63], a[204:207], v[240:243], v[60:63]
    ds_write_b128 v8, v[56:59] offset:32896
    v_mfma_f32_16x16x32_bf16 v[60:63], a[220:223], v[248:251], v[60:63]
    s_nop 1
    buffer_load_dwordx4 v[200:203], v2, s[12:15], 0 offen offset:2048 sc1
    s_waitcnt vmcnt(12)
    v_cmp_ne_u64 vcc, s[86:87], v[22:23]
    s_cbranch_vccnz L_slow_uf
L_back_uf:
    v_mfma_f32_16x16x32_bf16 v[80:83], a[144:147], v[236:239], v[80:83]
    s_waitcnt lgkmcnt(2)
    ds_write_b128 v9, v[60:63] offset:32896
    v_mfma_f32_16x16x32_bf16 v[80:83], a[192:195], v[244:247], v[80:83]
    s_add_u32 m0, s83, 0
    s_nop 0
    v_mfma_f32_16x16x32_bf16 v[80:83], a[208:211], v[252:255], v[80:83]
    s_nop 1
    buffer_load_dwordx4 v5, s[8:11], s64 offen sc1 lds
    v_mfma_f32_16x16x32_bf16 v[84:87], a[148:151], v[236:239], v[84:87]
    s_waitcnt vmcnt(12)
    s_nop 1
    v_mfma_f32_16x16x32_bf16 v[84:87], a[196:199], v[244:247], v[84:87]
    s_waitcnt lgkmcnt(2)
    ds_write_b128 v8, v[80:83] offset:36864
    v_mfma_f32_16x16x32_bf16 v[84:87], a[212:215], v[252:255], v[84:87]
    s_add_u32 m0, s83, 1024
    s_nop 1
    buffer_load_dwordx4 v6, s[8:11], s65 offen sc1 lds
    v_mfma_f32_16x16x32_bf16 v[88:91], a[152:155], v[236:239], v[88:91]
    s_waitcnt lgkmcnt(2)
    s_nop 1
    v_mfma_f32_16x16x32_bf16 v[88:91], a[200:203], v[244:247], v[88:91]
    ds_write_b128 v9, v[84:87] offset:36864
    v_mfma_f32_16x16x32_bf16 v[88:91], a[216:219], v[252:255], v[88:91]
    s_add_u32 m0, s83, 2048
    s_nop 1
    buffer_load_dwordx4 v5, s[8:11], s66 offen sc1 lds
    v_mfma_f32_16x16x32_bf16 v[92:95], a[156:159], v[236:239], v[92:95]
    s_waitcnt lgkmcnt(2)
    s_nop 1
    v_mfma_f32_16x16x32_bf16 v[92:95], a[204:207], v[244:247], v[92:95]
    ds_write_b128 v8, v[88:91] offset:36992
    v_mfma_f32_16x16x32_bf16 v[92:95], a[220:223], v[252:255], v[92:95]
    s_add_u32 m0, s83, 3072
    s_nop 1
    buffer_load_dwordx4 v6, s[8:11], s67 offen sc1 lds
    v_mfma_f32_16x16x32_bf16 v[32:35], a[0:3], v[160:163], 0
    s_waitcnt vmcnt(14)
    s_nop 1
    v_mfma_f32_16x16x32_bf16 v[36:39], a[4:7], v[160:163], 0
    s_waitcnt lgkmcnt(2)
    ds_write_b128 v9, v[92:95] offset:36992
    v_mfma_f32_16x16x32_bf16 v[40:43], a[8:11], v[160:163], 0
    buffer_load_dwordx4 v[204:207], v2, s[12:15], 0 offen offset:2304 sc1
    s_sub_u32 s14, s14, 4096
    s_add_u32 s12, s12, 4096
    s_addc_u32 s13, s13, 0
    v_mfma_f32_16x16x32_bf16 v[44:47], a[12:15], v[160:163], 0
    s_waitcnt lgkmcnt(2)
    v_mfma_f32_16x16x32_bf16 v[76:79], a[12:15], v[164:167], 0
    s_waitcnt vmcnt(14)
    v_mfma_f32_16x16x32_bf16 v[72:75], a[8:11], v[164:167], 0
    v_mfma_f32_16x16x32_bf16 v[68:71], a[4:7], v[164:167], 0
    buffer_load_dwordx4 v[208:211], v2, s[12:15], 0 offen offset:0 sc1
    v_mfma_f32_16x16x32_bf16 v[64:67], a[0:3], v[164:167], 0
    s_waitcnt lgkmcnt(1)
    v_mfma_f32_16x16x32_bf16 v[32:35], a[16:19], v[168:171], v[32:35]
    s_waitcnt vmcnt(14)
    v_mfma_f32_16x16x32_bf16 v[36:39], a[20:23], v[168:171], v[36:39]
    v_mfma_f32_16x16x32_bf16 v[40:43], a[24:27], v[168:171], v[40:43]
    s_waitcnt lgkmcnt(0)
    s_barrier
    v_mfma_f32_16x16x32_bf16 v[44:47], a[28:31], v[168:171], v[44:47]
    buffer_load_dwordx4 v[212:215], v2, s[12:15], 0 offen offset:256 sc1
    v_mfma_f32_16x16x32_bf16 v[76:79], a[28:31], v[172:175], v[76:79]
    s_waitcnt vmcnt(14)
    v_mfma_f32_16x16x32_bf16 v[72:75], a[24:27], v[172:175], v[72:75]
    ds_read_b128 v[96:99], v10 offset:32768
    ds_read_b128 v[100:103], v11 offset:32768
    v_mfma_f32_16x16x32_bf16 v[68:71], a[20:23], v[172:175], v[68:71]
    ds_read_b128 v[104:107], v10 offset:40960
    buffer_load_dwordx4 v[216:219], v2, s[12:15], 0 offen offset:2048 sc1
    v_mfma_f32_16x16x32_bf16 v[64:67], a[16:19], v[172:175], v[64:67]
    ds_read_b128 v[108:111], v11 offset:40960
    ds_read_b128 v[112:115], v10 offset:49152
    v_mfma_f32_16x16x32_bf16 v[32:35], a[32:35], v[176:179], v[32:35]
    s_waitcnt vmcnt(14)
    ds_read_b128 v[116:119], v11 offset:49152
    ds_read_b128 v[120:123], v10 offset:57344
    v_mfma_f32_16x16x32_bf16 v[36:39], a[36:39], v[176:179], v[36:39]
    ds_read_b128 v[124:127], v11 offset:57344
    v_mfma_f32_16x16x32_bf16 v[40:43], a[40:43], v[176:179], v[40:43]
    buffer_load_dwordx2 v[158:159], v25, s[8:11], s89 offen sc1
    v_mfma_f32_16x16x32_bf16 v[44:47], a[44:47], v[176:179], v[44:47]
    v_mfma_f32_16x16x32_bf16 v[76:79], a[44:47], v[180:183], v[76:79]
    s_waitcnt vmcnt(12)
    v_mfma_f32_16x16x32_bf16 v[72:75], a[40:43], v[180:183], v[72:75]
    v_mfma_f32_16x16x32_bf16 v[68:71], a[36:39], v[180:183], v[68:71]
    s_waitcnt lgkmcnt(6)
    v_mfma_f32_16x16x32_bf16 v[64:67], a[32:35], v[180:183], v[64:67]
    s_waitcnt lgkmcnt(5)
    v_add_f32 v96, v96, v104
    v_add_f32 v97, v97, v105
    v_mfma_f32_16x16x32_bf16 v[32:35], a[48:51], v[184:187], v[32:35]
    s_waitcnt lgkmcnt(3)
    v_add_f32 v100, v100, v108
    v_add_f32 v98, v98, v106
    v_mfma_f32_16x16x32_bf16 v[36:39], a[52:55], v[184:187], v[36:39]
    s_waitcnt lgkmcnt(1)
    v_add_f32 v112, v112, v120
    v_add_f32 v99, v99, v107
    v_mfma_f32_16x16x32_bf16 v[40:43], a[56:59], v[184:187], v[40:43]
    s_waitcnt lgkmcnt(0)
    v_add_f32 v116, v116, v124
    v_add_f32 v101, v101, v109
    v_mfma_f32_16x16x32_bf16 v[44:47], a[60:63], v[184:187], v[44:47]
    s_waitcnt vmcnt(11)
    v_add_f32 v102, v102, v110
    v_add_f32 v103, v103, v111
    v_mfma_f32_16x16x32_bf16 v[76:79], a[60:63], v[188:191], v[76:79]
    s_waitcnt vmcnt(10)
    v_add_f32 v113, v113, v121
    v_add_f32 v114, v114, v122
    v_mfma_f32_16x16x32_bf16 v[72:75], a[56:59], v[188:191], v[72:75]
    buffer_load_dwordx4 v[220:223], v2, s[12:15], 0 offen offset:2304 sc1
    s_sub_u32 s14, s14, 4096
    s_add_u32 s12, s12, 4096
    s_addc_u32 s13, s13, 0
    v_mfma_f32_16x16x32_bf16 v[68:71], a[52:55], v[188:191], v[68:71]
    buffer_load_dwordx4 v[224:227], v2, s[12:15], 0 offen offset:0 sc1
    v_add_f32 v115, v115, v123
    v_mfma_f32_16x16x32_bf16 v[64:67], a[48:51], v[188:191], v[64:67]
    v_add_f32 v117, v117, v125
    v_add_f32 v118, v118, v126
    v_mfma_f32_16x16x32_bf16 v[32:35], a[64:67], v[192:195], v[32:35]
    s_waitcnt vmcnt(11)
    v_add_f32 v119, v119, v127
    v_add_f32 v136, v96, v112
    v_mfma_f32_16x16x32_bf16 v[36:39], a[68:71], v[192:195], v[36:39]
    v_add_f32 v137, v97, v113
    v_add_f32 v138, v98, v114
    v_mfma_f32_16x16x32_bf16 v[40:43], a[72:75], v[192:195], v[40:43]
    buffer_load_dwordx4 v[228:231], v2, s[12:15], 0 offen offset:256 sc1
    v_add_f32 v139, v99, v115
    v_mfma_f32_16x16x32_bf16 v[44:47], a[76:79], v[192:195], v[44:47]
    v_add_f32 v140, v100, v116
    v_add_f32 v141, v101, v117
    v_add_f32 v142, v102, v118
    v_add_f32 v143, v103, v119
    v_mul_f32 v96, s68, v136
    v_mul_f32 v97, s68, v137
    v_mul_f32 v98, s68, v138
    v_mul_f32 v99, s68, v139
    v_mul_f32 v100, s68, v140
    v_mul_f32 v101, s68, v141
    v_mfma_f32_16x16x32_bf16 v[76:79], a[76:79], v[196:199], v[76:79]
    buffer_load_dwordx4 v[232:235], v2, s[12:15], 0 offen offset:2048 sc1
    v_mul_f32 v102, s68, v142
    v_mfma_f32_16x16x32_bf16 v[72:75], a[72:75], v[196:199], v[72:75]
    v_mul_f32 v103, s68, v143
    v_lshlrev_b32 v112, 16, v144
    v_mfma_f32_16x16x32_bf16 v[68:71], a[68:71], v[196:199], v[68:71]
    v_exp_f32 v96, v96
    v_mfma_f32_16x16x32_bf16 v[64:67], a[64:67], v[196:199], v[64:67]
    v_exp_f32 v97, v97
    v_mfma_f32_16x16x32_bf16 v[32:35], a[80:83], v[200:203], v[32:35]
    buffer_load_dwordx4 v[236:239], v2, s[12:15], 0 offen offset:2304 sc1
    s_sub_u32 s14, s14, 4096
    s_add_u32 s12, s12, 4096
    s_addc_u32 s13, s13, 0
    v_mfma_f32_16x16x32_bf16 v[36:39], a[84:87], v[200:203], v[36:39]
    v_exp_f32 v98, v98
    v_mfma_f32_16x16x32_bf16 v[40:43], a[88:91], v[200:203], v[40:43]
    v_exp_f32 v99, v99
    v_mfma_f32_16x16x32_bf16 v[44:47], a[92:95], v[200:203], v[44:47]
    v_exp_f32 v100, v100
    v_exp_f32 v101, v101
    v_exp_f32 v102, v102
    s_waitcnt vmcnt(10)
    s_barrier
    v_exp_f32 v103, v103
    v_fma_f32 v96, v96, s69, s69
    v_fma_f32 v97, v97, s69, s69
    v_fma_f32 v98, v98, s69, s69
    v_fma_f32 v99, v99, s69, s69
    v_fma_f32 v100, v100, s69, s69
    v_fma_f32 v101, v101, s69, s69
    v_fma_f32 v102, v102, s69, s69
    v_fma_f32 v103, v103, s69, s69
    v_rcp_f32 v96, v96
    s_waitcnt vmcnt(9)
    v_mfma_f32_16x16x32_bf16 v[76:79], a[92:95], v[204:207], v[76:79]
    ds_read_b64_tr_b16 v[48:49], v16 offset:0
    ds_read_b64_tr_b16 v[50:51], v16 offset:512
    buffer_load_dwordx4 v[240:243], v2, s[12:15], 0 offen offset:0 sc1
    buffer_load_dwordx4 v[244:247], v2, s[12:15], 0 offen offset:256 sc1
    v_mfma_f32_16x16x32_bf16 v[72:75], a[88:91], v[204:207], v[72:75]
    ds_read_b64_tr_b16 v[52:53], v16 offset:4096
    ds_read_b64_tr_b16 v[54:55], v16 offset:4608
    v_mfma_f32_16x16x32_bf16 v[68:71], a[84:87], v[204:207], v[68:71]
    ds_read_b64_tr_b16 v[56:57], v16 offset:8192
    ds_read_b64_tr_b16 v[58:59], v16 offset:8704
    buffer_load_dwordx4 v[248:251], v2, s[12:15], 0 offen offset:2048 sc1
    v_mfma_f32_16x16x32_bf16 v[64:67], a[80:83], v[204:207], v[64:67]
    s_waitcnt vmcnt(11)
    ds_read_b64_tr_b16 v[60:61], v16 offset:12288
    ds_read_b64_tr_b16 v[62:63], v16 offset:12800
    v_mfma_f32_16x16x32_bf16 v[32:35], a[96:99], v[208:211], v[32:35]
    ds_read_b64_tr_b16 v[80:81], v17 offset:0
    ds_read_b64_tr_b16 v[82:83], v17 offset:512
    v_mfma_f32_16x16x32_bf16 v[36:39], a[100:103], v[208:211], v[36:39]
    ds_read_b64_tr_b16 v[84:85], v17 offset:4096
    ds_read_b64_tr_b16 v[86:87], v17 offset:4608
    v_mfma_f32_16x16x32_bf16 v[40:43], a[104:107], v[208:211], v[40:43]
    ds_read_b64_tr_b16 v[88:89], v17 offset:8192
    ds_read_b64_tr_b16 v[90:91], v17 offset:8704
    buffer_load_dwordx4 v[252:255], v2, s[12:15], 0 offen offset:2304 sc1
    s_add_u32 s12, s12, 77824
    s_addc_u32 s13, s13, 0
    s_sub_u32 s14, s14, 77824
    v_mfma_f32_16x16x32_bf16 v[44:47], a[108:111], v[208:211], v[44:47]
    s_waitcnt vmcnt(11)
    ds_read_b64_tr_b16 v[92:93], v17 offset:12288
    ds_read_b64_tr_b16 v[94:95], v17 offset:12800
    s_waitcnt lgkmcnt(14)
    v_mfma_f32_16x16x32_bf16 a[224:227], v[48:51], a[160:163], 0
    v_rcp_f32 v97, v97
    v_mfma_f32_16x16x32_bf16 a[240:243], v[48:51], a[164:167], 0
    s_waitcnt lgkmcnt(12)
    v_rcp_f32 v98, v98
    v_mfma_f32_16x16x32_bf16 a[224:227], v[52:55], a[168:171], a[224:227]
    s_waitcnt lgkmcnt(10)
    ds_read_b64_tr_b16 v[48:49], v18 offset:0
    ds_read_b64_tr_b16 v[50:51], v18 offset:512
    v_mfma_f32_16x16x32_bf16 a[240:243], v[52:55], a[172:175], a[240:243]
    s_waitcnt vmcnt(10)
    v_rcp_f32 v99, v99
    v_mfma_f32_16x16x32_bf16 a[224:227], v[56:59], a[176:179], a[224:227]
    s_waitcnt lgkmcnt(9)
    ds_read_b64_tr_b16 v[52:53], v18 offset:4096
    ds_read_b64_tr_b16 v[54:55], v18 offset:4608
    v_mfma_f32_16x16x32_bf16 a[240:243], v[56:59], a[180:183], a[240:243]
    s_waitcnt lgkmcnt(9)
    v_rcp_f32 v100, v100
    v_mfma_f32_16x16x32_bf16 a[224:227], v[60:63], a[184:187], a[224:227]
    s_waitcnt lgkmcnt(7)
    ds_read_b64_tr_b16 v[56:57], v18 offset:8192
    ds_read_b64_tr_b16 v[58:59], v18 offset:8704
    v_mfma_f32_16x16x32_bf16 a[240:243], v[60:63], a[188:191], a[240:243]
    s_waitcnt lgkmcnt(8)
    v_rcp_f32 v101, v101
    v_mfma_f32_16x16x32_bf16 a[228:231], v[80:83], a[160:163], 0
    s_waitcnt lgkmcnt(7)
    ds_read_b64_tr_b16 v[60:61], v18 offset:12288
    ds_read_b64_tr_b16 v[62:63], v18 offset:12800
    v_mfma_f32_16x16x32_bf16 a[244:247], v[80:83], a[164:167], 0
    s_waitcnt lgkmcnt(8)
    ds_write_b128 v26, a[224:227] offset:0
    s_waitcnt vmcnt(9)
    v_cmp_ne_u64 vcc, s[86:87], v[158:159]
    s_cbranch_vccnz L_slow_hf3
L_back_hf3:
    buffer_load_dwordx4 v[160:163], v2, s[12:15], 0 offen offset:0 sc1
    buffer_load_dwordx4 v[164:167], v2, s[12:15], 0 offen offset:256 sc1
    buffer_load_dwordx4 v[168:171], v2, s[12:15], 0 offen offset:2048 sc1
    v_mfma_f32_16x16x32_bf16 a[228:231], v[84:87], a[168:171], a[228:231]
    s_waitcnt lgkmcnt(7)
    ds_read_b64_tr_b16 v[80:81], v19 offset:0
    ds_read_b64_tr_b16 v[82:83], v19 offset:512
    v_mfma_f32_16x16x32_bf16 a[244:247], v[84:87], a[172:175], a[244:247]
    s_waitcnt lgkmcnt(8)
    ds_write_b128 v26, a[240:243] offset:4096
    buffer_load_dwordx4 v[172:175], v2, s[12:15], 0 offen offset:2304 sc1
    s_add_u32 s12, s12, 4096
    s_addc_u32 s13, s13, 0
    s_sub_u32 s14, s14, 4096
    v_mfma_f32_16x16x32_bf16 a[228:231], v[88:91], a[176:179], a[228:231]
    s_waitcnt lgkmcnt(6)
    ds_read_b64_tr_b16 v[84:85], v19 offset:4096
    ds_read_b64_tr_b16 v[86:87], v19 offset:4608
    v_mfma_f32_16x16x32_bf16 a[244:247], v[88:91], a[180:183], a[244:247]
    v_rcp_f32 v102, v102
    v_mfma_f32_16x16x32_bf16 a[228:231], v[92:95], a[184:187], a[228:231]
    s_waitcnt lgkmcnt(6)
    ds_read_b64_tr_b16 v[88:89], v19 offset:8192
    ds_read_b64_tr_b16 v[90:91], v19 offset:8704
    v_mfma_f32_16x16x32_bf16 a[244:247], v[92:95], a[188:191], a[244:247]
    s_nop 0
    v_rcp_f32 v103, v103
    v_mfma_f32_16x16x32_bf16 a[232:235], v[48:51], a[160:163], 0
    s_waitcnt lgkmcnt(7)
    ds_read_b64_tr_b16 v[92:93], v19 offset:12288
    ds_read_b64_tr_b16 v[94:95], v19 offset:12800
    buffer_load_dwordx4 v[176:179], v2, s[12:15], 0 offen offset:0 sc1
    v_mfma_f32_16x16x32_bf16 a[248:251], v[48:51], a[164:167], 0
    ds_write_b128 v27, a[228:231] offset:0
    v_mfma_f32_16x16x32_bf16 a[232:235], v[52:55], a[168:171], a[232:235]
    s_waitcnt lgkmcnt(8)
    ds_write_b128 v27, a[244:247] offset:4096
    buffer_load_dwordx4 v[180:183], v2, s[12:15], 0 offen offset:256 sc1
    v_mfma_f32_16x16x32_bf16 a[248:251], v[52:55], a[172:175], a[248:251]
    s_waitcnt lgkmcnt(8)
    v_mul_f32 v136, v136, v96
    v_mul_f32 v137, v137, v97
    v_mfma_f32_16x16x32_bf16 a[232:235], v[56:59], a[176:179], a[232:235]
    s_waitcnt lgkmcnt(7)
    v_mul_f32 v138, v138, v98
    v_mul_f32 v139, v139, v99
    v_mfma_f32_16x16x32_bf16 a[248:251], v[56:59], a[180:183], a[248:251]
    s_waitcnt lgkmcnt(6)
    v_mul_f32 v140, v140, v100
    v_mul_f32 v141, v141, v101
    v_mfma_f32_16x16x32_bf16 a[232:235], v[60:63], a[184:187], a[232:235]
    s_waitcnt lgkmcnt(5)
    v_mul_f32 v142, v142, v102
    v_mul_f32 v143, v143, v103
    v_mfma_f32_16x16x32_bf16 a[248:251], v[60:63], a[188:191], a[248:251]
    s_waitcnt lgkmcnt(4)
    v_and_b32 v113, s91, v144
    v_lshlrev_b32 v114, 16, v145
    v_mfma_f32_16x16x32_bf16 a[236:239], v[80:83], a[160:163], 0
    s_waitcnt lgkmcnt(3)
    ds_write_b128 v26, a[232:235] offset:128
    buffer_load_dwordx4 v[184:187], v2, s[12:15], 0 offen offset:2048 sc1
    v_mfma_f32_16x16x32_bf16 a[252:255], v[80:83], a[164:167], 0
    s_waitcnt lgkmcnt(3)
    ds_write_b128 v26, a[248:251] offset:4224
    buffer_load_dwordx4 v[188:191], v2, s[12:15], 0 offen offset:2304 sc1
    v_mfma_f32_16x16x32_bf16 a[236:239], v[84:87], a[168:171], a[236:239]
    s_add_u32 s12, s12, 4096
    s_addc_u32 s13, s13, 0
    s_sub_u32 s14, s14, 4096
    v_mfma_f32_16x16x32_bf16 a[252:255], v[84:87], a[172:175], a[252:255]
    s_waitcnt lgkmcnt(2)
    v_and_b32 v115, s91, v145
    v_lshlrev_b32 v116, 16, v146
    v_mfma_f32_16x16x32_bf16 a[236:239], v[88:91], a[176:179], a[236:239]
    v_and_b32 v117, s91, v146
    v_lshlrev_b32 v118, 16, v147
    v_mfma_f32_16x16x32_bf16 a[252:255], v[88:91], a[180:183], a[252:255]
    v_and_b32 v119, s91, v147
    v_lshlrev_b32 v120, 16, v148
    v_mfma_f32_16x16x32_bf16 a[236:239], v[92:95], a[184:187], a[236:239]
    s_nop 0
    v_and_b32 v121, s91, v148
    v_lshlrev_b32 v122, 16, v149
    v_mfma_f32_16x16x32_bf16 a[252:255], v[92:95], a[188:191], a[252:255]
    s_nop 0
    v_and_b32 v123, s91, v149
    v_lshlrev_b32 v124, 16, v150
    v_mfma_f32_16x16x32_bf16 v[76:79], a[108:111], v[212:215], v[76:79]
    s_waitcnt vmcnt(16)
    ds_write_b128 v27, a[236:239] offset:128
    v_mfma_f32_16x16x32_bf16 v[72:75], a[104:107], v[212:215], v[72:75]
    s_waitcnt lgkmcnt(2)
    ds_write_b128 v27, a[252:255] offset:4224
    v_mfma_f32_16x16x32_bf16 v[68:71], a[100:103], v[212:215], v[68:71]
    s_waitcnt lgkmcnt(2)
    v_and_b32 v125, s91, v150
    v_lshlrev_b32 v126, 16, v151
    v_mfma_f32_16x16x32_bf16 v[64:67], a[96:99], v[212:215], v[64:67]
    buffer_load_dwordx4 v[192:195], v2, s[12:15], 0 offen offset:0 sc1
    buffer_load_dwordx4 v[196:199], v2, s[12:15], 0 offen offset:256 sc1
    v_mfma_f32_16x16x32_bf16 v[32:35], a[112:115], v[216:219], v[32:35]
    s_waitcnt vmcnt(17)
    v_and_b32 v127, s91, v151
    v_mfma_f32_16x16x32_bf16 v[36:39], a[116:119], v[216:219], v[36:39]
    buffer_load_dwordx4 v[200:203], v2, s[12:15], 0 offen offset:2048 sc1
    v_mfma_f32_16x16x32_bf16 v[40:43], a[120:123], v[216:219], v[40:43]
    v_mfma_f32_16x16x32_bf16 v[44:47], a[124:127], v[216:219], v[44:47]
    v_mfma_f32_16x16x32_bf16 v[76:79], a[124:127], v[220:223], v[76:79]
    s_waitcnt vmcnt(17)
    v_mfma_f32_16x16x32_bf16 v[72:75], a[120:123], v[220:223], v[72:75]
    buffer_load_dwordx4 v[204:207], v2, s[12:15], 0 offen offset:2304 sc1
    v_mfma_f32_16x16x32_bf16 v[68:71], a[116:119], v[220:223], v[68:71]
    s_add_u32 s12, s12, 4096
    s_addc_u32 s13, s13, 0
    s_sub_u32 s14, s14, 4096
    v_mfma_f32_16x16x32_bf16 v[64:67], a[112:115], v[220:223], v[64:67]
    s_waitcnt lgkmcnt(0)
    s_barrier
    v_mfma_f32_16x16x32_bf16 v[32:35], a[128:131], v[224:227], v[32:35]
    s_waitcnt vmcnt(17)
    v_mfma_f32_16x16x32_bf16 v[36:39], a[132:135], v[224:227], v[36:39]
    s_waitcnt vmcnt(11)
    v_mfma_f32_16x16x32_bf16 v[40:43], a[136:139], v[224:227], v[40:43]
    buffer_load_dwordx4 v[208:211], v2, s[12:15], 0 offen offset:0 sc1
    ds_read_b128 v[96:99], v28 offset:0
    v_mfma_f32_16x16x32_bf16 v[44:47], a[140:143], v[224:227], v[44:47]
    ds_read_b128 v[100:103], v29 offset:0
    ds_read_b128 v[104:107], v28 offset:8192
    v_mfma_f32_16x16x32_bf16 v[76:79], a[140:143], v[228:231], v[76:79]
    ds_read_b128 v[108:111], v29 offset:8192
    v_mfma_f32_16x16x32_bf16 v[72:75], a[136:139], v[228:231], v[72:75]
    v_mfma_f32_16x16x32_bf16 v[68:71], a[132:135], v[228:231], v[68:71]
    s_waitcnt vmcnt(11)
    buffer_load_dwordx4 v[212:215], v2, s[12:15], 0 offen offset:256 sc1
    v_mfma_f32_16x16x32_bf16 v[64:67], a[128:131], v[228:231], v[64:67]
    v_mfma_f32_16x16x32_bf16 v[32:35], a[144:147], v[232:235], v[32:35]
    v_mfma_f32_16x16x32_bf16 v[32:35], a[192:195], v[240:243], v[32:35]
    v_mfma_f32_16x16x32_bf16 v[32:35], a[208:211], v[248:251], v[32:35]
    s_nop 1
    buffer_load_dwordx4 v[216:219], v2, s[12:15], 0 offen offset:2048 sc1
    v_mfma_f32_16x16x32_bf16 v[36:39], a[148:151], v[232:235], v[36:39]
    s_nop 2
    v_mfma_f32_16x16x32_bf16 v[36:39], a[196:199], v[240:243], v[36:39]
    s_waitcnt lgkmcnt(3)
    v_fmac_f32 v112, v96, v128
    v_fmac_f32 v113, v97, v129
    v_mfma_f32_16x16x32_bf16 v[36:39], a[212:215], v[248:251], v[36:39]
    s_waitcnt lgkmcnt(1)
    v_fmac_f32 v116, v100, v132
    v_fmac_f32 v114, v98, v130
    v_mfma_f32_16x16x32_bf16 v[40:43], a[152:155], v[232:235], v[40:43]
    s_waitcnt lgkmcnt(0)
    v_fmac_f32 v124, v108, v140
    v_fmac_f32 v115, v99, v131
    v_mfma_f32_16x16x32_bf16 v[40:43], a[200:203], v[240:243], v[40:43]
    ds_write_b128 v8, v[32:35] offset:0
    v_mfma_f32_16x16x32_bf16 v[40:43], a[216:219], v[248:251], v[40:43]
    ds_write_b128 v9, v[36:39] offset:0
    v_mfma_f32_16x16x32_bf16 v[44:47], a[156:159], v[232:235], v[44:47]
    s_nop 0
    v_fmac_f32 v117, v101, v133
    v_fmac_f32 v118, v102, v134
    v_mfma_f32_16x16x32_bf16 v[44:47], a[204:207], v[240:243], v[44:47]
    s_nop 0
    v_fmac_f32 v119, v103, v135
    v_cvt_pk_bf16_f32 v144, v112, v113
    v_mfma_f32_16x16x32_bf16 v[44:47], a[220:223], v[248:251], v[44:47]
    ds_write_b128 v8, v[40:43] offset:128
    v_mfma_f32_16x16x32_bf16 v[64:67], a[144:147], v[236:239], v[64:67]
    s_nop 0
    v_cvt_pk_bf16_f32 v145, v114, v115
    v_cvt_pk_bf16_f32 v146, v116, v117
    v_mfma_f32_16x16x32_bf16 v[64:67], a[192:195], v[244:247], v[64:67]
    s_nop 0
    v_cvt_pk_bf16_f32 v147, v118, v119
    v_fmac_f32 v120, v104, v136
    v_mfma_f32_16x16x32_bf16 v[64:67], a[208:211], v[252:255], v[64:67]
    ds_write_b128 v9, v[44:47] offset:128
    buffer_load_dwordx4 v[220:223], v2, s[12:15], 0 offen offset:2304 sc1
    v_mfma_f32_16x16x32_bf16 v[68:71], a[148:151], v[236:239], v[68:71]
    s_add_u32 s12, s12, 4096
    s_addc_u32 s13, s13, 0
    s_sub_u32 s14, s14, 4096
    v_mfma_f32_16x16x32_bf16 v[68:71], a[196:199], v[244:247], v[68:71]
    s_waitcnt lgkmcnt(3)
    ds_write_b128 v8, v[64:67] offset:4096
    v_mfma_f32_16x16x32_bf16 v[68:71], a[212:215], v[252:255], v[68:71]
    s_waitcnt lgkmcnt(3)
    v_fmac_f32 v121, v105, v137
    v_fmac_f32 v122, v106, v138
    v_mfma_f32_16x16x32_bf16 v[72:75], a[152:155], v[236:239], v[72:75]
    s_nop 0
    v_fmac_f32 v123, v107, v139
    v_fmac_f32 v125, v109, v141
    v_mfma_f32_16x16x32_bf16 v[72:75], a[200:203], v[244:247], v[72:75]
    ds_write_b128 v9, v[68:71] offset:4096
    buffer_load_dwordx4 v[224:227], v2, s[12:15], 0 offen offset:0 sc1
    v_mfma_f32_16x16x32_bf16 v[72:75], a[216:219], v[252:255], v[72:75]
    s_waitcnt lgkmcnt(3)
    v_fmac_f32 v126, v110, v142
    v_fmac_f32 v127, v111, v143
    v_mfma_f32_16x16x32_bf16 v[76:79], a[156:159], v[236:239], v[76:79]
    s_nop 0
    v_cvt_pk_bf16_f32 v148, v120, v121
    v_cvt_pk_bf16_f32 v149, v122, v123
    v_mfma_f32_16x16x32_bf16 v[76:79], a[204:207], v[244:247], v[76:79]
    ds_write_b128 v8, v[72:75] offset:4224
    v_mfma_f32_16x16x32_bf16 v[76:79], a[220:223], v[252:255], v[76:79]
    s_waitcnt lgkmcnt(3)
    v_cvt_pk_bf16_f32 v150, v124, v125
    v_cvt_pk_bf16_f32 v151, v126, v127
    v_mfma_f32_16x16x32_bf16 v[48:51], a[0:3], v[160:163], 0
    s_waitcnt vmcnt(14)
    s_nop 1
    buffer_load_dwordx4 v[228:231], v2, s[12:15], 0 offen offset:256 sc1
    v_mfma_f32_16x16x32_bf16 v[52:55], a[4:7], v[160:163], 0
    s_waitcnt lgkmcnt(2)
    ds_write_b128 v9, v[76:79] offset:4224
    v_mfma_f32_16x16x32_bf16 v[56:59], a[8:11], v[160:163], 0
    buffer_load_dwordx4 v[232:235], v2, s[12:15], 0 offen offset:2048 sc1
    buffer_load_dwordx4 v[236:239], v2, s[12:15], 0 offen offset:2304 sc1
    v_mfma_f32_16x16x32_bf16 v[60:63], a[12:15], v[160:163], 0
    s_add_u32 s12, s12, 4096
    s_addc_u32 s13, s13, 0
    s_sub_u32 s14, s14, 4096
    v_mfma_f32_16x16x32_bf16 v[92:95], a[12:15], v[164:167], 0
    s_waitcnt vmcnt(16)
    buffer_load_dwordx4 v[240:243], v2, s[12:15], 0 offen offset:0 sc1
    v_mfma_f32_16x16x32_bf16 v[88:91], a[8:11], v[164:167], 0
    s_waitcnt lgkmcnt(2)
    buffer_load_dwordx4 v[244:247], v2, s[12:15], 0 offen offset:256 sc1
    v_mfma_f32_16x16x32_bf16 v[84:87], a[4:7], v[164:167], 0
    v_mfma_f32_16x16x32_bf16 v[80:83], a[0:3], v[164:167], 0
    s_waitcnt lgkmcnt(1)
    v_mfma_f32_16x16x32_bf16 v[48:51], a[16:19], v[168:171], v[48:51]
    s_waitcnt vmcnt(17)
    v_mfma_f32_16x16x32_bf16 v[52:55], a[20:23], v[168:171], v[52:55]
    buffer_load_dwordx4 v[248:251], v2, s[12:15], 0 offen offset:2048 sc1
    v_mfma_f32_16x16x32_bf16 v[56:59], a[24:27], v[168:171], v[56:59]
    v_mfma_f32_16x16x32_bf16 v[60:63], a[28:31], v[168:171], v[60:63]
    s_waitcnt lgkmcnt(0)
    s_barrier
    v_mfma_f32_16x16x32_bf16 v[92:95], a[28:31], v[172:175], v[92:95]
    s_waitcnt vmcnt(17)
    v_mfma_f32_16x16x32_bf16 v[88:91], a[24:27], v[172:175], v[88:91]
    buffer_load_dwordx4 v[252:255], v2, s[12:15], 0 offen offset:2304 sc1
    v_mfma_f32_16x16x32_bf16 v[84:87], a[20:23], v[172:175], v[84:87]
    ds_read_b128 v[96:99], v10 offset:0
    ds_read_b128 v[100:103], v11 offset:0
    v_mfma_f32_16x16x32_bf16 v[80:83], a[16:19], v[172:175], v[80:83]
    ds_read_b128 v[104:107], v10 offset:8192
    ds_read_b128 v[108:111], v11 offset:8192
    v_mfma_f32_16x16x32_bf16 v[48:51], a[32:35], v[176:179], v[48:51]
    s_waitcnt vmcnt(17)
    ds_read_b128 v[112:115], v10 offset:16384
    ds_read_b128 v[116:119], v11 offset:16384
    v_mfma_f32_16x16x32_bf16 v[52:55], a[36:39], v[176:179], v[52:55]
    ds_read_b128 v[120:123], v10 offset:24576
    v_mfma_f32_16x16x32_bf16 v[56:59], a[40:43], v[176:179], v[56:59]
    buffer_load_dwordx4 v[128:131], v3, s[4:7], s62 offen
    v_mfma_f32_16x16x32_bf16 v[60:63], a[44:47], v[176:179], v[60:63]
    ds_read_b128 v[124:127], v11 offset:24576
    ds_read_b128 v[32:35], v28 offset:16384
    v_mfma_f32_16x16x32_bf16 v[92:95], a[44:47], v[180:183], v[92:95]
    s_waitcnt vmcnt(17)
    ds_read_b128 v[36:39], v29 offset:16384
    v_mfma_f32_16x16x32_bf16 v[88:91], a[40:43], v[180:183], v[88:91]
    buffer_load_dwordx4 v[132:135], v3, s[4:7], s63 offen
    v_mfma_f32_16x16x32_bf16 v[84:87], a[36:39], v[180:183], v[84:87]
    ds_read_b128 v[40:43], v28 offset:24576
    ds_read_b128 v[44:47], v29 offset:24576
    v_mfma_f32_16x16x32_bf16 v[80:83], a[32:35], v[180:183], v[80:83]
    v_mfma_f32_16x16x32_bf16 v[48:51], a[48:51], v[184:187], v[48:51]
    s_waitcnt vmcnt(17)
    s_waitcnt lgkmcnt(9)
    v_add_f32 v96, v96, v104
    v_mfma_f32_16x16x32_bf16 v[52:55], a[52:55], v[184:187], v[52:55]
    s_waitcnt lgkmcnt(8)
    v_add_f32 v100, v100, v108
    v_add_f32 v97, v97, v105
    v_mfma_f32_16x16x32_bf16 v[56:59], a[56:59], v[184:187], v[56:59]
    s_waitcnt lgkmcnt(6)
    v_add_f32 v98, v98, v106
    v_add_f32 v99, v99, v107
    v_mfma_f32_16x16x32_bf16 v[60:63], a[60:63], v[184:187], v[60:63]
    s_waitcnt lgkmcnt(5)
    v_add_f32 v112, v112, v120
    v_add_f32 v101, v101, v109
    v_mfma_f32_16x16x32_bf16 v[92:95], a[60:63], v[188:191], v[92:95]
    s_waitcnt vmcnt(16)
    v_add_f32 v102, v102, v110
    v_add_f32 v103, v103, v111
    v_mfma_f32_16x16x32_bf16 v[88:91], a[56:59], v[188:191], v[88:91]
    s_waitcnt lgkmcnt(3)
    v_add_f32 v116, v116, v124
    v_add_f32 v113, v113, v121
    v_mfma_f32_16x16x32_bf16 v[84:87], a[52:55], v[188:191], v[84:87]
    s_waitcnt lgkmcnt(2)
    v_add_f32 v114, v114, v122
    v_add_f32 v115, v115, v123
    v_mfma_f32_16x16x32_bf16 v[80:83], a[48:51], v[188:191], v[80:83]
    buffer_store_dwordx4 v[144:147], v3, s[24:27], s60 offen sc1
    v_mfma_f32_16x16x32_bf16 v[48:51], a[64:67], v[192:195], v[48:51]
    s_waitcnt vmcnt(16)
    v_add_f32 v117, v117, v125
    v_add_f32 v118, v118, v126
    v_mfma_f32_16x16x32_bf16 v[52:55], a[68:71], v[192:195], v[52:55]
    s_waitcnt lgkmcnt(0)
    v_add_f32 v119, v119, v127
    v_add_f32 v144, v96, v112
    v_mfma_f32_16x16x32_bf16 v[56:59], a[72:75], v[192:195], v[56:59]
    buffer_store_dwordx4 v[148:151], v3, s[24:27], s61 offen sc1
    v_mfma_f32_16x16x32_bf16 v[60:63], a[76:79], v[192:195], v[60:63]
    s_nop 0
    v_add_f32 v145, v97, v113
    v_add_f32 v146, v98, v114
    v_mfma_f32_16x16x32_bf16 v[92:95], a[76:79], v[196:199], v[92:95]
    s_waitcnt vmcnt(16)
    v_add_f32 v147, v99, v115
    v_add_f32 v148, v100, v116
    v_mfma_f32_16x16x32_bf16 v[88:91], a[72:75], v[196:199], v[88:91]
    v_add_f32 v149, v101, v117
    v_add_f32 v150, v102, v118
    v_mfma_f32_16x16x32_bf16 v[84:87], a[68:71], v[196:199], v[84:87]
    v_add_f32 v151, v103, v119
    v_mul_f32 v96, s68, v144
    v_mfma_f32_16x16x32_bf16 v[80:83], a[64:67], v[196:199], v[80:83]
    v_mul_f32 v97, s68, v145
    v_mul_f32 v98, s68, v146
    v_mfma_f32_16x16x32_bf16 v[48:51], a[80:83], v[200:203], v[48:51]
    s_waitcnt vmcnt(15)
    v_mul_f32 v99, s68, v147
    v_mul_f32 v100, s68, v148
    v_mfma_f32_16x16x32_bf16 v[52:55], a[84:87], v[200:203], v[52:55]
    v_mul_f32 v101, s68, v149
    v_mul_f32 v102, s68, v150
    v_mfma_f32_16x16x32_bf16 v[56:59], a[88:91], v[200:203], v[56:59]
    v_mul_f32 v103, s68, v151
    v_mfma_f32_16x16x32_bf16 v[60:63], a[92:95], v[200:203], v[60:63]
    v_exp_f32 v96, v96
    v_mfma_f32_16x16x32_bf16 v[92:95], a[92:95], v[204:207], v[92:95]
    s_waitcnt vmcnt(14)
    v_exp_f32 v97, v97
    v_mfma_f32_16x16x32_bf16 v[88:91], a[88:91], v[204:207], v[88:91]
    v_exp_f32 v98, v98
    v_mfma_f32_16x16x32_bf16 v[84:87], a[84:87], v[204:207], v[84:87]
    v_exp_f32 v99, v99
    v_mfma_f32_16x16x32_bf16 v[80:83], a[80:83], v[204:207], v[80:83]
    v_exp_f32 v100, v100
    v_mfma_f32_16x16x32_bf16 v[48:51], a[96:99], v[208:211], v[48:51]
    s_waitcnt vmcnt(13)
    v_exp_f32 v101, v101
    v_mfma_f32_16x16x32_bf16 v[52:55], a[100:103], v[208:211], v[52:55]
    v_exp_f32 v102, v102
    v_mfma_f32_16x16x32_bf16 v[56:59], a[104:107], v[208:211], v[56:59]
    v_exp_f32 v103, v103
    v_mfma_f32_16x16x32_bf16 v[60:63], a[108:111], v[208:211], v[60:63]
    v_fma_f32 v96, v96, s69, s69
    v_fma_f32 v97, v97, s69, s69
    v_mfma_f32_16x16x32_bf16 v[92:95], a[108:111], v[212:215], v[92:95]
    s_waitcnt vmcnt(12)
    v_fma_f32 v98, v98, s69, s69
    v_fma_f32 v99, v99, s69, s69
    v_mfma_f32_16x16x32_bf16 v[88:91], a[104:107], v[212:215], v[88:91]
    v_fma_f32 v100, v100, s69, s69
    v_fma_f32 v101, v101, s69, s69
    v_mfma_f32_16x16x32_bf16 v[84:87], a[100:103], v[212:215], v[84:87]
    v_fma_f32 v102, v102, s69, s69
    v_fma_f32 v103, v103, s69, s69
    v_mfma_f32_16x16x32_bf16 v[80:83], a[96:99], v[212:215], v[80:83]
    v_rcp_f32 v96, v96
    v_mfma_f32_16x16x32_bf16 v[48:51], a[112:115], v[216:219], v[48:51]
    s_waitcnt vmcnt(11)
    v_rcp_f32 v97, v97
    v_mfma_f32_16x16x32_bf16 v[52:55], a[116:119], v[216:219], v[52:55]
    v_rcp_f32 v98, v98
    v_mfma_f32_16x16x32_bf16 v[56:59], a[120:123], v[216:219], v[56:59]
    v_rcp_f32 v99, v99
    v_mfma_f32_16x16x32_bf16 v[60:63], a[124:127], v[216:219], v[60:63]
    v_rcp_f32 v100, v100
    v_mfma_f32_16x16x32_bf16 v[92:95], a[124:127], v[220:223], v[92:95]
    s_waitcnt vmcnt(10)
    v_rcp_f32 v101, v101
    v_mfma_f32_16x16x32_bf16 v[88:91], a[120:123], v[220:223], v[88:91]
L_gbody_h6:
    s_cbranch_execz L_gbody_hr
    v_rcp_f32 v102, v102
    v_mfma_f32_16x16x32_bf16 v[84:87], a[116:119], v[220:223], v[84:87]
    v_rcp_f32 v103, v103
    v_mfma_f32_16x16x32_bf16 v[80:83], a[112:115], v[220:223], v[80:83]
    v_mul_f32 v144, v144, v96
    v_mul_f32 v145, v145, v97
    v_mfma_f32_16x16x32_bf16 v[48:51], a[128:131], v[224:227], v[48:51]
    s_waitcnt vmcnt(9)
    v_mul_f32 v146, v146, v98
    v_mul_f32 v147, v147, v99
    v_mfma_f32_16x16x32_bf16 v[52:55], a[132:135], v[224:227], v[52:55]
    v_mul_f32 v148, v148, v100
    v_mul_f32 v149, v149, v101
    v_mfma_f32_16x16x32_bf16 v[56:59], a[136:139], v[224:227], v[56:59]
    v_mul_f32 v150, v150, v102
    v_mul_f32 v151, v151, v103
    v_mfma_f32_16x16x32_bf16 v[60:63], a[140:143], v[224:227], v[60:63]
    s_waitcnt vmcnt(3)
    v_lshlrev_b32 v64, 16, v128
    v_and_b32 v65, s91, v128
    v_mfma_f32_16x16x32_bf16 v[92:95], a[140:143], v[228:231], v[92:95]
    v_lshlrev_b32 v66, 16, v129
    v_and_b32 v67, s91, v129
    v_mfma_f32_16x16x32_bf16 v[88:91], a[136:139], v[228:231], v[88:91]
    v_lshlrev_b32 v68, 16, v130
    v_and_b32 v69, s91, v130
    v_mfma_f32_16x16x32_bf16 v[84:87], a[132:135], v[228:231], v[84:87]
    v_lshlrev_b32 v70, 16, v131
    v_and_b32 v71, s91, v131
    v_mfma_f32_16x16x32_bf16 v[80:83], a[128:131], v[228:231], v[80:83]
    s_waitcnt vmcnt(2)
    v_lshlrev_b32 v72, 16, v132
    v_and_b32 v73, s91, v132
    v_mfma_f32_16x16x32_bf16 v[48:51], a[144:147], v[232:235], v[48:51]
    v_lshlrev_b32 v74, 16, v133
    v_and_b32 v75, s91, v133
    v_mfma_f32_16x16x32_bf16 v[48:51], a[192:195], v[240:243], v[48:51]
    v_lshlrev_b32 v76, 16, v134
    v_and_b32 v77, s91, v134
    v_mfma_f32_16x16x32_bf16 v[48:51], a[208:211], v[248:251], v[48:51]
    s_nop 0
    v_lshlrev_b32 v78, 16, v135
    v_and_b32 v79, s91, v135
    v_mfma_f32_16x16x32_bf16 v[52:55], a[148:151], v[232:235], v[52:55]
    s_nop 0
    v_fmac_f32 v64, v32, v144
    v_fmac_f32 v65, v33, v145
    v_mfma_f32_16x16x32_bf16 v[52:55], a[196:199], v[240:243], v[52:55]
    ds_write_b128 v8, v[48:51] offset:32768
    v_mfma_f32_16x16x32_bf16 v[52:55], a[212:215], v[248:251], v[52:55]
    s_nop 0
    v_fmac_f32 v66, v34, v146
    v_fmac_f32 v67, v35, v147
    v_mfma_f32_16x16x32_bf16 v[56:59], a[152:155], v[232:235], v[56:59]
    s_nop 0
    v_fmac_f32 v68, v36, v148
    v_fmac_f32 v69, v37, v149
    v_mfma_f32_16x16x32_bf16 v[56:59], a[200:203], v[240:243], v[56:59]
    ds_write_b128 v9, v[52:55] offset:32768
    v_mfma_f32_16x16x32_bf16 v[56:59], a[216:219], v[248:251], v[56:59]
    s_nop 0
    v_fmac_f32 v70, v38, v150
    v_fmac_f32 v71, v39, v151
    v_mfma_f32_16x16x32_bf16 v[60:63], a[156:159], v[232:235], v[60:63]
    s_nop 0
    v_cvt_pk_bf16_f32 v128, v64, v65
    v_cvt_pk_bf16_f32 v129, v66, v67
    v_mfma_f32_16x16x32_bf16 v[60:63], a[204:207], v[240:243], v[60:63]
    ds_write_b128 v8, v[56:59] offset:32896
    v_mfma_f32_16x16x32_bf16 v[60:63], a[220:223], v[248:251], v[60:63]
    s_nop 0
    v_cvt_pk_bf16_f32 v130, v68, v69
    v_cvt_pk_bf16_f32 v131, v70, v71
    v_mfma_f32_16x16x32_bf16 v[80:83], a[144:147], v[236:239], v[80:83]
    s_nop 2
    v_mfma_f32_16x16x32_bf16 v[80:83], a[192:195], v[244:247], v[80:83]
    s_waitcnt lgkmcnt(2)
    ds_write_b128 v9, v[60:63] offset:32896
    v_mfma_f32_16x16x32_bf16 v[80:83], a[208:211], v[252:255], v[80:83]
    s_nop 2
    v_mfma_f32_16x16x32_bf16 v[84:87], a[148:151], v[236:239], v[84:87]
    s_nop 2
    v_mfma_f32_16x16x32_bf16 v[84:87], a[196:199], v[244:247], v[84:87]
    s_waitcnt lgkmcnt(2)
    ds_write_b128 v8, v[80:83] offset:36864
    v_mfma_f32_16x16x32_bf16 v[84:87], a[212:215], v[252:255], v[84:87]
    s_nop 2
    v_mfma_f32_16x16x32_bf16 v[88:91], a[152:155], v[236:239], v[88:91]
    s_nop 2
    v_mfma_f32_16x16x32_bf16 v[88:91], a[200:203], v[244:247], v[88:91]
    s_waitcnt lgkmcnt(2)
    ds_write_b128 v9, v[84:87] offset:36864
    v_mfma_f32_16x16x32_bf16 v[88:91], a[216:219], v[252:255], v[88:91]
    s_nop 2
    v_mfma_f32_16x16x32_bf16 v[92:95], a[156:159], v[236:239], v[92:95]
    s_nop 2
    v_mfma_f32_16x16x32_bf16 v[92:95], a[204:207], v[244:247], v[92:95]
    s_waitcnt lgkmcnt(2)
    ds_write_b128 v8, v[88:91] offset:36992
    v_mfma_f32_16x16x32_bf16 v[92:95], a[220:223], v[252:255], v[92:95]
    s_nop 1
    buffer_store_dwordx4 v[128:131], v3, s[24:27], s62 offen sc1
    s_nop 4
    ds_write_b128 v9, v[92:95] offset:36992
    s_waitcnt lgkmcnt(0)
    s_barrier
    ds_read_b128 v[96:99], v10 offset:32768
    ds_read_b128 v[100:103], v11 offset:32768
    ds_read_b128 v[104:107], v10 offset:40960
    ds_read_b128 v[108:111], v11 offset:40960
    ds_read_b128 v[112:115], v10 offset:49152
    ds_read_b128 v[116:119], v11 offset:49152
    ds_read_b128 v[120:123], v10 offset:57344
    ds_read_b128 v[124:127], v11 offset:57344
    s_waitcnt lgkmcnt(5)
    v_pk_add_f32 v[96:97], v[96:97], v[104:105]
    v_pk_add_f32 v[98:99], v[98:99], v[106:107]
    s_waitcnt lgkmcnt(3)
    v_pk_add_f32 v[100:101], v[100:101], v[108:109]
    v_pk_add_f32 v[102:103], v[102:103], v[110:111]
    s_waitcnt lgkmcnt(1)
    v_pk_add_f32 v[112:113], v[112:113], v[120:121]
    v_pk_add_f32 v[114:115], v[114:115], v[122:123]
    v_pk_add_f32 v[152:153], v[96:97], v[112:113]
    s_waitcnt lgkmcnt(0)
    v_pk_add_f32 v[116:117], v[116:117], v[124:125]
    v_pk_add_f32 v[118:119], v[118:119], v[126:127]
    v_pk_add_f32 v[154:155], v[98:99], v[114:115]
    v_pk_add_f32 v[156:157], v[100:101], v[116:117]
    v_pk_add_f32 v[158:159], v[102:103], v[118:119]
    v_mul_f32 v96, s68, v152
    v_mul_f32 v97, s68, v153
    v_mul_f32 v98, s68, v154
    v_mul_f32 v99, s68, v155
    v_mul_f32 v100, s68, v156
    v_mul_f32 v101, s68, v157
    v_mul_f32 v102, s68, v158
    v_mul_f32 v103, s68, v159
    v_exp_f32 v96, v96
    v_exp_f32 v97, v97
    v_exp_f32 v98, v98
    v_exp_f32 v99, v99
    v_exp_f32 v100, v100
    v_exp_f32 v101, v101
    v_exp_f32 v102, v102
    v_exp_f32 v103, v103
    v_pk_mul_f32 v[152:153], v[152:153], v[40:41]
    v_pk_mul_f32 v[154:155], v[154:155], v[42:43]
    v_pk_mul_f32 v[156:157], v[156:157], v[44:45]
    v_pk_mul_f32 v[158:159], v[158:159], v[46:47]
    v_fma_f32 v96, v96, s69, s69
    v_fma_f32 v97, v97, s69, s69
    v_fma_f32 v98, v98, s69, s69
    v_fma_f32 v99, v99, s69, s69
    v_fma_f32 v100, v100, s69, s69
    v_fma_f32 v101, v101, s69, s69
    v_fma_f32 v102, v102, s69, s69
    v_fma_f32 v103, v103, s69, s69
    v_rcp_f32 v96, v96
    v_rcp_f32 v97, v97
    v_rcp_f32 v98, v98
    v_rcp_f32 v99, v99
    v_rcp_f32 v100, v100
    v_rcp_f32 v101, v101
    v_rcp_f32 v102, v102
    v_rcp_f32 v103, v103
    v_pk_fma_f32 v[72:73], v[152:153], v[96:97], v[72:73]
    v_pk_fma_f32 v[74:75], v[154:155], v[98:99], v[74:75]
    v_pk_fma_f32 v[76:77], v[156:157], v[100:101], v[76:77]
    v_pk_fma_f32 v[78:79], v[158:159], v[102:103], v[78:79]
    v_cvt_pk_bf16_f32 v132, v72, v73
    v_cvt_pk_bf16_f32 v133, v74, v75
    v_cvt_pk_bf16_f32 v134, v76, v77
    v_cvt_pk_bf16_f32 v135, v78, v79
    buffer_store_dwordx4 v[132:135], v3, s[24:27], s63 offen sc1
L_gdone:
L_end:
    s_endpgm
L_slow_st:
    s_mov_b32 s93, 0
L_spin_st:
    buffer_load_dwordx4 v[144:147], v22, s[8:11], s76 offen sc1
    s_waitcnt vmcnt(0)
    v_cmp_ne_u64 vcc, s[86:87], v[146:147]
    s_nop 1
    s_cbranch_vccz L_back_st
    s_sleep 2
    s_add_u32 s93, s93, 1
    s_cmp_lt_u32 s93, 20000
    s_cbranch_scc1 L_spin_st
    s_branch L_back_st
L_slow_hf0:
    s_mov_b32 s93, 0
L_spin_hf0:
    buffer_load_dwordx2 v[158:159], v25, s[8:11], s28 offen sc1
    s_waitcnt vmcnt(0)
    v_cmp_ne_u64 vcc, s[86:87], v[158:159]
    s_nop 1
    s_cbranch_vccz L_back_hf0
    s_sleep 4
    s_add_u32 s93, s93, 1
    s_cmp_lt_u32 s93, 20000
    s_cbranch_scc1 L_spin_hf0
    s_branch L_back_hf0
L_slow_hf1:
    s_mov_b32 s93, 0
L_spin_hf1:
    buffer_load_dwordx2 v[158:159], v25, s[8:11], s29 offen sc1
    s_waitcnt vmcnt(0)
    v_cmp_ne_u64 vcc, s[86:87], v[158:159]
    s_nop 1
    s_cbranch_vccz L_back_hf1
    s_sleep 4
    s_add_u32 s93, s93, 1
    s_cmp_lt_u32 s93, 20000
    s_cbranch_scc1 L_spin_hf1
    s_branch L_back_hf1
L_slow_hf2:
    s_mov_b32 s93, 0
L_spin_hf2:
    buffer_load_dwordx2 v[158:159], v25, s[8:11], s80 offen sc1
    s_waitcnt vmcnt(0)
    v_cmp_ne_u64 vcc, s[86:87], v[158:159]
    s_nop 1
    s_cbranch_vccz L_back_hf2
    s_sleep 4
    s_add_u32 s93, s93, 1
    s_cmp_lt_u32 s93, 20000
    s_cbranch_scc1 L_spin_hf2
    s_branch L_back_hf2
L_slow_uf:
    s_mov_b32 s93, 0
L_spin_uf:
    buffer_load_dwordx2 v[22:23], v24, s[8:11], s92 offen offset:640 sc1
    s_waitcnt vmcnt(0)
    v_cmp_ne_u64 vcc, s[86:87], v[22:23]
    s_nop 1
    s_cbranch_vccz L_back_uf
    s_sleep 4
    s_add_u32 s93, s93, 1
    s_cmp_lt_u32 s93, 20000
    s_cbranch_scc1 L_spin_uf
    s_branch L_back_uf
L_slow_hf3:
    s_mov_b32 s93, 0
L_spin_hf3:
    buffer_load_dwordx2 v[158:159], v25, s[8:11], s89 offen sc1
    s_waitcnt vmcnt(0)
    v_cmp_ne_u64 vcc, s[86:87], v[158:159]
    s_nop 1
    s_cbranch_vccz L_back_hf3
    s_sleep 4
    s_add_u32 s93, s93, 1
    s_cmp_lt_u32 s93, 20000
    s_cbranch_scc1 L_spin_hf3
    s_branch L_back_hf3
.p2align 12
L_spec:
    s_lshl_b32 s78, s33, 12
    s_add_u32 s78, s78, 12582912
    s_lshl_b32 s73, s32, 7
    s_add_u32 s73, s73, s78
    s_mul_i32 s64, s34, 320
    s_cmp_eq_u32 s32, 0
    s_cselect_b32 s79, 0, 2130706432
    s_mov_b32 s14, 1314816
    s_mov_b32 s15, 0x20000
    s_mov_b32 s18, 1314816
    s_mov_b32 s19, 0x20000
    s_mul_i32 s65, s69, 655360
    s_add_u32 s65, s65, s64
    s_lshl_b32 s61, s69, 10
    s_add_u32 s61, s61, s73
    s_mul_i32 s66, s70, 655360
    s_add_u32 s66, s66, s64
    s_lshl_b32 s62, s70, 10
    s_add_u32 s62, s62, s73
    s_mul_i32 s67, s71, 655360
    s_add_u32 s67, s67, s64
    s_lshl_b32 s63, s71, 10
    s_add_u32 s63, s63, s73
    s_lshl_b32 s56, s34, 10
    s_add_u32 s73, s73, s56
    s_add_u32 s78, s78, s56
    s_lshl_b32 s58, s32, 3
    v_add_u32 v6, s58, v2
    v_mul_u32_u24 v6, 320, v6
    v_lshl_add_u32 v7, v3, 3, v6
    v_lshl_add_u32 v6, v3, 4, v6
    v_lshlrev_b32 v2, 4, v2
    v_lshl_add_u32 v9, v3, 28, v2
    s_mov_b32 s35, 0x3f803f80
    s_mov_b32 s72, 0xffff0000
    v_and_b32 v80, 31, v0
    s_lshl_b32 s58, s32, 5
    v_add_u32 v80, s58, v80
    v_lshrrev_b32 v81, 1, v80
    v_cmp_eq_u32 vcc, 1, v80
    v_and_b32 v82, 1, v80
    v_lshrrev_b32 v83, 5, v0
    v_cndmask_b32 v81, v81, 64, vcc
    v_cndmask_b32 v82, v82, 0, vcc
    v_cvt_f32_u32 v81, v81
    v_cvt_f32_u32 v82, v82
    v_mul_f32 v81, 0x3c000000, v81
    v_mul_f32 v82, 0xbe800000, v82
    v_lshlrev_b32 v83, 3, v83
    v_lshl_add_u32 v84, s68, 5, v83
    v_cvt_f32_u32 v84, v84
    v_fma_f32 v84, v81, v84, v82
    v_cos_f32 v16, v84
    v_fmamk_f32 v17, v81, 0x3f800000, v84
    v_fmamk_f32 v18, v81, 0x40000000, v84
    v_fmamk_f32 v19, v81, 0x40400000, v84
    v_fmamk_f32 v20, v81, 0x40800000, v84
    v_fmamk_f32 v21, v81, 0x40a00000, v84
    v_fmamk_f32 v22, v81, 0x40c00000, v84
    v_fmamk_f32 v23, v81, 0x40e00000, v84
    v_cos_f32 v17, v17
    v_cos_f32 v18, v18
    v_cos_f32 v19, v19
    v_cos_f32 v20, v20
    v_cos_f32 v21, v21
    v_cos_f32 v22, v22
    v_cos_f32 v23, v23
    v_cvt_pk_bf16_f32 v16, v16, v17
    v_cvt_pk_bf16_f32 v18, v18, v19
    v_cvt_pk_bf16_f32 v20, v20, v21
    v_cvt_pk_bf16_f32 v22, v22, v23
    v_accvgpr_write_b32 a200, v16
    v_accvgpr_write_b32 a201, v18
    v_accvgpr_write_b32 a202, v20
    v_accvgpr_write_b32 a203, v22
    v_fmamk_f32 v16, v81, 0x41800000, v84
    v_fmamk_f32 v17, v81, 0x41880000, v84
    v_fmamk_f32 v18, v81, 0x41900000, v84
    v_fmamk_f32 v19, v81, 0x41980000, v84
    v_fmamk_f32 v20, v81, 0x41a00000, v84
    v_fmamk_f32 v21, v81, 0x41a80000, v84
    v_fmamk_f32 v22, v81, 0x41b00000, v84
    v_fmamk_f32 v23, v81, 0x41b80000, v84
    v_cos_f32 v16, v16
    v_cos_f32 v17, v17
    v_cos_f32 v18, v18
    v_cos_f32 v19, v19
    v_cos_f32 v20, v20
    v_cos_f32 v21, v21
    v_cos_f32 v22, v22
    v_cos_f32 v23, v23
    v_cvt_pk_bf16_f32 v16, v16, v17
    v_cvt_pk_bf16_f32 v18, v18, v19
    v_cvt_pk_bf16_f32 v20, v20, v21
    v_cvt_pk_bf16_f32 v22, v22, v23
    v_accvgpr_write_b32 a204, v16
    v_accvgpr_write_b32 a205, v18
    v_accvgpr_write_b32 a206, v20
    v_accvgpr_write_b32 a207, v22
    v_lshl_add_u32 v84, s69, 5, v83
    v_cvt_f32_u32 v84, v84
    v_fma_f32 v84, v81, v84, v82
    v_cos_f32 v16, v84
    v_fmamk_f32 v17, v81, 0x3f800000, v84
    v_fmamk_f32 v18, v81, 0x40000000, v84
    v_fmamk_f32 v19, v81, 0x40400000, v84
    v_fmamk_f32 v20, v81, 0x40800000, v84
    v_fmamk_f32 v21, v81, 0x40a00000, v84
    v_fmamk_f32 v22, v81, 0x40c00000, v84
    v_fmamk_f32 v23, v81, 0x40e00000, v84
    v_cos_f32 v17, v17
    v_cos_f32 v18, v18
    v_cos_f32 v19, v19
    v_cos_f32 v20, v20
    v_cos_f32 v21, v21
    v_cos_f32 v22, v22
    v_cos_f32 v23, v23
    v_cvt_pk_bf16_f32 v16, v16, v17
    v_cvt_pk_bf16_f32 v18, v18, v19
    v_cvt_pk_bf16_f32 v20, v20, v21
    v_cvt_pk_bf16_f32 v22, v22, v23
    v_accvgpr_write_b32 a208, v16
    v_accvgpr_write_b32 a209, v18
    v_accvgpr_write_b32 a210, v20
    v_accvgpr_write_b32 a211, v22
    v_fmamk_f32 v16, v81, 0x41800000, v84
    v_fmamk_f32 v17, v81, 0x41880000, v84
    v_fmamk_f32 v18, v81, 0x41900000, v84
    v_fmamk_f32 v19, v81, 0x41980000, v84
    v_fmamk_f32 v20, v81, 0x41a00000, v84
    v_fmamk_f32 v21, v81, 0x41a80000, v84
    v_fmamk_f32 v22, v81, 0x41b00000, v84
    v_fmamk_f32 v23, v81, 0x41b80000, v84
    v_cos_f32 v16, v16
    v_cos_f32 v17, v17
    v_cos_f32 v18, v18
    v_cos_f32 v19, v19
    v_cos_f32 v20, v20
    v_cos_f32 v21, v21
    v_cos_f32 v22, v22
    v_cos_f32 v23, v23
    v_cvt_pk_bf16_f32 v16, v16, v17
    v_cvt_pk_bf16_f32 v18, v18, v19
    v_cvt_pk_bf16_f32 v20, v20, v21
    v_cvt_pk_bf16_f32 v22, v22, v23
    v_accvgpr_write_b32 a212, v16
    v_accvgpr_write_b32 a213, v18
    v_accvgpr_write_b32 a214, v20
    v_accvgpr_write_b32 a215, v22
    v_lshl_add_u32 v84, s70, 5, v83
    v_cvt_f32_u32 v84, v84
    v_fma_f32 v84, v81, v84, v82
    v_cos_f32 v16, v84
    v_fmamk_f32 v17, v81, 0x3f800000, v84
    v_fmamk_f32 v18, v81, 0x40000000, v84
    v_fmamk_f32 v19, v81, 0x40400000, v84
    v_fmamk_f32 v20, v81, 0x40800000, v84
    v_fmamk_f32 v21, v81, 0x40a00000, v84
    v_fmamk_f32 v22, v81, 0x40c00000, v84
    v_fmamk_f32 v23, v81, 0x40e00000, v84
    v_cos_f32 v17, v17
    v_cos_f32 v18, v18
    v_cos_f32 v19, v19
    v_cos_f32 v20, v20
    v_cos_f32 v21, v21
    v_cos_f32 v22, v22
    v_cos_f32 v23, v23
    v_cvt_pk_bf16_f32 v16, v16, v17
    v_cvt_pk_bf16_f32 v18, v18, v19
    v_cvt_pk_bf16_f32 v20, v20, v21
    v_cvt_pk_bf16_f32 v22, v22, v23
    v_accvgpr_write_b32 a216, v16
    v_accvgpr_write_b32 a217, v18
    v_accvgpr_write_b32 a218, v20
    v_accvgpr_write_b32 a219, v22
    v_fmamk_f32 v16, v81, 0x41800000, v84
    v_fmamk_f32 v17, v81, 0x41880000, v84
    v_fmamk_f32 v18, v81, 0x41900000, v84
    v_fmamk_f32 v19, v81, 0x41980000, v84
    v_fmamk_f32 v20, v81, 0x41a00000, v84
    v_fmamk_f32 v21, v81, 0x41a80000, v84
    v_fmamk_f32 v22, v81, 0x41b00000, v84
    v_fmamk_f32 v23, v81, 0x41b80000, v84
    v_cos_f32 v16, v16
    v_cos_f32 v17, v17
    v_cos_f32 v18, v18
    v_cos_f32 v19, v19
    v_cos_f32 v20, v20
    v_cos_f32 v21, v21
    v_cos_f32 v22, v22
    v_cos_f32 v23, v23
    v_cvt_pk_bf16_f32 v16, v16, v17
    v_cvt_pk_bf16_f32 v18, v18, v19
    v_cvt_pk_bf16_f32 v20, v20, v21
    v_cvt_pk_bf16_f32 v22, v22, v23
    v_accvgpr_write_b32 a220, v16
    v_accvgpr_write_b32 a221, v18
    v_accvgpr_write_b32 a222, v20
    v_accvgpr_write_b32 a223, v22
    v_lshl_add_u32 v84, s71, 5, v83
    v_cvt_f32_u32 v84, v84
    v_fma_f32 v84, v81, v84, v82
    v_cos_f32 v16, v84
    v_fmamk_f32 v17, v81, 0x3f800000, v84
    v_fmamk_f32 v18, v81, 0x40000000, v84
    v_fmamk_f32 v19, v81, 0x40400000, v84
    v_fmamk_f32 v20, v81, 0x40800000, v84
    v_fmamk_f32 v21, v81, 0x40a00000, v84
    v_fmamk_f32 v22, v81, 0x40c00000, v84
    v_fmamk_f32 v23, v81, 0x40e00000, v84
    v_cos_f32 v17, v17
    v_cos_f32 v18, v18
    v_cos_f32 v19, v19
    v_cos_f32 v20, v20
    v_cos_f32 v21, v21
    v_cos_f32 v22, v22
    v_cos_f32 v23, v23
    v_cvt_pk_bf16_f32 v16, v16, v17
    v_cvt_pk_bf16_f32 v18, v18, v19
    v_cvt_pk_bf16_f32 v20, v20, v21
    v_cvt_pk_bf16_f32 v22, v22, v23
    v_accvgpr_write_b32 a224, v16
    v_accvgpr_write_b32 a225, v18
    v_accvgpr_write_b32 a226, v20
    v_accvgpr_write_b32 a227, v22
    v_fmamk_f32 v16, v81, 0x41800000, v84
    v_fmamk_f32 v17, v81, 0x41880000, v84
    v_fmamk_f32 v18, v81, 0x41900000, v84
    v_fmamk_f32 v19, v81, 0x41980000, v84
    v_fmamk_f32 v20, v81, 0x41a00000, v84
    v_fmamk_f32 v21, v81, 0x41a80000, v84
    v_fmamk_f32 v22, v81, 0x41b00000, v84
    v_fmamk_f32 v23, v81, 0x41b80000, v84
    v_cos_f32 v16, v16
    v_cos_f32 v17, v17
    v_cos_f32 v18, v18
    v_cos_f32 v19, v19
    v_cos_f32 v20, v20
    v_cos_f32 v21, v21
    v_cos_f32 v22, v22
    v_cos_f32 v23, v23
    v_cvt_pk_bf16_f32 v16, v16, v17
    v_cvt_pk_bf16_f32 v18, v18, v19
    v_cvt_pk_bf16_f32 v20, v20, v21
    v_cvt_pk_bf16_f32 v22, v22, v23
    v_accvgpr_write_b32 a228, v16
    v_accvgpr_write_b32 a229, v18
    v_accvgpr_write_b32 a230, v20
    v_accvgpr_write_b32 a231, v22
    s_mov_b64 exec, 0
    s_cmp_eq_u32 s32, 0
    s_cbranch_scc1 L_spec_h0
    s_cmp_eq_u32 s32, 1
    s_cbranch_scc1 L_spec_h1
    s_cmp_eq_u32 s32, 2
    s_cbranch_scc1 L_spec_h2
    s_branch L_spec_h3
L_spec_hr:
    s_mov_b64 exec, -1
    v_bfe_u32 v8, v0, 2, 2
    v_add_u32 v8, v8, v83
    v_mul_u32_u24 v8, 320, v8
    v_bfe_u32 v10, v0, 4, 1
    v_lshl_add_u32 v8, v10, 5, v8
    v_and_b32 v10, 1, v0
    v_lshl_add_u32 v8, v10, 4, v8
    v_bfe_u32 v10, v0, 1, 1
    v_lshl_add_u32 v8, v10, 3, v8
    v_lshrrev_b32 v14, 4, v0
    v_lshlrev_b32 v14, 24, v14
    v_lshl_add_u32 v14, v0, 3, v14
    v_add_u32 v14, s79, v14
    s_cmp_eq_u32 s2, 0
    s_cselect_b32 s56, 64, s2
    s_lshl_b32 s57, s32, 10
    s_add_u32 s56, s56, s57
    s_sub_u32 s58, 4096, s57
    s_sub_u32 s58, s58, s2
    s_cmp_lt_u32 s32, 2
    s_cselect_b32 s56, s56, s58
    s_cselect_b32 s57, 1, -1
    s_lshl_b32 s57, s57, 7
    s_mul_i32 s90, s32, 5760
    s_add_u32 s90, s90, 82944
    v_cmp_gt_u32 vcc, 41, v0
    v_lshlrev_b32 v1, 4, v0
    v_mov_b32 v10, 2130706432
    v_cndmask_b32 v1, v10, v1, vcc
    s_mul_i32 s92, s2, 3840
    s_mul_i32 s3, s32, 491520
    s_add_u32 s92, s92, s3
    s_add_u32 s3, s92, 245760
    v_min_u32 v15, 29, v0
    v_lshlrev_b32 v15, 7, v15
    s_and_b32 s24, s56, 2047
    s_mul_i32 s24, s24, 642
    s_and_b32 s24, s24, -4
    s_add_u32 s56, s56, s57
    s_and_b32 s25, s56, 2047
    s_mul_i32 s25, s25, 642
    s_and_b32 s25, s25, -4
    s_add_u32 s56, s56, s57
    s_and_b32 s26, s56, 2047
    s_mul_i32 s26, s26, 642
    s_and_b32 s26, s26, -4
    s_add_u32 s56, s56, s57
    s_and_b32 s27, s56, 2047
    s_mul_i32 s27, s27, 642
    s_and_b32 s27, s27, -4
    s_add_u32 s56, s56, s57
    s_and_b32 s68, s56, 2047
    s_mul_i32 s68, s68, 642
    s_and_b32 s68, s68, -4
    s_add_u32 s56, s56, s57
    s_and_b32 s69, s56, 2047
    s_mul_i32 s69, s69, 642
    s_and_b32 s69, s69, -4
    s_add_u32 s56, s56, s57
    s_and_b32 s70, s56, 2047
    s_mul_i32 s70, s70, 642
    s_and_b32 s70, s70, -4
    s_add_u32 s56, s56, s57
    s_and_b32 s71, s56, 2047
    s_mul_i32 s71, s71, 642
    s_and_b32 s71, s71, -4
    s_add_u32 s56, s56, s57
    s_waitcnt lgkmcnt(0)
    s_add_u32 s86, s86, 0x9e3779b9
    s_add_u32 s87, s87, 0x7f4a7c15
    s_waitcnt vmcnt(11)
    v_dot2_f32_bf16 v10, s35, v106, 0
    v_dot2_f32_bf16 v11, v106, v106, 0
    v_dot2_f32_bf16 v12, s35, v107, 0
    v_dot2_f32_bf16 v13, v107, v107, 0
    v_dot2c_f32_bf16 v10, s35, v108
    v_dot2c_f32_bf16 v11, v108, v108
    v_dot2c_f32_bf16 v12, s35, v109
    v_dot2c_f32_bf16 v13, v109, v109
    s_waitcnt vmcnt(10)
    v_dot2c_f32_bf16 v10, s35, v110
    v_dot2c_f32_bf16 v11, v110, v110
    v_dot2c_f32_bf16 v12, s35, v111
    v_dot2c_f32_bf16 v13, v111, v111
    v_dot2c_f32_bf16 v10, s35, v112
    v_dot2c_f32_bf16 v11, v112, v112
    v_dot2c_f32_bf16 v12, s35, v113
    v_dot2c_f32_bf16 v13, v113, v113
    s_waitcnt vmcnt(9)
    v_dot2c_f32_bf16 v10, s35, v114
    v_dot2c_f32_bf16 v11, v114, v114
    v_dot2c_f32_bf16 v12, s35, v115
    v_dot2c_f32_bf16 v13, v115, v115
    s_waitcnt vmcnt(8)
    v_dot2c_f32_bf16 v10, s35, v116
    v_dot2c_f32_bf16 v11, v116, v116
    v_dot2c_f32_bf16 v12, s35, v117
    v_dot2c_f32_bf16 v13, v117, v117
    v_dot2c_f32_bf16 v10, s35, v118
    v_dot2c_f32_bf16 v11, v118, v118
    v_dot2c_f32_bf16 v12, s35, v119
    v_dot2c_f32_bf16 v13, v119, v119
    s_waitcnt vmcnt(7)
    v_dot2c_f32_bf16 v10, s35, v120
    v_dot2c_f32_bf16 v11, v120, v120
    v_dot2c_f32_bf16 v12, s35, v121
    v_dot2c_f32_bf16 v13, v121, v121
    v_dot2c_f32_bf16 v10, s35, v122
    v_dot2c_f32_bf16 v11, v122, v122
    v_dot2c_f32_bf16 v12, s35, v123
    v_dot2c_f32_bf16 v13, v123, v123
    s_waitcnt vmcnt(6)
    v_dot2c_f32_bf16 v10, s35, v124
    v_dot2c_f32_bf16 v11, v124, v124
    v_dot2c_f32_bf16 v12, s35, v125
    v_dot2c_f32_bf16 v13, v125, v125
    s_waitcnt vmcnt(5)
    v_dot2c_f32_bf16 v10, s35, v126
    v_dot2c_f32_bf16 v11, v126, v126
    v_dot2c_f32_bf16 v12, s35, v127
    v_dot2c_f32_bf16 v13, v127, v127
    v_dot2c_f32_bf16 v10, s35, v128
    v_dot2c_f32_bf16 v11, v128, v128
    v_dot2c_f32_bf16 v12, s35, v129
    v_dot2c_f32_bf16 v13, v129, v129
    s_waitcnt vmcnt(4)
    v_dot2c_f32_bf16 v10, s35, v130
    v_dot2c_f32_bf16 v11, v130, v130
    v_dot2c_f32_bf16 v12, s35, v131
    v_dot2c_f32_bf16 v13, v131, v131
    v_dot2c_f32_bf16 v10, s35, v132
    v_dot2c_f32_bf16 v11, v132, v132
    v_dot2c_f32_bf16 v12, s35, v133
    v_dot2c_f32_bf16 v13, v133, v133
    s_waitcnt vmcnt(3)
    v_dot2c_f32_bf16 v10, s35, v134
    v_dot2c_f32_bf16 v11, v134, v134
    v_dot2c_f32_bf16 v12, s35, v135
    v_dot2c_f32_bf16 v13, v135, v135
    s_waitcnt vmcnt(2)
    v_dot2c_f32_bf16 v10, s35, v96
    v_dot2c_f32_bf16 v11, v96, v96
    v_dot2c_f32_bf16 v12, s35, v97
    v_dot2c_f32_bf16 v13, v97, v97
    v_dot2c_f32_bf16 v10, s35, v98
    v_dot2c_f32_bf16 v11, v98, v98
    v_dot2c_f32_bf16 v12, s35, v99
    v_dot2c_f32_bf16 v13, v99, v99
    s_waitcnt vmcnt(1)
    v_dot2c_f32_bf16 v10, s35, v100
    v_dot2c_f32_bf16 v11, v100, v100
    v_dot2c_f32_bf16 v12, s35, v101
    v_dot2c_f32_bf16 v13, v101, v101
    v_dot2c_f32_bf16 v10, s35, v102
    v_dot2c_f32_bf16 v11, v102, v102
    v_dot2c_f32_bf16 v12, s35, v103
    v_dot2c_f32_bf16 v13, v103, v103
    s_waitcnt vmcnt(0)
    v_dot2c_f32_bf16 v10, s35, v104
    v_dot2c_f32_bf16 v11, v104, v104
    v_dot2c_f32_bf16 v12, s35, v105
    v_dot2c_f32_bf16 v13, v105, v105
    v_lshlrev_b32 v176, 16, v96
    v_and_b32 v177, s72, v96
    v_add_f32 v10, v10, v12
    v_add_f32 v11, v11, v13
    v_mov_b32 v12, s86
    v_mov_b32 v13, s87
    v_add_f32_dpp v10, v10, v10 quad_perm:[1,0,3,2] row_mask:0xf bank_mask:0xf
    v_add_f32_dpp v11, v11, v11 quad_perm:[1,0,3,2] row_mask:0xf bank_mask:0xf
    v_lshlrev_b32 v178, 16, v97
    v_add_f32_dpp v10, v10, v10 quad_perm:[2,3,0,1] row_mask:0xf bank_mask:0xf
    v_add_f32_dpp v11, v11, v11 quad_perm:[2,3,0,1] row_mask:0xf bank_mask:0xf
    v_and_b32 v179, s72, v97
    v_add_f32_dpp v10, v10, v10 row_half_mirror row_mask:0xf bank_mask:0xf
    v_add_f32_dpp v11, v11, v11 row_half_mirror row_mask:0xf bank_mask:0xf
    v_mul_f32 v10, 0x3acccccd, v10
    v_mul_f32 v11, 0x3acccccd, v11
    v_fma_f32 v11, -v10, v10, v11
    v_max_f32 v11, 0, v11
    v_add_f32 v11, 0x3727c5ac, v11
    v_rsq_f32 v11, v11
    s_mul_i32 s58, s32, 10240
    s_add_u32 s91, s58, 40960
    v_lshlrev_b32 v180, 16, v98
    s_mul_i32 s80, s32, 655360
    s_mul_i32 s81, s33, 2560
    v_and_b32 v181, s72, v98
    s_add_u32 s80, s80, s81
    s_add_u32 s80, s80, s64
    v_lshlrev_b32 v182, 16, v99
    s_add_u32 s80, s80, s64
    s_add_u32 s80, s80, 65536
    v_and_b32 v183, s72, v99
    s_add_u32 s81, s80, 327680
    buffer_store_dwordx4 v[10:13], v9, s[8:11], s73 offen sc1
    buffer_load_dwordx4 v[136:139], v4, s[4:7], s65 offen
    buffer_load_dwordx4 v[140:143], v4, s[4:7], s65 offen offset:128
    buffer_load_dwordx2 v[144:145], v5, s[4:7], s65 offen offset:256
    buffer_load_dwordx4 v[146:149], v4, s[4:7], s66 offen
    buffer_load_dwordx4 v[150:153], v4, s[4:7], s66 offen offset:128
    buffer_load_dwordx2 v[154:155], v5, s[4:7], s66 offen offset:256
    v_mul_f32_e64 v12, -v10, v11
    v_lshlrev_b32 v184, 16, v100
    v_and_b32 v185, s72, v100
    v_lshlrev_b32 v186, 16, v101
    v_and_b32 v187, s72, v101
    v_lshlrev_b32 v188, 16, v102
    v_and_b32 v189, s72, v102
    v_lshlrev_b32 v190, 16, v103
    v_and_b32 v191, s72, v103
    v_lshlrev_b32 v192, 16, v104
    v_and_b32 v193, s72, v104
    v_lshlrev_b32 v194, 16, v105
    v_and_b32 v195, s72, v105
    v_pk_fma_f32 v[176:177], v[176:177], v[10:11], v[12:13] op_sel:[0,1,0] op_sel_hi:[1,1,0]
    v_pk_fma_f32 v[178:179], v[178:179], v[10:11], v[12:13] op_sel:[0,1,0] op_sel_hi:[1,1,0]
    v_pk_fma_f32 v[180:181], v[180:181], v[10:11], v[12:13] op_sel:[0,1,0] op_sel_hi:[1,1,0]
    v_pk_fma_f32 v[182:183], v[182:183], v[10:11], v[12:13] op_sel:[0,1,0] op_sel_hi:[1,1,0]
    v_pk_fma_f32 v[184:185], v[184:185], v[10:11], v[12:13] op_sel:[0,1,0] op_sel_hi:[1,1,0]
    v_pk_fma_f32 v[186:187], v[186:187], v[10:11], v[12:13] op_sel:[0,1,0] op_sel_hi:[1,1,0]
    v_pk_fma_f32 v[188:189], v[188:189], v[10:11], v[12:13] op_sel:[0,1,0] op_sel_hi:[1,1,0]
    v_pk_fma_f32 v[190:191], v[190:191], v[10:11], v[12:13] op_sel:[0,1,0] op_sel_hi:[1,1,0]
    v_pk_fma_f32 v[192:193], v[192:193], v[10:11], v[12:13] op_sel:[0,1,0] op_sel_hi:[1,1,0]
    v_pk_fma_f32 v[194:195], v[194:195], v[10:11], v[12:13] op_sel:[0,1,0] op_sel_hi:[1,1,0]
    v_cvt_pk_bf16_f32 v96, v176, v177
    v_cvt_pk_bf16_f32 v97, v178, v179
    v_cvt_pk_bf16_f32 v98, v180, v181
    v_cvt_pk_bf16_f32 v99, v182, v183
    v_cvt_pk_bf16_f32 v100, v184, v185
    v_cvt_pk_bf16_f32 v101, v186, v187
    v_cvt_pk_bf16_f32 v102, v188, v189
    v_cvt_pk_bf16_f32 v103, v190, v191
    v_cvt_pk_bf16_f32 v104, v192, v193
    v_cvt_pk_bf16_f32 v105, v194, v195
    buffer_load_dwordx4 v[156:159], v4, s[4:7], s67 offen
    buffer_load_dwordx4 v[160:163], v4, s[4:7], s67 offen offset:128
    buffer_load_dwordx2 v[164:165], v5, s[4:7], s67 offen offset:256
    ds_write_b128 v6, v[96:99] offset:0
    ds_write_b64 v7, v[104:105] offset:256
    ds_write_b128 v6, v[100:103] offset:128
    v_and_b32 v120, 31, v0
    v_lshrrev_b32 v121, 5, v0
    v_bfe_u32 v122, v0, 1, 2
    v_xor_b32 v121, v121, v122
    v_lshlrev_b32 v121, 4, v121
    v_lshl_add_u32 v120, v120, 6, v121
    v_add_u32 v168, s91, v120
    v_xor_b32 v169, 32, v168
    v_lshl_add_u32 v170, v0, 4, s91
    v_lshrrev_b32 v120, 3, v0
    v_and_b32 v121, 3, v120
    v_and_b32 v122, 3, v0
    v_xor_b32 v121, v121, v122
    v_lshlrev_b32 v121, 4, v121
    v_mul_u32_u24 v120, 40960, v120
    v_bfe_u32 v122, v0, 2, 1
    v_lshlrev_b32 v122, 6, v122
    v_add3_u32 v171, v120, v121, v122
    buffer_load_dword a254, v15, s[20:23], s92 offen
    s_and_b32 s56, s32, 1
    s_cmp_eq_u32 s56, 0
    s_cselect_b32 s57, 31, 7
    s_cselect_b32 s59, 32, 8
    s_cselect_b32 s74, -1.0, 1.0
    s_cselect_b32 s75, 16, 0
    s_lshl_b32 s58, s56, 5
    v_and_b32 v68, s57, v0
    v_add_u32 v68, s58, v68
    v_and_b32 v69, 31, v0
    v_cmp_gt_u32 s[84:85], s59, v69
    s_mul_i32 s58, s32, 3072
    s_add_u32 s58, s58, 135168
    v_lshl_add_u32 v76, v0, 4, s58
    s_cmp_eq_u32 s2, 0
    s_cselect_b32 s76, 64, s2
    s_cselect_b32 s77, 0, 0x3e800000
    s_cselect_b64 s[82:83], 0, -1
    s_mov_b32 s88, 0x80008000
    s_lshl_b32 s75, 0xffff, s75
    s_or_b32 s75, s75, s82
    s_cmp_eq_u32 s56, 0
    s_cselect_b32 s57, s76, s2
    s_lshl_b32 s58, s56, 3
    v_lshrrev_b32 v69, 5, v0
    v_cvt_f32_u32 v69, v69
    v_mov_b32 v34, 0
    v_mov_b32 v35, 0
    s_cmp_ge_u32 s32, 2
    s_cbranch_scc1 L_cinv
    v_lshrrev_b32 v70, 1, v68
    v_and_b32 v71, 1, v68
    v_cmp_eq_u32 vcc, 1, v68
    s_nop 1
    v_cndmask_b32 v70, v70, 20, vcc
    v_cndmask_b32 v71, v71, 0, vcc
    v_cvt_f32_u32 v70, v70
    v_cvt_f32_u32 v71, v71
    v_mul_f32 v70, 0x3ccccccd, v70
    v_mul_f32 v71, 0xbe800000, v71
    v_fma_f32 v72, v70, v69, v71
    v_cos_f32 v16, v72
    v_fmamk_f32 v17, v70, 0x41200000, v72
    v_fmamk_f32 v18, v70, 0x41a00000, v72
    v_fmamk_f32 v19, v70, 0x41f00000, v72
    v_fmamk_f32 v20, v70, 0x40000000, v72
    v_fmamk_f32 v21, v70, 0x41400000, v72
    v_fmamk_f32 v22, v70, 0x41b00000, v72
    v_fmamk_f32 v23, v70, 0x42000000, v72
    v_cos_f32 v17, v17
    v_cos_f32 v18, v18
    v_cos_f32 v19, v19
    v_cos_f32 v20, v20
    v_cos_f32 v21, v21
    v_cos_f32 v22, v22
    v_cos_f32 v23, v23
    v_cvt_pk_bf16_f32 v24, v16, v17
    v_cvt_pk_bf16_f32 v25, v18, v19
    v_cvt_pk_bf16_f32 v26, v20, v21
    v_cvt_pk_bf16_f32 v27, v22, v23
    v_fmamk_f32 v16, v70, 0x40800000, v72
    v_fmamk_f32 v17, v70, 0x41600000, v72
    v_fmamk_f32 v18, v70, 0x41c00000, v72
    v_fmamk_f32 v19, v70, 0x42080000, v72
    v_fmamk_f32 v20, v70, 0x40c00000, v72
    v_fmamk_f32 v21, v70, 0x41800000, v72
    v_fmamk_f32 v22, v70, 0x41d00000, v72
    v_fmamk_f32 v23, v70, 0x42100000, v72
    v_cos_f32 v16, v16
    v_cos_f32 v17, v17
    v_cos_f32 v18, v18
    v_cos_f32 v19, v19
    v_cos_f32 v20, v20
    v_cos_f32 v21, v21
    v_cos_f32 v22, v22
    v_cos_f32 v23, v23
    v_cvt_pk_bf16_f32 v28, v16, v17
    v_cvt_pk_bf16_f32 v29, v18, v19
    v_cvt_pk_bf16_f32 v30, v20, v21
    v_cvt_pk_bf16_f32 v31, v22, v23
    v_fmamk_f32 v16, v70, 0x41000000, v72
    v_fmamk_f32 v17, v70, 0x41900000, v72
    v_fmamk_f32 v18, v70, 0x41e00000, v72
    v_fmamk_f32 v19, v70, 0x42180000, v72
    v_cos_f32 v16, v16
    v_cos_f32 v17, v17
    v_cos_f32 v18, v18
    v_cos_f32 v19, v19
    v_cvt_pk_bf16_f32 v32, v16, v17
    v_cvt_pk_bf16_f32 v33, v18, v19
    v_and_b32 v70, 15, v0
    v_lshrrev_b32 v71, 4, v0
    v_cvt_f32_u32 v71, v71
    v_lshl_add_u32 v70, v70, 7, s57
    v_cvt_f32_u32 v70, v70
    v_mul_f32 v70, 0x3a000000, v70
    v_mul_f32 v71, v70, v71
    v_add_f32 v71, v71, v71
    v_add_f32 v72, s77, v71
    v_mul_f32 v70, s74, v70
    v_mul_f32 v71, s74, v71
    v_mul_f32 v72, s74, v72
    v_fmamk_f32 v45, v70, 0x3f800000, v71
    v_fmamk_f32 v46, v70, 0x41000000, v71
    v_fmamk_f32 v47, v70, 0x41100000, v71
    v_cos_f32 v40, v71
    v_sin_f32 v44, v71
    v_cos_f32 v41, v45
    v_sin_f32 v45, v45
    v_cos_f32 v42, v46
    v_sin_f32 v46, v46
    v_cos_f32 v43, v47
    v_sin_f32 v47, v47
    v_fmamk_f32 v53, v70, 0x3f800000, v72
    v_fmamk_f32 v54, v70, 0x41000000, v72
    v_fmamk_f32 v55, v70, 0x41100000, v72
    v_cos_f32 v48, v72
    v_sin_f32 v52, v72
    v_cos_f32 v49, v53
    v_sin_f32 v53, v53
    v_cos_f32 v50, v54
    v_sin_f32 v54, v54
    v_cos_f32 v51, v55
    v_sin_f32 v55, v55
    v_cvt_pk_bf16_f32 v56, v40, v48
    v_cvt_pk_bf16_f32 v60, v44, v52
    v_cvt_pk_bf16_f32 v57, v41, v49
    v_cvt_pk_bf16_f32 v61, v45, v53
    v_cvt_pk_bf16_f32 v58, v42, v50
    v_cvt_pk_bf16_f32 v62, v46, v54
    v_cvt_pk_bf16_f32 v59, v43, v51
    v_cvt_pk_bf16_f32 v63, v47, v55
    v_and_b32 v56, s75, v56
    v_and_b32 v57, s75, v57
    v_and_b32 v58, s75, v58
    v_and_b32 v59, s75, v59
    v_and_b32 v60, s75, v60
    v_and_b32 v61, s75, v61
    v_and_b32 v62, s75, v62
    v_and_b32 v63, s75, v63
    s_branch L_cjoin
L_cinv:
    v_cvt_f32_u32 v70, v68
    v_mul_f32 v71, 0.5, v70
    v_cos_f32 v71, v71
    v_mul_f32 v70, 0x3ccccccd, v70
    v_mul_f32 v73, v70, v69
    v_add_f32 v73, v73, v73
    v_add_f32 v72, v73, v73
    v_cmp_gt_u32 vcc, 32, v0
    v_fmamk_f32 v21, v70, 0x3f800000, v72
    v_fmamk_f32 v22, v70, 0x40000000, v72
    v_fmamk_f32 v23, v70, 0x40400000, v72
    v_cos_f32 v16, v72
    v_sin_f32 v20, v72
    v_cos_f32 v17, v21
    v_sin_f32 v21, v21
    v_cos_f32 v18, v22
    v_sin_f32 v22, v22
    v_cos_f32 v19, v23
    v_sin_f32 v23, v23
    v_cndmask_b32 v20, v20, v71, vcc
    v_cvt_pk_bf16_f32 v24, v16, v20
    v_cvt_pk_bf16_f32 v25, v17, v21
    v_cvt_pk_bf16_f32 v26, v18, v22
    v_cvt_pk_bf16_f32 v27, v19, v23
    v_fmamk_f32 v20, v70, 0x41000000, v72
    v_fmamk_f32 v21, v70, 0x41100000, v72
    v_fmamk_f32 v22, v70, 0x41200000, v72
    v_fmamk_f32 v23, v70, 0x41300000, v72
    v_cos_f32 v16, v20
    v_sin_f32 v20, v20
    v_cos_f32 v17, v21
    v_sin_f32 v21, v21
    v_cos_f32 v18, v22
    v_sin_f32 v22, v22
    v_cos_f32 v19, v23
    v_sin_f32 v23, v23
    v_cvt_pk_bf16_f32 v28, v16, v20
    v_cvt_pk_bf16_f32 v29, v17, v21
    v_cvt_pk_bf16_f32 v30, v18, v22
    v_cvt_pk_bf16_f32 v31, v19, v23
    v_fmamk_f32 v18, v70, 0x41800000, v73
    v_fmamk_f32 v19, v70, 0x41880000, v73
    v_cos_f32 v16, v18
    v_sin_f32 v18, v18
    v_cos_f32 v17, v19
    v_sin_f32 v19, v19
    v_cvt_pk_bf16_f32 v32, v16, v18
    v_cvt_pk_bf16_f32 v33, v17, v19
L_spec_h0:
    s_cbranch_execz L_spec_hr
    v_and_b32 v73, 1, v0
    v_cmp_eq_u32 vcc, 1, v73
    s_or_b64 s[28:29], vcc, s[82:83]
    s_orn2_b64 s[30:31], s[82:83], vcc
    v_cvt_f32_u32 v73, v73
    v_mul_f32 v73, s77, v73
    v_lshrrev_b32 v69, 4, v0
    v_lshl_add_u32 v74, v69, 9, s76
    v_lshl_add_u32 v75, v69, 9, s2
    v_cvt_f32_u32 v74, v74
    v_cvt_f32_u32 v75, v75
    v_mul_f32 v74, 0x3c000000, v74
    v_mul_f32 v75, 0x3c000000, v75
    v_bfe_u32 v70, v0, 1, 3
    v_add_u32 v70, s58, v70
    v_cvt_f32_u32 v70, v70
    v_mul_f32 v71, 0x3d800000, v70
    v_mul_f32 v70, 0xbd800000, v70
    v_fma_f32 v72, v70, v74, -v73
    v_fma_f32 v68, v71, v75, v73
    v_fmamk_f32 v45, v70, 0x3f800000, v72
    v_fmamk_f32 v46, v70, 0x40000000, v72
    v_fmamk_f32 v47, v70, 0x40400000, v72
    v_cos_f32 v40, v72
    v_sin_f32 v44, v72
    v_cos_f32 v41, v45
    v_sin_f32 v45, v45
    v_cos_f32 v42, v46
    v_sin_f32 v46, v46
    v_cos_f32 v43, v47
    v_sin_f32 v47, v47
    v_fmamk_f32 v53, v71, 0x3f800000, v68
    v_fmamk_f32 v54, v71, 0x40000000, v68
    v_fmamk_f32 v55, v71, 0x40400000, v68
    v_cos_f32 v48, v68
    v_sin_f32 v52, v68
    v_cos_f32 v49, v53
    v_sin_f32 v53, v53
    v_cos_f32 v50, v54
    v_sin_f32 v54, v54
    v_cos_f32 v51, v55
    v_sin_f32 v55, v55
    v_cvt_pk_bf16_f32 v56, v40, v41
    v_cvt_pk_bf16_f32 v60, v44, v45
    v_cvt_pk_bf16_f32 v57, v42, v43
    v_cvt_pk_bf16_f32 v61, v46, v47
    v_cvt_pk_bf16_f32 v58, v48, v49
    v_cvt_pk_bf16_f32 v62, v52, v53
    v_cvt_pk_bf16_f32 v59, v50, v51
    v_cvt_pk_bf16_f32 v63, v54, v55
    v_cndmask_b32 v56, 0, v56, s[28:29]
    v_cndmask_b32 v57, 0, v57, s[28:29]
    v_cndmask_b32 v58, 0, v58, s[30:31]
    v_cndmask_b32 v59, 0, v59, s[30:31]
    v_cndmask_b32 v60, 0, v60, s[28:29]
    v_cndmask_b32 v61, 0, v61, s[28:29]
    v_cndmask_b32 v62, 0, v62, s[30:31]
    v_cndmask_b32 v63, 0, v63, s[30:31]
L_cjoin:
    v_cndmask_b32 v24, 0, v24, s[84:85]
    v_cndmask_b32 v25, 0, v25, s[84:85]
    v_cndmask_b32 v26, 0, v26, s[84:85]
    v_cndmask_b32 v27, 0, v27, s[84:85]
    v_cndmask_b32 v28, 0, v28, s[84:85]
    v_cndmask_b32 v29, 0, v29, s[84:85]
    v_cndmask_b32 v30, 0, v30, s[84:85]
    v_cndmask_b32 v31, 0, v31, s[84:85]
    v_cndmask_b32 v32, 0, v32, s[84:85]
    v_cndmask_b32 v33, 0, v33, s[84:85]
    v_xor_b32 v64, s88, v60
    v_xor_b32 v65, s88, v61
    v_xor_b32 v66, s88, v62
    v_xor_b32 v67, s88, v63
    ds_write_b128 v76, v[24:27] offset:0
    ds_write_b128 v76, v[56:59] offset:12288
    ds_write_b128 v76, v[28:31] offset:1024
    ds_write_b128 v76, v[60:63] offset:13312
    ds_write_b128 v76, v[32:35] offset:2048
    ds_write_b128 v76, v[64:67] offset:14336
    s_mul_i32 s74, s32, 5
    s_cmp_eq_u32 s32, 0
    s_cselect_b32 s75, 20, s74
    s_cselect_b32 s84, 0, 0x3e800000
    s_cselect_b64 s[30:31], 0, -1
    s_waitcnt vmcnt(9)
    v_lshlrev_b32 v196, 16, v136
    v_and_b32 v197, s72, v136
    v_lshlrev_b32 v198, 16, v137
    v_and_b32 v199, s72, v137
    v_lshlrev_b32 v200, 16, v138
    v_and_b32 v201, s72, v138
    v_lshlrev_b32 v202, 16, v139
    v_and_b32 v203, s72, v139
    s_waitcnt vmcnt(8)
    v_lshlrev_b32 v204, 16, v140
    v_and_b32 v205, s72, v140
    v_lshlrev_b32 v206, 16, v141
    v_and_b32 v207, s72, v141
    v_lshlrev_b32 v208, 16, v142
    v_and_b32 v209, s72, v142
    v_lshlrev_b32 v210, 16, v143
    v_and_b32 v211, s72, v143
    s_waitcnt vmcnt(7)
    v_lshlrev_b32 v212, 16, v144
    v_and_b32 v213, s72, v144
    v_lshlrev_b32 v214, 16, v145
    v_and_b32 v215, s72, v145
    s_waitcnt vmcnt(6)
    v_lshlrev_b32 v216, 16, v146
    v_and_b32 v217, s72, v146
    v_lshlrev_b32 v218, 16, v147
    v_and_b32 v219, s72, v147
    v_lshlrev_b32 v220, 16, v148
    v_and_b32 v221, s72, v148
    v_lshlrev_b32 v222, 16, v149
    v_and_b32 v223, s72, v149
    s_waitcnt vmcnt(5)
    v_lshlrev_b32 v224, 16, v150
    v_and_b32 v225, s72, v150
    v_lshlrev_b32 v226, 16, v151
    v_and_b32 v227, s72, v151
    v_lshlrev_b32 v228, 16, v152
    v_and_b32 v229, s72, v152
    v_lshlrev_b32 v230, 16, v153
    v_and_b32 v231, s72, v153
    s_waitcnt vmcnt(4)
    v_lshlrev_b32 v232, 16, v154
    v_and_b32 v233, s72, v154
    v_lshlrev_b32 v234, 16, v155
    v_and_b32 v235, s72, v155
    s_waitcnt vmcnt(3)
    v_lshlrev_b32 v236, 16, v156
    v_and_b32 v237, s72, v156
    v_lshlrev_b32 v238, 16, v157
    v_and_b32 v239, s72, v157
    v_lshlrev_b32 v240, 16, v158
    v_and_b32 v241, s72, v158
    v_lshlrev_b32 v242, 16, v159
    v_and_b32 v243, s72, v159
    s_and_b32 s76, s2, 1
    s_lshl_b32 s76, s76, 1
    s_waitcnt vmcnt(2)
    v_lshlrev_b32 v244, 16, v160
    s_add_u32 s76, s76, 82944
    s_lshl_b32 s77, s2, 10
    v_and_b32 v245, s72, v160
    s_add_u32 s77, s77, 12582912
    buffer_load_dwordx4 v[108:111], v2, s[8:11], s61 offen sc1
    buffer_load_dwordx4 v[112:115], v2, s[8:11], s62 offen sc1
    buffer_load_dwordx4 v[116:119], v2, s[8:11], s63 offen sc1
    v_lshlrev_b32 v246, 16, v161
    v_and_b32 v247, s72, v161
    v_lshlrev_b32 v248, 16, v162
    v_and_b32 v249, s72, v162
    v_lshlrev_b32 v250, 16, v163
    v_and_b32 v251, s72, v163
    s_waitcnt vmcnt(4)
    v_lshlrev_b32 v252, 16, v164
    v_and_b32 v253, s72, v164
    v_lshlrev_b32 v254, 16, v165
    v_and_b32 v255, s72, v165
    v_and_b32 v3, 15, v0
    v_cmp_gt_u32 s[28:29], 8, v3
    v_mul_u32_u24 v4, 40, v3
    v_subrev_u32 v5, 280, v4
    v_subrev_u32 v5, s74, v5
    v_add_u32 v10, s75, v4
    v_add_u32 v4, s74, v4
    v_cndmask_b32 v106, v5, v10, s[28:29]
    v_cndmask_b32 v107, v5, v4, s[28:29]
    v_cndmask_b32 v96, -2, 2, s[28:29]
    v_lshrrev_b32 v4, 5, v0
    v_mul_u32_u24 v3, 5760, v4
    v_bfe_u32 v10, v0, 4, 1
    v_mul_u32_u24 v11, 2696, v10
    v_add3_u32 v3, v3, v11, s76
    v_lshl_add_u32 v97, v106, 1, v3
    v_lshl_add_u32 v98, v107, 1, v3
    v_add_u32 v98, v98, v96
    v_add_u32 v99, v98, v96
    v_add_u32 v100, v99, v96
    v_add_u32 v101, v100, v96
    v_cndmask_b32 v123, -1.0, 1.0, s[28:29]
    v_cvt_f32_u32 v124, v106
    v_cvt_f32_u32 v125, v107
    v_cmp_eq_u32 vcc, 1, v4
    s_xnor_b64 s[28:29], vcc, s[28:29]
    s_or_b64 s[28:29], s[28:29], s[30:31]
    v_cvt_f32_u32 v126, v4
    v_mul_f32_e64 v126, v126, -v123
    v_lshlrev_b32 v127, 3, v10
    v_cvt_f32_u32 v127, v127
    v_lshrrev_b32 v104, 2, v0
    v_lshlrev_b32 v104, 4, v104
    v_and_b32 v105, 3, v0
    v_lshl_add_u32 v104, v105, 8, v104
    v_add_u32 v104, s91, v104
    v_cmp_eq_u32 vcc, 320, v106
    v_mov_b32 v120, v14
    v_and_b32 v121, 15, v0
    v_cndmask_b32 v102, 1.0, 0.5, vcc
    v_lshlrev_b32 v121, 10, v121
    s_add_u32 m0, s90, 0
    s_nop 0
    buffer_load_dwordx4 v1, s[12:15], s24 offen lds
    s_add_u32 m0, s90, 672
    s_nop 0
    buffer_load_dwordx4 v1, s[12:15], s25 offen lds
    s_add_u32 m0, s90, 1344
    s_nop 0
    buffer_load_dwordx4 v1, s[12:15], s26 offen lds
    s_add_u32 m0, s90, 2016
    s_nop 0
    buffer_load_dwordx4 v1, s[12:15], s27 offen lds
    v_mov_b32 v12, s86
    v_mov_b32 v13, s87
    v_subrev_u32 v172, 0, v0
    v_and_b32 v172, 31, v172
    v_and_or_b32 v172, v0, 32, v172
    v_lshlrev_b32 v172, 4, v172
    v_add_u32 v172, 135168, v172
    v_subrev_u32 v173, 8, v0
    v_and_b32 v173, 31, v173
    v_and_or_b32 v173, v0, 32, v173
    v_lshlrev_b32 v173, 4, v173
    v_add_u32 v173, 135168, v173
    v_subrev_u32 v174, 16, v0
    v_and_b32 v174, 31, v174
    v_and_or_b32 v174, v0, 32, v174
    v_lshlrev_b32 v174, 4, v174
    v_add_u32 v174, 135168, v174
    v_subrev_u32 v175, 24, v0
    v_and_b32 v175, 31, v175
    v_and_or_b32 v175, v0, 32, v175
    v_lshlrev_b32 v175, 4, v175
    v_add_u32 v175, 135168, v175
    v_mul_f32 v128, 0xbacccccd, v124
    v_mul_f32 v129, s84, v126
    v_fma_f32 v129, v128, v127, v129
    v_fmamk_f32 v25, v128, 0x3f800000, v129
    v_fmamk_f32 v26, v128, 0x40000000, v129
    v_fmamk_f32 v27, v128, 0x40400000, v129
    v_fmamk_f32 v28, v128, 0x40800000, v129
    v_fmamk_f32 v29, v128, 0x40a00000, v129
    v_fmamk_f32 v30, v128, 0x40c00000, v129
    v_fmamk_f32 v31, v128, 0x40e00000, v129
    v_cos_f32 v16, v129
    v_sin_f32 v24, v129
    v_cos_f32 v17, v25
    v_sin_f32 v25, v25
    v_cos_f32 v18, v26
    v_sin_f32 v26, v26
    v_cos_f32 v19, v27
    s_add_u32 m0, s90, 2696
    s_nop 0
    buffer_load_dwordx4 v1, s[12:15], s68 offen lds
    s_add_u32 m0, s90, 3368
    s_nop 0
    buffer_load_dwordx4 v1, s[12:15], s69 offen lds
    s_add_u32 m0, s90, 4040
    s_nop 0
    buffer_load_dwordx4 v1, s[12:15], s70 offen lds
    s_add_u32 m0, s90, 4712
    s_nop 0
    buffer_load_dwordx4 v1, s[12:15], s71 offen lds
    v_sin_f32 v27, v27
    v_cos_f32 v20, v28
    v_sin_f32 v28, v28
    v_cos_f32 v21, v29
    v_sin_f32 v29, v29
    v_cos_f32 v22, v30
    v_sin_f32 v30, v30
    v_cos_f32 v23, v31
    v_sin_f32 v31, v31
    v_cvt_pk_bf16_f32 v16, v16, v17
    v_cvt_pk_bf16_f32 v17, v18, v19
    v_cvt_pk_bf16_f32 v18, v20, v21
    v_cvt_pk_bf16_f32 v19, v22, v23
    v_cvt_pk_bf16_f32 v20, v24, v25
    v_cvt_pk_bf16_f32 v21, v26, v27
    v_cvt_pk_bf16_f32 v22, v28, v29
    v_cvt_pk_bf16_f32 v23, v30, v31
    v_cndmask_b32 v16, 0, v16, s[28:29]
    v_cndmask_b32 v17, 0, v17, s[28:29]
    v_cndmask_b32 v18, 0, v18, s[28:29]
    v_cndmask_b32 v19, 0, v19, s[28:29]
    v_cndmask_b32 v20, 0, v20, s[28:29]
    v_cndmask_b32 v21, 0, v21, s[28:29]
    v_cndmask_b32 v22, 0, v22, s[28:29]
    v_cndmask_b32 v23, 0, v23, s[28:29]
    ds_write_b128 v170, v[16:19] offset:0
    ds_write_b128 v170, v[20:23] offset:1024
    ds_read_b128 a[60:63], v170 offset:0
    ds_read_b128 a[64:67], v170 offset:1024
    ds_read_b64_tr_b16 a[148:149], v104 offset:0
    ds_read_b64_tr_b16 a[150:151], v104 offset:1024
    ds_read_b64_tr_b16 a[152:153], v104 offset:8
    ds_read_b64_tr_b16 a[154:155], v104 offset:1032
    s_waitcnt vmcnt(10)
    v_cmp_ne_u64 vcc, s[86:87], v[110:111]
    s_waitcnt vmcnt(9)
    v_cmp_ne_u64 s[56:57], s[86:87], v[114:115]
    s_waitcnt vmcnt(8)
    v_cmp_ne_u64 s[58:59], s[86:87], v[118:119]
    s_or_b64 vcc, vcc, s[56:57]
    s_or_b64 vcc, vcc, s[58:59]
    s_cbranch_vccnz L_slow_ns
L_back_ns:
    v_mul_f32_e64 v110, -v108, v109
    v_pk_fma_f32 v[196:197], v[196:197], v[108:109], v[110:111] op_sel:[0,1,0] op_sel_hi:[1,1,0]
    v_pk_fma_f32 v[198:199], v[198:199], v[108:109], v[110:111] op_sel:[0,1,0] op_sel_hi:[1,1,0]
    v_pk_fma_f32 v[200:201], v[200:201], v[108:109], v[110:111] op_sel:[0,1,0] op_sel_hi:[1,1,0]
    v_pk_fma_f32 v[202:203], v[202:203], v[108:109], v[110:111] op_sel:[0,1,0] op_sel_hi:[1,1,0]
    v_pk_fma_f32 v[204:205], v[204:205], v[108:109], v[110:111] op_sel:[0,1,0] op_sel_hi:[1,1,0]
    v_pk_fma_f32 v[206:207], v[206:207], v[108:109], v[110:111] op_sel:[0,1,0] op_sel_hi:[1,1,0]
    v_pk_fma_f32 v[208:209], v[208:209], v[108:109], v[110:111] op_sel:[0,1,0] op_sel_hi:[1,1,0]
    v_pk_fma_f32 v[210:211], v[210:211], v[108:109], v[110:111] op_sel:[0,1,0] op_sel_hi:[1,1,0]
    v_pk_fma_f32 v[212:213], v[212:213], v[108:109], v[110:111] op_sel:[0,1,0] op_sel_hi:[1,1,0]
    v_pk_fma_f32 v[214:215], v[214:215], v[108:109], v[110:111] op_sel:[0,1,0] op_sel_hi:[1,1,0]
    v_cvt_pk_bf16_f32 v136, v196, v197
    v_cvt_pk_bf16_f32 v137, v198, v199
    v_cvt_pk_bf16_f32 v138, v200, v201
    v_cvt_pk_bf16_f32 v139, v202, v203
    v_cvt_pk_bf16_f32 v140, v204, v205
    v_cvt_pk_bf16_f32 v141, v206, v207
    v_cvt_pk_bf16_f32 v142, v208, v209
    v_cvt_pk_bf16_f32 v143, v210, v211
    v_cvt_pk_bf16_f32 v144, v212, v213
    v_cvt_pk_bf16_f32 v145, v214, v215
    ds_write_b128 v6, v[136:139] offset:10240
    ds_write_b64 v7, v[144:145] offset:10496
    ds_write_b128 v6, v[140:143] offset:10368
    v_mul_f32_e64 v114, -v112, v113
    v_pk_fma_f32 v[216:217], v[216:217], v[112:113], v[114:115] op_sel:[0,1,0] op_sel_hi:[1,1,0]
    v_pk_fma_f32 v[218:219], v[218:219], v[112:113], v[114:115] op_sel:[0,1,0] op_sel_hi:[1,1,0]
    v_pk_fma_f32 v[220:221], v[220:221], v[112:113], v[114:115] op_sel:[0,1,0] op_sel_hi:[1,1,0]
    v_pk_fma_f32 v[222:223], v[222:223], v[112:113], v[114:115] op_sel:[0,1,0] op_sel_hi:[1,1,0]
    v_pk_fma_f32 v[224:225], v[224:225], v[112:113], v[114:115] op_sel:[0,1,0] op_sel_hi:[1,1,0]
    v_pk_fma_f32 v[226:227], v[226:227], v[112:113], v[114:115] op_sel:[0,1,0] op_sel_hi:[1,1,0]
    v_pk_fma_f32 v[228:229], v[228:229], v[112:113], v[114:115] op_sel:[0,1,0] op_sel_hi:[1,1,0]
    v_pk_fma_f32 v[230:231], v[230:231], v[112:113], v[114:115] op_sel:[0,1,0] op_sel_hi:[1,1,0]
    v_pk_fma_f32 v[232:233], v[232:233], v[112:113], v[114:115] op_sel:[0,1,0] op_sel_hi:[1,1,0]
    v_pk_fma_f32 v[234:235], v[234:235], v[112:113], v[114:115] op_sel:[0,1,0] op_sel_hi:[1,1,0]
    v_cvt_pk_bf16_f32 v146, v216, v217
    v_cvt_pk_bf16_f32 v147, v218, v219
    v_cvt_pk_bf16_f32 v148, v220, v221
    v_cvt_pk_bf16_f32 v149, v222, v223
    v_cvt_pk_bf16_f32 v150, v224, v225
    v_cvt_pk_bf16_f32 v151, v226, v227
    v_cvt_pk_bf16_f32 v152, v228, v229
    v_cvt_pk_bf16_f32 v153, v230, v231
    v_cvt_pk_bf16_f32 v154, v232, v233
    v_cvt_pk_bf16_f32 v155, v234, v235
    ds_write_b128 v6, v[146:149] offset:20480
    ds_write_b64 v7, v[154:155] offset:20736
    ds_write_b128 v6, v[150:153] offset:20608
    v_mul_f32_e64 v118, -v116, v117
    v_pk_fma_f32 v[236:237], v[236:237], v[116:117], v[118:119] op_sel:[0,1,0] op_sel_hi:[1,1,0]
    v_pk_fma_f32 v[238:239], v[238:239], v[116:117], v[118:119] op_sel:[0,1,0] op_sel_hi:[1,1,0]
    v_pk_fma_f32 v[240:241], v[240:241], v[116:117], v[118:119] op_sel:[0,1,0] op_sel_hi:[1,1,0]
    v_pk_fma_f32 v[242:243], v[242:243], v[116:117], v[118:119] op_sel:[0,1,0] op_sel_hi:[1,1,0]
    v_pk_fma_f32 v[244:245], v[244:245], v[116:117], v[118:119] op_sel:[0,1,0] op_sel_hi:[1,1,0]
    v_pk_fma_f32 v[246:247], v[246:247], v[116:117], v[118:119] op_sel:[0,1,0] op_sel_hi:[1,1,0]
    v_pk_fma_f32 v[248:249], v[248:249], v[116:117], v[118:119] op_sel:[0,1,0] op_sel_hi:[1,1,0]
    v_pk_fma_f32 v[250:251], v[250:251], v[116:117], v[118:119] op_sel:[0,1,0] op_sel_hi:[1,1,0]
    v_pk_fma_f32 v[252:253], v[252:253], v[116:117], v[118:119] op_sel:[0,1,0] op_sel_hi:[1,1,0]
    v_pk_fma_f32 v[254:255], v[254:255], v[116:117], v[118:119] op_sel:[0,1,0] op_sel_hi:[1,1,0]
    v_cvt_pk_bf16_f32 v156, v236, v237
    v_cvt_pk_bf16_f32 v157, v238, v239
    v_cvt_pk_bf16_f32 v158, v240, v241
    v_cvt_pk_bf16_f32 v159, v242, v243
    v_cvt_pk_bf16_f32 v160, v244, v245
    v_cvt_pk_bf16_f32 v161, v246, v247
    v_cvt_pk_bf16_f32 v162, v248, v249
    v_cvt_pk_bf16_f32 v163, v250, v251
    v_cvt_pk_bf16_f32 v164, v252, v253
    v_cvt_pk_bf16_f32 v165, v254, v255
    ds_write_b128 v6, v[156:159] offset:30720
    ds_write_b64 v7, v[164:165] offset:30976
    ds_write_b128 v6, v[160:163] offset:30848
    s_add_u32 m0, s90, 23040
    s_nop 0
    buffer_load_dwordx4 v1, s[16:19], s24 offen lds
    s_add_u32 m0, s90, 23712
    s_nop 0
    buffer_load_dwordx4 v1, s[16:19], s25 offen lds
    s_add_u32 m0, s90, 24384
    s_nop 0
    buffer_load_dwordx4 v1, s[16:19], s26 offen lds
    s_add_u32 m0, s90, 25056
    s_nop 0
    buffer_load_dwordx4 v1, s[16:19], s27 offen lds
    s_nop 0
    s_add_u32 m0, s90, 25736
    s_nop 0
    buffer_load_dwordx4 v1, s[16:19], s68 offen lds
    s_add_u32 m0, s90, 26408
    s_nop 0
    buffer_load_dwordx4 v1, s[16:19], s69 offen lds
    s_add_u32 m0, s90, 27080
    s_nop 0
    buffer_load_dwordx4 v1, s[16:19], s70 offen lds
    s_add_u32 m0, s90, 27752
    s_nop 0
    buffer_load_dwordx4 v1, s[16:19], s71 offen lds
    s_waitcnt lgkmcnt(0)
    s_barrier
    ds_read_b64_tr_b16 v[176:177], v8 offset:0
    ds_read_b64_tr_b16 v[178:179], v8 offset:1280
    ds_read_b64_tr_b16 v[180:181], v8 offset:5120
    ds_read_b64_tr_b16 v[182:183], v8 offset:6400
    ds_read_b64_tr_b16 v[184:185], v8 offset:10240
    ds_read_b64_tr_b16 v[186:187], v8 offset:11520
    ds_read_b64_tr_b16 v[188:189], v8 offset:15360
    ds_read_b64_tr_b16 v[190:191], v8 offset:16640
    ds_read_b64_tr_b16 v[192:193], v8 offset:20480
    ds_read_b64_tr_b16 v[194:195], v8 offset:21760
    ds_read_b64_tr_b16 v[196:197], v8 offset:25600
    ds_read_b64_tr_b16 v[198:199], v8 offset:26880
    ds_read_b64_tr_b16 v[200:201], v8 offset:30720
    ds_read_b64_tr_b16 v[202:203], v8 offset:32000
    ds_read_b64_tr_b16 v[204:205], v8 offset:35840
    ds_read_b64_tr_b16 v[206:207], v8 offset:37120
    ds_read_b64_tr_b16 v[208:209], v8 offset:64
    ds_read_b64_tr_b16 v[210:211], v8 offset:1344
    ds_read_b64_tr_b16 v[212:213], v8 offset:5184
    ds_read_b64_tr_b16 v[214:215], v8 offset:6464
    s_waitcnt lgkmcnt(15)
    v_mfma_f32_32x32x16_bf16 v[16:31], v[176:179], a[200:203], 0
    s_waitcnt lgkmcnt(15)
    v_mfma_f32_32x32x16_bf16 v[16:31], v[180:183], a[204:207], v[16:31]
    s_waitcnt lgkmcnt(8)
    ds_read_b64_tr_b16 v[176:177], v8 offset:10304
    ds_read_b64_tr_b16 v[178:179], v8 offset:11584
    v_mfma_f32_32x32x16_bf16 v[16:31], v[184:187], a[208:211], v[16:31]
    s_waitcnt lgkmcnt(6)
    ds_read_b64_tr_b16 v[180:181], v8 offset:15424
    ds_read_b64_tr_b16 v[182:183], v8 offset:16704
    v_mfma_f32_32x32x16_bf16 v[16:31], v[188:191], a[212:215], v[16:31]
    s_waitcnt lgkmcnt(4)
    ds_read_b64_tr_b16 v[184:185], v8 offset:20544
    ds_read_b64_tr_b16 v[186:187], v8 offset:21824
    v_mfma_f32_32x32x16_bf16 v[16:31], v[192:195], a[216:219], v[16:31]
    ds_read_b64_tr_b16 v[188:189], v8 offset:25664
    ds_read_b64_tr_b16 v[190:191], v8 offset:26944
    v_mfma_f32_32x32x16_bf16 v[16:31], v[196:199], a[220:223], v[16:31]
    s_waitcnt lgkmcnt(6)
    ds_read_b64_tr_b16 v[192:193], v8 offset:30784
    ds_read_b64_tr_b16 v[194:195], v8 offset:32064
    v_mfma_f32_32x32x16_bf16 v[16:31], v[200:203], a[224:227], v[16:31]
    s_waitcnt lgkmcnt(6)
    ds_read_b64_tr_b16 v[196:197], v8 offset:35904
    ds_read_b64_tr_b16 v[198:199], v8 offset:37184
    v_mfma_f32_32x32x16_bf16 v[16:31], v[204:207], a[228:231], v[16:31]
    s_waitcnt lgkmcnt(6)
    ds_read_b64_tr_b16 v[200:201], v8 offset:128
    ds_read_b64_tr_b16 v[202:203], v8 offset:1408
    s_nop 3
    v_mfma_f32_32x32x16_bf16 v[32:47], v[208:211], a[200:203], 0
    s_waitcnt lgkmcnt(6)
    ds_read_b64_tr_b16 v[204:205], v8 offset:5248
    ds_read_b64_tr_b16 v[206:207], v8 offset:6528
    s_nop 0
    v_cvt_pk_bf16_f32 v16, v16, v17
    v_cvt_pk_bf16_f32 v17, v18, v19
    v_cvt_pk_bf16_f32 v18, v20, v21
    v_mfma_f32_32x32x16_bf16 v[32:47], v[212:215], a[204:207], v[32:47]
    s_waitcnt lgkmcnt(6)
    v_cvt_pk_bf16_f32 v19, v22, v23
    v_cvt_pk_bf16_f32 v20, v24, v25
    v_cvt_pk_bf16_f32 v21, v26, v27
    v_cvt_pk_bf16_f32 v22, v28, v29
    v_cvt_pk_bf16_f32 v23, v30, v31
    v_mfma_f32_32x32x16_bf16 v[32:47], v[176:179], a[208:211], v[32:47]
    s_waitcnt lgkmcnt(4)
    ds_write_b128 v168, v[16:19] offset:0
    ds_read_b64_tr_b16 v[208:209], v8 offset:10368
    ds_read_b64_tr_b16 v[210:211], v8 offset:11648
    v_mfma_f32_32x32x16_bf16 v[32:47], v[180:183], a[212:215], v[32:47]
    s_waitcnt lgkmcnt(5)
    ds_write_b128 v169, v[20:23] offset:0
    v_mfma_f32_32x32x16_bf16 v[32:47], v[184:187], a[216:219], v[32:47]
    s_waitcnt lgkmcnt(4)
    ds_read_b128 v[216:219], v170 offset:0
    ds_read_b128 v[220:223], v170 offset:1024
    v_mfma_f32_32x32x16_bf16 v[32:47], v[188:191], a[220:223], v[32:47]
    ds_read_b64_tr_b16 v[212:213], v8 offset:15488
    ds_read_b64_tr_b16 v[214:215], v8 offset:16768
    ds_read_b64_tr_b16 v[176:177], v8 offset:20608
    v_mfma_f32_32x32x16_bf16 v[32:47], v[192:195], a[224:227], v[32:47]
    s_waitcnt lgkmcnt(8)
    ds_read_b64_tr_b16 v[178:179], v8 offset:21888
    ds_read_b64_tr_b16 v[180:181], v8 offset:25728
    ds_read_b64_tr_b16 v[182:183], v8 offset:27008
    ds_read_b64_tr_b16 v[184:185], v8 offset:30848
    v_mfma_f32_32x32x16_bf16 v[32:47], v[196:199], a[228:231], v[32:47]
    s_waitcnt lgkmcnt(9)
    ds_read_b64_tr_b16 v[186:187], v8 offset:32128
    ds_read_b64_tr_b16 v[188:189], v8 offset:35968
    ds_read_b64_tr_b16 v[190:191], v8 offset:37248
    s_nop 0
    ds_read_b64_tr_b16 v[192:193], v8 offset:192
    s_nop 0
    v_mfma_f32_32x32x16_bf16 v[48:63], v[200:203], a[200:203], 0
    s_waitcnt lgkmcnt(12)
    buffer_store_dwordx4 v[216:219], v171, s[8:11], s80 offen offset:0 sc1
    ds_read_b64_tr_b16 v[194:195], v8 offset:1472
    ds_read_b64_tr_b16 v[196:197], v8 offset:5312
    v_mfma_f32_32x32x16_bf16 v[48:63], v[204:207], a[204:207], v[48:63]
    s_waitcnt lgkmcnt(11)
    buffer_store_dwordx4 v[220:223], v171, s[8:11], s81 offen offset:0 sc1
    v_cvt_pk_bf16_f32 v32, v32, v33
    v_cvt_pk_bf16_f32 v33, v34, v35
    v_mfma_f32_32x32x16_bf16 v[48:63], v[208:211], a[208:211], v[48:63]
    s_waitcnt lgkmcnt(7)
    v_cvt_pk_bf16_f32 v34, v36, v37
    v_cvt_pk_bf16_f32 v35, v38, v39
    v_cvt_pk_bf16_f32 v36, v40, v41
    v_cvt_pk_bf16_f32 v37, v42, v43
    v_cvt_pk_bf16_f32 v38, v44, v45
    v_cvt_pk_bf16_f32 v39, v46, v47
    v_mfma_f32_32x32x16_bf16 v[48:63], v[212:215], a[212:215], v[48:63]
    s_waitcnt lgkmcnt(3)
    ds_write_b128 v168, v[32:35] offset:2048
    ds_read_b64_tr_b16 v[198:199], v8 offset:6592
    ds_read_b64_tr_b16 v[200:201], v8 offset:10432
    v_mfma_f32_32x32x16_bf16 v[48:63], v[176:179], a[216:219], v[48:63]
    s_waitcnt lgkmcnt(5)
    ds_write_b128 v169, v[36:39] offset:2048
    v_mfma_f32_32x32x16_bf16 v[48:63], v[180:183], a[220:223], v[48:63]
    s_waitcnt lgkmcnt(4)
    ds_read_b128 v[224:227], v170 offset:2048
    ds_read_b128 v[228:231], v170 offset:3072
    v_mfma_f32_32x32x16_bf16 v[48:63], v[184:187], a[224:227], v[48:63]
    ds_read_b64_tr_b16 v[202:203], v8 offset:11712
    ds_read_b64_tr_b16 v[204:205], v8 offset:15552
    ds_read_b64_tr_b16 v[206:207], v8 offset:16832
    v_mfma_f32_32x32x16_bf16 v[48:63], v[188:191], a[228:231], v[48:63]
    s_waitcnt lgkmcnt(8)
    ds_read_b64_tr_b16 v[208:209], v8 offset:20672
    ds_read_b64_tr_b16 v[210:211], v8 offset:21952
    ds_read_b64_tr_b16 v[212:213], v8 offset:25792
    s_nop 0
    ds_read_b64_tr_b16 v[214:215], v8 offset:27072
    s_nop 0
    v_mfma_f32_32x32x16_bf16 v[64:79], v[192:195], a[200:203], 0
    s_waitcnt lgkmcnt(9)
    ds_read_b64_tr_b16 v[176:177], v8 offset:30912
    ds_read_b64_tr_b16 v[178:179], v8 offset:32192
    ds_read_b64_tr_b16 v[180:181], v8 offset:36032
    v_cvt_pk_bf16_f32 v48, v48, v49
    v_cvt_pk_bf16_f32 v49, v50, v51
    v_cvt_pk_bf16_f32 v50, v52, v53
    v_mfma_f32_32x32x16_bf16 v[64:79], v[196:199], a[204:207], v[64:79]
    s_waitcnt lgkmcnt(11)
    buffer_store_dwordx4 v[224:227], v171, s[8:11], s80 offen offset:128 sc1
    v_cvt_pk_bf16_f32 v51, v54, v55
    v_cvt_pk_bf16_f32 v52, v56, v57
    s_waitcnt lgkmcnt(9)
    v_mfma_f32_32x32x16_bf16 v[64:79], v[200:203], a[208:211], v[64:79]
    s_waitcnt lgkmcnt(8)
    v_cvt_pk_bf16_f32 v53, v58, v59
    v_cvt_pk_bf16_f32 v54, v60, v61
    v_cvt_pk_bf16_f32 v55, v62, v63
    ds_read_b64_tr_b16 v[182:183], v8 offset:37312
    s_waitcnt lgkmcnt(5)
    v_mfma_f32_32x32x16_bf16 v[64:79], v[204:207], a[212:215], v[64:79]
    s_waitcnt lgkmcnt(4)
    ds_write_b128 v168, v[48:51] offset:4096
    ds_read_b64_tr_b16 v[184:185], v8 offset:256
    ds_read_b64_tr_b16 v[186:187], v8 offset:1536
    v_mfma_f32_32x32x16_bf16 v[64:79], v[208:211], a[216:219], v[64:79]
    s_waitcnt lgkmcnt(4)
    ds_write_b128 v169, v[52:55] offset:4096
    v_mfma_f32_32x32x16_bf16 v[64:79], v[212:215], a[220:223], v[64:79]
    buffer_store_dwordx4 v[228:231], v171, s[8:11], s81 offen offset:128 sc1
    ds_read_b128 v[232:235], v170 offset:4096
    ds_read_b128 v[236:239], v170 offset:5120
    v_mfma_f32_32x32x16_bf16 v[64:79], v[176:179], a[224:227], v[64:79]
    ds_read_b64_tr_b16 v[188:189], v8 offset:5376
    ds_read_b64_tr_b16 v[190:191], v8 offset:6656
    ds_read_b64_tr_b16 v[192:193], v8 offset:10496
    s_waitcnt lgkmcnt(9)
    v_mfma_f32_32x32x16_bf16 v[64:79], v[180:183], a[228:231], v[64:79]
    s_waitcnt lgkmcnt(7)
    ds_read_b64_tr_b16 v[194:195], v8 offset:11776
    ds_read_b64_tr_b16 v[196:197], v8 offset:15616
    ds_read_b64_tr_b16 v[198:199], v8 offset:16896
    ds_read_b64_tr_b16 v[200:201], v8 offset:20736
    s_nop 0
    ds_read_b64_tr_b16 v[202:203], v8 offset:22016
    s_waitcnt lgkmcnt(10)
    v_mfma_f32_32x32x16_bf16 v[80:95], v[184:187], a[200:203], 0
    s_nop 0
    ds_read_b64_tr_b16 v[204:205], v8 offset:25856
    ds_read_b64_tr_b16 v[206:207], v8 offset:27136
    v_cvt_pk_bf16_f32 v64, v64, v65
    v_cvt_pk_bf16_f32 v65, v66, v67
    v_cvt_pk_bf16_f32 v66, v68, v69
    v_cvt_pk_bf16_f32 v67, v70, v71
    v_cvt_pk_bf16_f32 v68, v72, v73
    v_cvt_pk_bf16_f32 v69, v74, v75
    v_cvt_pk_bf16_f32 v70, v76, v77
    v_cvt_pk_bf16_f32 v71, v78, v79
    s_waitcnt lgkmcnt(8)
    v_mfma_f32_32x32x16_bf16 v[80:95], v[188:191], a[204:207], v[80:95]
    s_waitcnt lgkmcnt(7)
    ds_write_b128 v168, v[64:67] offset:6144
    ds_read_b64_tr_b16 v[208:209], v8 offset:30976
    ds_read_b64_tr_b16 v[210:211], v8 offset:32256
    s_waitcnt lgkmcnt(7)
    v_mfma_f32_32x32x16_bf16 v[80:95], v[192:195], a[208:211], v[80:95]
    s_waitcnt lgkmcnt(6)
    ds_write_b128 v169, v[68:71] offset:6144
    v_mfma_f32_32x32x16_bf16 v[80:95], v[196:199], a[212:215], v[80:95]
    s_waitcnt lgkmcnt(4)
    ds_read_b128 v[240:243], v170 offset:6144
    buffer_store_dwordx4 v[232:235], v171, s[8:11], s80 offen offset:256 sc1
    ds_read_b128 v[244:247], v170 offset:7168
    v_mfma_f32_32x32x16_bf16 v[80:95], v[200:203], a[216:219], v[80:95]
    buffer_store_dwordx4 v[236:239], v171, s[8:11], s81 offen offset:256 sc1
    ds_read_b64_tr_b16 v[212:213], v8 offset:36096
    ds_read_b64_tr_b16 v[214:215], v8 offset:37376
    v_mfma_f32_32x32x16_bf16 v[80:95], v[204:207], a[220:223], v[80:95]
    s_waitcnt lgkmcnt(6)
    s_waitcnt lgkmcnt(5)
    v_mfma_f32_32x32x16_bf16 v[80:95], v[208:211], a[224:227], v[80:95]
    s_waitcnt lgkmcnt(4)
    s_waitcnt lgkmcnt(3)
    buffer_store_dwordx4 v[240:243], v171, s[8:11], s80 offen offset:384 sc1
    s_waitcnt lgkmcnt(2)
    buffer_store_dwordx4 v[244:247], v171, s[8:11], s81 offen offset:384 sc1
    s_waitcnt lgkmcnt(0)
    v_mfma_f32_32x32x16_bf16 v[80:95], v[212:215], a[228:231], v[80:95]
L_spec_h1:
    s_cbranch_execz L_spec_hr
    s_nop 11
    v_cvt_pk_bf16_f32 v80, v80, v81
    v_cvt_pk_bf16_f32 v81, v82, v83
    v_cvt_pk_bf16_f32 v82, v84, v85
    v_cvt_pk_bf16_f32 v83, v86, v87
    v_cvt_pk_bf16_f32 v84, v88, v89
    v_cvt_pk_bf16_f32 v85, v90, v91
    v_cvt_pk_bf16_f32 v86, v92, v93
    v_cvt_pk_bf16_f32 v87, v94, v95
    ds_write_b128 v168, v[80:83] offset:8192
    ds_write_b128 v169, v[84:87] offset:8192
    ds_read_b128 v[248:251], v170 offset:8192
    ds_read_b128 v[252:255], v170 offset:9216
    s_waitcnt lgkmcnt(1)
    buffer_store_dwordx4 v[248:251], v171, s[8:11], s80 offen offset:512 sc1
    s_waitcnt lgkmcnt(0)
    buffer_store_dwordx4 v[252:255], v171, s[8:11], s81 offen offset:512 sc1
    ds_read_b128 a[0:3], v172 offset:0
    ds_read_b128 a[4:7], v172 offset:1024
    ds_read_b128 a[8:11], v172 offset:2048
    ds_read_b128 a[12:15], v172 offset:3072
    ds_read_b128 a[16:19], v172 offset:4096
    ds_read_b128 a[20:23], v172 offset:5120
    ds_read_b128 a[24:27], v173 offset:3072
    v_fmamk_f32 v124, v123, 0x3f800000, v125
    v_mul_f32 v128, 0xbacccccd, v124
    v_mul_f32 v129, 0x3e800000, v126
    v_fma_f32 v129, v128, v127, v129
    v_fmamk_f32 v41, v128, 0x3f800000, v129
    v_fmamk_f32 v42, v128, 0x40000000, v129
    v_fmamk_f32 v43, v128, 0x40400000, v129
    v_fmamk_f32 v44, v128, 0x40800000, v129
    v_fmamk_f32 v45, v128, 0x40a00000, v129
    v_fmamk_f32 v46, v128, 0x40c00000, v129
    v_fmamk_f32 v47, v128, 0x40e00000, v129
    v_cos_f32 v32, v129
    v_sin_f32 v40, v129
    v_cos_f32 v33, v41
    v_sin_f32 v41, v41
    ds_read_b128 a[28:31], v173 offset:4096
    ds_read_b128 a[32:35], v173 offset:5120
    ds_read_b128 a[36:39], v174 offset:3072
    ds_read_b128 a[40:43], v174 offset:4096
    ds_read_b128 a[44:47], v174 offset:5120
    ds_read_b128 a[48:51], v175 offset:3072
    ds_read_b128 a[52:55], v175 offset:4096
    v_cos_f32 v34, v42
    v_sin_f32 v42, v42
    v_cos_f32 v35, v43
    v_sin_f32 v43, v43
    v_cos_f32 v36, v44
    v_sin_f32 v44, v44
    v_cos_f32 v37, v45
    v_sin_f32 v45, v45
    v_cos_f32 v38, v46
    v_sin_f32 v46, v46
    ds_read_b128 a[56:59], v175 offset:5120
    v_cos_f32 v39, v47
    v_sin_f32 v47, v47
    v_cvt_pk_bf16_f32 v32, v32, v33
    v_cvt_pk_bf16_f32 v33, v34, v35
    v_cvt_pk_bf16_f32 v34, v36, v37
    v_cvt_pk_bf16_f32 v35, v38, v39
    v_cvt_pk_bf16_f32 v36, v40, v41
    v_cvt_pk_bf16_f32 v37, v42, v43
    v_cvt_pk_bf16_f32 v38, v44, v45
    v_cvt_pk_bf16_f32 v39, v46, v47
    ds_write_b128 v170, v[32:35] offset:2048
    ds_write_b128 v170, v[36:39] offset:3072
    ds_read_b128 a[68:71], v170 offset:2048
    ds_read_b128 a[72:75], v170 offset:3072
    ds_read_b64_tr_b16 a[156:157], v104 offset:2048
    ds_read_b64_tr_b16 a[158:159], v104 offset:3072
    ds_read_b64_tr_b16 a[160:161], v104 offset:2056
    ds_read_b64_tr_b16 a[162:163], v104 offset:3080
    v_fmamk_f32 v124, v123, 0x40000000, v125
    v_mul_f32 v128, 0xbacccccd, v124
    v_mul_f32 v129, 0x3e800000, v126
    v_fma_f32 v129, v128, v127, v129
    v_fmamk_f32 v57, v128, 0x3f800000, v129
    v_fmamk_f32 v58, v128, 0x40000000, v129
    v_fmamk_f32 v59, v128, 0x40400000, v129
    v_fmamk_f32 v60, v128, 0x40800000, v129
    v_fmamk_f32 v61, v128, 0x40a00000, v129
    v_fmamk_f32 v62, v128, 0x40c00000, v129
    v_fmamk_f32 v63, v128, 0x40e00000, v129
    v_cos_f32 v48, v129
    v_sin_f32 v56, v129
    v_cos_f32 v49, v57
    v_sin_f32 v57, v57
    v_cos_f32 v50, v58
    v_sin_f32 v58, v58
    v_cos_f32 v51, v59
    v_sin_f32 v59, v59
    v_cos_f32 v52, v60
    v_sin_f32 v60, v60
    v_cos_f32 v53, v61
    v_sin_f32 v61, v61
    v_cos_f32 v54, v62
    v_sin_f32 v62, v62
    v_cos_f32 v55, v63
    v_sin_f32 v63, v63
    v_cvt_pk_bf16_f32 v48, v48, v49
    v_cvt_pk_bf16_f32 v49, v50, v51
    v_cvt_pk_bf16_f32 v50, v52, v53
    v_cvt_pk_bf16_f32 v51, v54, v55
    v_cvt_pk_bf16_f32 v52, v56, v57
    v_cvt_pk_bf16_f32 v53, v58, v59
    v_cvt_pk_bf16_f32 v54, v60, v61
    v_cvt_pk_bf16_f32 v55, v62, v63
    ds_write_b128 v170, v[48:51] offset:4096
    ds_write_b128 v170, v[52:55] offset:5120
    ds_read_b128 a[76:79], v170 offset:4096
    ds_read_b128 a[80:83], v170 offset:5120
    ds_read_b64_tr_b16 a[164:165], v104 offset:4096
    ds_read_b64_tr_b16 a[166:167], v104 offset:5120
    ds_read_b64_tr_b16 a[168:169], v104 offset:4104
    ds_read_b64_tr_b16 a[170:171], v104 offset:5128
    s_waitcnt vmcnt(0)
    s_barrier
    buffer_store_dwordx2 v[12:13], v14, s[8:11], s78 offen offset:512 sc1
    buffer_load_dword a253, v15, s[20:23], s3 offen
    s_lshl_b32 s81, s32, 14
    s_add_u32 s81, s81, 12582912
    ds_read_u16_d16_hi v176, v97 offset:0
    ds_read_u16_d16_hi v177, v97 offset:672
    ds_read_u16_d16_hi v178, v97 offset:1344
    ds_read_u16_d16_hi v179, v97 offset:2016
    ds_read_u16_d16_hi v180, v97 offset:11520
    ds_read_u16_d16_hi v181, v97 offset:12192
    ds_read_u16_d16_hi v182, v97 offset:12864
    ds_read_u16_d16_hi v183, v97 offset:13536
    ds_read_u16_d16_hi v184, v97 offset:23040
    ds_read_u16_d16_hi v185, v97 offset:23712
    ds_read_u16_d16_hi v186, v97 offset:24384
    v_fmamk_f32 v124, v123, 0x40400000, v125
    v_mul_f32 v128, 0xbacccccd, v124
    v_mul_f32 v129, 0x3e800000, v126
    v_fma_f32 v129, v128, v127, v129
    v_fmamk_f32 v73, v128, 0x3f800000, v129
    v_fmamk_f32 v74, v128, 0x40000000, v129
    v_fmamk_f32 v75, v128, 0x40400000, v129
    v_fmamk_f32 v76, v128, 0x40800000, v129
    v_fmamk_f32 v77, v128, 0x40a00000, v129
    v_fmamk_f32 v78, v128, 0x40c00000, v129
    v_fmamk_f32 v79, v128, 0x40e00000, v129
    v_cos_f32 v64, v129
    v_sin_f32 v72, v129
    v_cos_f32 v65, v73
    v_sin_f32 v73, v73
    v_cos_f32 v66, v74
    s_mul_i32 s74, s32, 10240
    s_mul_i32 s75, s2, 40960
    ds_read_u16_d16_hi v187, v97 offset:25056
    ds_read_u16_d16_hi v188, v97 offset:34560
    ds_read_u16_d16_hi v189, v97 offset:35232
    ds_read_u16_d16_hi v190, v97 offset:35904
    ds_read_u16_d16_hi v191, v97 offset:36576
    ds_read_b128 a[100:103], v172 offset:12288
    ds_read_b128 a[104:107], v172 offset:13312
    ds_read_b128 a[108:111], v172 offset:14336
    ds_read_b128 a[112:115], v172 offset:15360
    v_sin_f32 v74, v74
    v_cos_f32 v67, v75
    v_sin_f32 v75, v75
    v_cos_f32 v68, v76
    v_sin_f32 v76, v76
    v_cos_f32 v69, v77
    v_sin_f32 v77, v77
    v_cos_f32 v70, v78
    v_sin_f32 v78, v78
    v_cos_f32 v71, v79
    s_add_u32 s75, s75, s74
    s_add_u32 s76, s75, 3145728
    ds_read_b128 a[116:119], v172 offset:16384
    ds_read_b128 a[120:123], v172 offset:17408
    ds_read_b128 a[124:127], v172 offset:18432
    ds_read_b128 a[128:131], v172 offset:19456
    ds_read_b128 a[132:135], v172 offset:20480
    ds_read_b128 a[136:139], v172 offset:21504
    ds_read_b128 a[140:143], v172 offset:22528
    v_sin_f32 v79, v79
    v_cvt_pk_bf16_f32 v64, v64, v65
    v_cvt_pk_bf16_f32 v65, v66, v67
    v_cvt_pk_bf16_f32 v66, v68, v69
    v_cvt_pk_bf16_f32 v67, v70, v71
    v_cvt_pk_bf16_f32 v68, v72, v73
    v_cvt_pk_bf16_f32 v69, v74, v75
    v_cvt_pk_bf16_f32 v70, v76, v77
    v_cvt_pk_bf16_f32 v71, v78, v79
    s_add_u32 s75, s75, 65536
    s_lshl_b32 s56, s32, 7
    ds_write_b128 v170, v[64:67] offset:6144
    ds_write_b128 v170, v[68:71] offset:7168
    ds_read_b128 a[84:87], v170 offset:6144
    ds_read_b128 a[88:91], v170 offset:7168
    ds_read_b64_tr_b16 a[172:173], v104 offset:6144
    ds_read_b64_tr_b16 a[174:175], v104 offset:7168
    ds_read_b64_tr_b16 a[176:177], v104 offset:6152
    ds_read_b64_tr_b16 a[178:179], v104 offset:7176
    v_fmamk_f32 v124, v123, 0x40800000, v125
    v_mul_f32 v128, 0xbacccccd, v124
    v_mul_f32 v129, 0x3e800000, v126
    v_fma_f32 v129, v128, v127, v129
    v_fmamk_f32 v89, v128, 0x3f800000, v129
    v_fmamk_f32 v90, v128, 0x40000000, v129
    v_fmamk_f32 v91, v128, 0x40400000, v129
    v_fmamk_f32 v92, v128, 0x40800000, v129
    v_fmamk_f32 v93, v128, 0x40a00000, v129
    v_fmamk_f32 v94, v128, 0x40c00000, v129
    v_fmamk_f32 v95, v128, 0x40e00000, v129
    v_cos_f32 v80, v129
    v_sin_f32 v88, v129
    v_cos_f32 v81, v89
    v_sin_f32 v89, v89
    v_cos_f32 v82, v90
    v_sin_f32 v90, v90
    v_cos_f32 v83, v91
    s_add_u32 s57, s56, 90112
    s_add_u32 s56, s56, 40960
    ds_read_b128 a[144:147], v172 offset:23552
    ds_read_b128 a[188:191], v172 offset:6144
    ds_read_b128 a[192:195], v172 offset:7168
    ds_read_b128 a[196:199], v172 offset:8192
    ds_read_b128 a[200:203], v172 offset:9216
    ds_read_b128 a[204:207], v172 offset:10240
    ds_read_b128 a[208:211], v172 offset:11264
    v_sin_f32 v91, v91
    v_cos_f32 v84, v92
    v_sin_f32 v92, v92
    v_cos_f32 v85, v93
    v_sin_f32 v93, v93
    v_cos_f32 v86, v94
    v_sin_f32 v94, v94
    v_cos_f32 v87, v95
    v_sin_f32 v95, v95
    v_cvt_pk_bf16_f32 v80, v80, v81
    s_add_u32 s82, s75, 4096
    s_add_u32 s83, s75, 8192
    ds_read_b128 a[212:215], v173 offset:9216
    ds_read_b128 a[216:219], v173 offset:10240
    ds_read_b128 a[220:223], v173 offset:11264
    ds_read_b128 a[224:227], v174 offset:9216
    ds_read_b128 a[228:231], v174 offset:10240
    ds_read_b128 a[232:235], v174 offset:11264
    ds_read_b128 a[236:239], v175 offset:9216
    v_cvt_pk_bf16_f32 v81, v82, v83
    v_cvt_pk_bf16_f32 v82, v84, v85
    v_cvt_pk_bf16_f32 v83, v86, v87
    v_cvt_pk_bf16_f32 v84, v88, v89
    v_cvt_pk_bf16_f32 v85, v90, v91
    v_cvt_pk_bf16_f32 v86, v92, v93
    v_cvt_pk_bf16_f32 v87, v94, v95
    s_add_u32 s85, s76, 2560
    s_add_u32 s88, s76, 5120
    ds_write_b128 v170, v[80:83] offset:8192
    ds_write_b128 v170, v[84:87] offset:9216
    ds_read_b128 a[92:95], v170 offset:8192
    ds_read_b128 a[96:99], v170 offset:9216
    ds_read_b64_tr_b16 a[180:181], v104 offset:8192
    ds_read_b64_tr_b16 a[182:183], v104 offset:9216
    ds_read_b64_tr_b16 a[184:185], v104 offset:8200
    ds_read_b64_tr_b16 a[186:187], v104 offset:9224
    s_waitcnt lgkmcnt(14)
    v_mul_f32 v176, v102, v176
    v_mul_f32 v177, v102, v177
    v_mul_f32 v178, v102, v178
    v_mul_f32 v179, v102, v179
    v_mul_f32 v180, v102, v180
    v_mul_f32 v181, v102, v181
    v_mul_f32 v182, v102, v182
    v_mul_f32 v183, v102, v183
    v_mul_f32 v184, v102, v184
    v_mul_f32 v185, v102, v185
    v_mul_f32 v186, v102, v186
    v_mul_f32 v187, v102, v187
    v_mul_f32 v188, v102, v188
    v_mul_f32 v189, v102, v189
    v_mul_f32 v190, v102, v190
    v_mul_f32 v191, v102, v191
    v_lshlrev_b32 v1, 4, v0
    v_bfe_u32 v10, v0, 2, 2
    v_lshrrev_b32 v11, 5, v0
    v_bfe_u32 v12, v0, 4, 1
    v_and_b32 v13, 1, v0
    v_bfe_u32 v14, v0, 1, 1
    v_lshlrev_b32 v14, 3, v14
    v_mul_u32_u24 v2, 640, v10
    v_lshl_add_u32 v2, v13, 4, v2
    v_add3_u32 v2, v2, v14, s74
    v_lshl_add_u32 v2, v12, 6, v2
    s_add_u32 s89, s76, 7680
    ds_read_b128 a[240:243], v175 offset:10240
    ds_read_b128 a[244:247], v175 offset:11264
    ds_read_u16_d16_hi v192, v98 offset:0
    ds_read_u16_d16_hi v193, v98 offset:672
    ds_read_u16_d16_hi v194, v98 offset:1344
    ds_read_u16_d16_hi v195, v98 offset:2016
    ds_read_u16_d16_hi v196, v98 offset:11520
    ds_read_u16_d16_hi v197, v98 offset:12192
    ds_read_u16_d16_hi v198, v98 offset:12864
    ds_read_u16_d16_hi v199, v98 offset:13536
    v_lshl_add_u32 v2, v11, 5, v2
    v_mul_u32_u24 v8, 544, v13
    v_lshl_add_u32 v8, v12, 4, v8
    v_add3_u32 v8, v8, v14, s57
    v_lshl_add_u32 v9, v11, 2, v10
    v_lshl_add_u32 v10, v11, 3, v10
    v_mul_u32_u24 v9, 1088, v9
    v_mul_u32_u24 v10, 1088, v10
    v_add_u32 v9, v9, v8
    v_add_u32 v8, v10, v8
    v_and_b32 v10, 31, v0
    v_mul_u32_u24 v4, 1040, v10
    v_lshl_add_u32 v13, v11, 9, s56
    v_add_u32 v4, v4, v13
    v_and_b32 v14, 7, v0
    v_mul_u32_u24 v5, 1040, v14
    v_bfe_u32 v15, v0, 3, 2
    v_lshl_add_u32 v5, v15, 5, v5
    v_add_u32 v5, v5, v13
    v_lshlrev_b32 v13, 4, v11
    s_mul_i32 s56, s32, 10400
    s_add_u32 s56, s56, 40960
    ds_read_u16_d16_hi v200, v98 offset:23040
    ds_read_u16_d16_hi v201, v98 offset:23712
    ds_read_u16_d16_hi v202, v98 offset:24384
    ds_read_u16_d16_hi v203, v98 offset:25056
    ds_read_u16_d16_hi v204, v98 offset:34560
    ds_read_u16_d16_hi v205, v98 offset:35232
    ds_read_u16_d16_hi v206, v98 offset:35904
    ds_read_u16_d16_hi v207, v98 offset:36576
    ds_read_u16_d16_hi v208, v99 offset:0
    ds_read_u16_d16_hi v209, v99 offset:672
    ds_read_u16_d16_hi v210, v99 offset:1344
    v_lshl_add_u32 v14, v14, 5, v13
    v_mul_u32_u24 v15, 2560, v15
    v_add_u32 v15, v15, v14
    v_lshl_add_u32 v14, v10, 5, v13
    v_and_b32 v10, 15, v0
    v_lshlrev_b32 v10, 4, v10
    v_mul_u32_u24 v6, 1040, v11
    v_lshl_add_u32 v6, v12, 9, v6
    v_add3_u32 v6, v6, v10, s56
    s_mul_i32 s56, s32, 10880
    s_add_u32 s56, s56, 90112
    ds_read_u16_d16_hi v211, v99 offset:2016
    ds_read_u16_d16_hi v212, v99 offset:11520
    ds_read_u16_d16_hi v213, v99 offset:12192
    ds_read_u16_d16_hi v214, v99 offset:12864
    ds_read_u16_d16_hi v215, v99 offset:13536
    v_lshrrev_b32 v7, 4, v0
    v_mul_u32_u24 v7, 544, v7
    v_add3_u32 v7, v7, v10, s56
    buffer_load_dwordx2 v[130:131], v121, s[8:11], s81 offen offset:512 sc1
    v_mov_b32 v3, v120
    v_mov_b32 v10, s86
    v_mov_b32 v11, s87
    s_waitcnt lgkmcnt(0)
    s_barrier
    s_waitcnt vmcnt(0)
    v_cmp_ne_u64 vcc, s[86:87], v[130:131]
    s_cbranch_vccnz L_slow_tf
L_back_tf:
    s_add_u32 m0, s74, 0
    ds_read_u16_d16_hi v216, v99 offset:23040
    buffer_load_dwordx4 v1, s[8:11], s75 offen offset:0 sc1 lds
    buffer_load_dwordx4 v1, s[8:11], s75 offen offset:1024 sc1 lds
    buffer_load_dwordx4 v1, s[8:11], s75 offen offset:2048 sc1 lds
    buffer_load_dwordx4 v1, s[8:11], s75 offen offset:3072 sc1 lds
    s_add_u32 m0, s74, 4096
    ds_read_u16_d16_hi v217, v99 offset:23712
    buffer_load_dwordx4 v1, s[8:11], s82 offen offset:0 sc1 lds
    buffer_load_dwordx4 v1, s[8:11], s82 offen offset:1024 sc1 lds
    buffer_load_dwordx4 v1, s[8:11], s82 offen offset:2048 sc1 lds
    buffer_load_dwordx4 v1, s[8:11], s82 offen offset:3072 sc1 lds
    s_add_u32 m0, s74, 8192
    ds_read_u16_d16_hi v218, v99 offset:24384
    buffer_load_dwordx4 v1, s[8:11], s83 offen offset:0 sc1 lds
    buffer_load_dwordx4 v1, s[8:11], s83 offen offset:1024 sc1 lds
    ds_read_u16_d16_hi v219, v99 offset:25056
    ds_read_u16_d16_hi v220, v99 offset:34560
    ds_read_u16_d16_hi v221, v99 offset:35232
    ds_read_u16_d16_hi v222, v99 offset:35904
    ds_read_u16_d16_hi v223, v99 offset:36576
    ds_read_u16_d16_hi v224, v100 offset:0
    ds_read_u16_d16_hi v225, v100 offset:672
    v_mov_b32 v106, 0
    v_mov_b32 v107, 0
    v_mov_b32 v118, 0
    v_mov_b32 v119, 0
    v_mov_b32 v130, 0
    v_mov_b32 v131, 0
    v_mov_b32 v142, 0
    v_mov_b32 v143, 0
    ds_read_u16_d16_hi v226, v100 offset:1344
    ds_read_u16_d16_hi v227, v100 offset:2016
    ds_read_u16_d16_hi v228, v100 offset:11520
    ds_read_u16_d16_hi v229, v100 offset:12192
    ds_read_u16_d16_hi v230, v100 offset:12864
    ds_read_u16_d16_hi v231, v100 offset:13536
    ds_read_u16_d16_hi v232, v100 offset:23040
    ds_read_u16_d16_hi v233, v100 offset:23712
    ds_read_u16_d16_hi v234, v100 offset:24384
    ds_read_u16_d16_hi v235, v100 offset:25056
    ds_read_u16_d16_hi v236, v100 offset:34560
    ds_read_u16_d16_hi v237, v100 offset:35232
    ds_read_u16_d16_hi v238, v100 offset:35904
    ds_read_u16_d16_hi v239, v100 offset:36576
    ds_read_u16_d16_hi v240, v101 offset:0
    ds_read_u16_d16_hi v241, v101 offset:672
    ds_read_u16_d16_hi v242, v101 offset:1344
    ds_read_u16_d16_hi v243, v101 offset:2016
    ds_read_u16_d16_hi v244, v101 offset:11520
    ds_read_u16_d16_hi v245, v101 offset:12192
    ds_read_u16_d16_hi v246, v101 offset:12864
    ds_read_u16_d16_hi v247, v101 offset:13536
    ds_read_u16_d16_hi v248, v101 offset:23040
    ds_read_u16_d16_hi v249, v101 offset:23712
    ds_read_u16_d16_hi v250, v101 offset:24384
    ds_read_u16_d16_hi v251, v101 offset:25056
    ds_read_u16_d16_hi v252, v101 offset:34560
    ds_read_u16_d16_hi v253, v101 offset:35232
    ds_read_u16_d16_hi v254, v101 offset:35904
    ds_read_u16_d16_hi v255, v101 offset:36576
    s_waitcnt vmcnt(7)
    ds_read_b64_tr_b16 v[96:97], v2 offset:0
    ds_read_b64_tr_b16 v[98:99], v2 offset:128
    ds_read_b64_tr_b16 v[100:101], v2 offset:256
    ds_read_b64_tr_b16 v[102:103], v2 offset:384
    ds_read_b64_tr_b16 v[104:105], v2 offset:512
    s_waitcnt lgkmcnt(3)
    v_mfma_f32_32x32x16_bf16 v[16:31], v[96:99], a[0:3], 0
    s_waitcnt lgkmcnt(1)
    v_mfma_f32_32x32x16_bf16 v[16:31], v[100:103], a[4:7], v[16:31]
    s_waitcnt lgkmcnt(0)
    v_mfma_f32_32x32x16_bf16 v[16:31], v[104:107], a[8:11], v[16:31]
    s_waitcnt vmcnt(5)
    ds_read_b64_tr_b16 v[108:109], v2 offset:2560
    ds_read_b64_tr_b16 v[110:111], v2 offset:2688
    ds_read_b64_tr_b16 v[112:113], v2 offset:2816
    ds_read_b64_tr_b16 v[114:115], v2 offset:2944
    ds_read_b64_tr_b16 v[116:117], v2 offset:3072
    s_nop 0
    v_mfma_f32_32x32x16_bf16 v[80:95], v[96:99], a[12:15], 0
    s_nop 3
    v_cvt_pk_bf16_f32 v16, v16, v17
    v_cvt_pk_bf16_f32 v17, v18, v19
    v_cvt_pk_bf16_f32 v18, v20, v21
    v_mfma_f32_32x32x16_bf16 v[80:95], v[100:103], a[16:19], v[80:95]
    v_cvt_pk_bf16_f32 v19, v22, v23
    v_cvt_pk_bf16_f32 v20, v24, v25
    v_cvt_pk_bf16_f32 v21, v26, v27
    v_cvt_pk_bf16_f32 v22, v28, v29
    v_cvt_pk_bf16_f32 v23, v30, v31
    v_mfma_f32_32x32x16_bf16 v[80:95], v[104:107], a[20:23], v[80:95]
    s_waitcnt lgkmcnt(3)
    v_mfma_f32_32x32x16_bf16 v[32:47], v[108:111], a[0:3], 0
    s_waitcnt lgkmcnt(1)
    v_mfma_f32_32x32x16_bf16 v[32:47], v[112:115], a[4:7], v[32:47]
    s_waitcnt lgkmcnt(0)
    v_mfma_f32_32x32x16_bf16 v[32:47], v[116:119], a[8:11], v[32:47]
    s_nop 6
    v_mfma_f32_32x32x16_bf16 v[80:95], v[108:111], a[24:27], v[80:95]
    s_nop 3
    v_cvt_pk_bf16_f32 v32, v32, v33
    v_cvt_pk_bf16_f32 v33, v34, v35
    v_cvt_pk_bf16_f32 v34, v36, v37
    v_mfma_f32_32x32x16_bf16 v[80:95], v[112:115], a[28:31], v[80:95]
    s_waitcnt vmcnt(2)
    ds_read_b64_tr_b16 v[120:121], v2 offset:5120
    ds_read_b64_tr_b16 v[122:123], v2 offset:5248
    ds_read_b64_tr_b16 v[124:125], v2 offset:5376
    ds_read_b64_tr_b16 v[126:127], v2 offset:5504
    ds_read_b64_tr_b16 v[128:129], v2 offset:5632
    v_cvt_pk_bf16_f32 v35, v38, v39
    v_mfma_f32_32x32x16_bf16 v[80:95], v[116:119], a[32:35], v[80:95]
    ds_write_b128 v4, v[16:19] offset:0
    v_cvt_pk_bf16_f32 v36, v40, v41
    v_cvt_pk_bf16_f32 v37, v42, v43
    v_cvt_pk_bf16_f32 v38, v44, v45
    v_cvt_pk_bf16_f32 v39, v46, v47
    ds_write_b128 v4, v[20:23] offset:16
    s_waitcnt lgkmcnt(5)
    v_mfma_f32_32x32x16_bf16 v[48:63], v[120:123], a[0:3], 0
    s_waitcnt lgkmcnt(3)
    v_mfma_f32_32x32x16_bf16 v[48:63], v[124:127], a[4:7], v[48:63]
    s_waitcnt lgkmcnt(1)
    s_waitcnt vmcnt(0)
    ds_read_b64_tr_b16 v[132:133], v2 offset:7680
    ds_read_b64_tr_b16 v[134:135], v2 offset:7808
    v_mfma_f32_32x32x16_bf16 v[48:63], v[128:131], a[8:11], v[48:63]
    s_nop 0
    ds_read_b64_tr_b16 v[136:137], v2 offset:7936
    ds_read_b64_tr_b16 v[138:139], v2 offset:8064
    ds_read_b64_tr_b16 v[140:141], v2 offset:8192
    s_nop 2
    v_mfma_f32_32x32x16_bf16 v[80:95], v[120:123], a[36:39], v[80:95]
    s_waitcnt lgkmcnt(5)
    ds_write_b128 v4, v[32:35] offset:32
    s_nop 1
    v_mfma_f32_32x32x16_bf16 v[80:95], v[124:127], a[40:43], v[80:95]
    ds_write_b128 v4, v[36:39] offset:48
    v_cvt_pk_bf16_f32 v48, v48, v49
    v_cvt_pk_bf16_f32 v49, v50, v51
    v_mfma_f32_32x32x16_bf16 v[80:95], v[128:131], a[44:47], v[80:95]
    v_cvt_pk_bf16_f32 v50, v52, v53
    v_cvt_pk_bf16_f32 v51, v54, v55
    v_cvt_pk_bf16_f32 v52, v56, v57
    v_cvt_pk_bf16_f32 v53, v58, v59
    v_cvt_pk_bf16_f32 v54, v60, v61
    v_cvt_pk_bf16_f32 v55, v62, v63
    s_waitcnt lgkmcnt(3)
    v_mfma_f32_32x32x16_bf16 v[64:79], v[132:135], a[0:3], 0
    s_waitcnt lgkmcnt(2)
    ds_write_b128 v4, v[48:51] offset:64
    v_mfma_f32_32x32x16_bf16 v[64:79], v[136:139], a[4:7], v[64:79]
    s_waitcnt lgkmcnt(2)
    ds_write_b128 v4, v[52:55] offset:80
    v_mfma_f32_32x32x16_bf16 v[64:79], v[140:143], a[8:11], v[64:79]
    s_waitcnt lgkmcnt(2)
    s_nop 5
    v_mfma_f32_32x32x16_bf16 v[80:95], v[132:135], a[48:51], v[80:95]
    s_nop 3
    v_cvt_pk_bf16_f32 v64, v64, v65
    v_cvt_pk_bf16_f32 v65, v66, v67
    v_cvt_pk_bf16_f32 v66, v68, v69
    v_mfma_f32_32x32x16_bf16 v[80:95], v[136:139], a[52:55], v[80:95]
    s_waitcnt lgkmcnt(1)
    v_cvt_pk_bf16_f32 v67, v70, v71
    v_cvt_pk_bf16_f32 v68, v72, v73
    v_cvt_pk_bf16_f32 v69, v74, v75
    v_cvt_pk_bf16_f32 v70, v76, v77
    v_cvt_pk_bf16_f32 v71, v78, v79
    v_mfma_f32_32x32x16_bf16 v[80:95], v[140:143], a[56:59], v[80:95]
    s_waitcnt lgkmcnt(0)
    ds_write_b128 v4, v[64:67] offset:96
    ds_write_b128 v4, v[68:71] offset:112
    s_nop 8
    v_cvt_pk_bf16_f32 v80, v80, v81
    v_cvt_pk_bf16_f32 v81, v82, v83
    v_cvt_pk_bf16_f32 v82, v84, v85
    v_cvt_pk_bf16_f32 v83, v86, v87
    v_cvt_pk_bf16_f32 v84, v88, v89
    v_cvt_pk_bf16_f32 v85, v90, v91
    v_cvt_pk_bf16_f32 v86, v92, v93
    v_cvt_pk_bf16_f32 v87, v94, v95
    ds_write_b128 v5, v[80:83] offset:33280
    ds_write_b128 v5, v[84:87] offset:33296
    s_waitcnt lgkmcnt(0)
    s_barrier
    ds_read_b128 v[16:19], v6 offset:0
    ds_read_b128 v[20:23], v6 offset:256
    ds_read_b128 v[48:51], v6 offset:2080
    ds_read_b128 v[52:55], v6 offset:2336
    ds_read_b128 v[80:83], v6 offset:4160
    ds_read_b128 v[84:87], v6 offset:4416
    ds_read_b128 v[112:115], v6 offset:6240
    ds_read_b128 v[116:119], v6 offset:6496
    ds_read_b128 v[144:147], v6 offset:8320
    ds_read_b128 v[148:151], v6 offset:8576
    s_waitcnt lgkmcnt(9)
    v_mfma_f32_16x16x32_bf16 v[32:35], v[16:19], a[60:63], 0
    s_waitcnt lgkmcnt(7)
    s_nop 1
    v_mfma_f32_16x16x32_bf16 v[36:39], v[20:23], a[60:63], 0
    s_waitcnt lgkmcnt(5)
    s_nop 1
    v_mfma_f32_16x16x32_bf16 v[40:43], v[16:19], a[64:67], 0
    s_waitcnt lgkmcnt(4)
    v_cvt_pk_bf16_f32 v24, v32, v33
    v_cvt_pk_bf16_f32 v25, v34, v35
    v_mfma_f32_16x16x32_bf16 v[44:47], v[20:23], a[64:67], 0
    s_waitcnt lgkmcnt(3)
    v_cvt_pk_bf16_f32 v26, v36, v37
    v_cvt_pk_bf16_f32 v27, v38, v39
    v_mfma_f32_16x16x32_bf16 v[64:67], v[48:51], a[68:71], 0
    s_waitcnt lgkmcnt(2)
    v_cvt_pk_bf16_f32 v28, v40, v41
    v_cvt_pk_bf16_f32 v29, v42, v43
    v_mfma_f32_16x16x32_bf16 v[32:35], a[100:103], v[24:27], 0
    s_waitcnt lgkmcnt(1)
    v_cvt_pk_bf16_f32 v30, v44, v45
    v_cvt_pk_bf16_f32 v31, v46, v47
    v_mfma_f32_16x16x32_bf16 v[40:43], a[104:107], v[24:27], 0
    s_waitcnt lgkmcnt(0)
    v_cvt_pk_bf16_f32 v56, v64, v65
    v_cvt_pk_bf16_f32 v57, v66, v67
    v_mfma_f32_16x16x32_bf16 v[36:39], a[112:115], v[24:27], 0
    v_mfma_f32_16x16x32_bf16 v[44:47], a[116:119], v[24:27], 0
    v_mfma_f32_16x16x32_bf16 v[32:35], a[108:111], v[28:31], v[32:35]
L_spec_h2:
    s_cbranch_execz L_spec_hr
    v_mfma_f32_16x16x32_bf16 v[40:43], a[100:103], v[28:31], v[40:43]
    v_mfma_f32_16x16x32_bf16 v[36:39], a[120:123], v[28:31], v[36:39]
    v_mfma_f32_16x16x32_bf16 v[44:47], a[112:115], v[28:31], v[44:47]
    s_nop 2
    v_mfma_f32_16x16x32_bf16 v[68:71], v[52:55], a[68:71], 0
    s_nop 2
    v_mfma_f32_16x16x32_bf16 v[72:75], v[48:51], a[72:75], 0
    s_nop 3
    v_cvt_pk_bf16_f32 v58, v68, v69
    v_pk_mul_f32 v[16:17], v[32:33], v[176:177]
    v_pk_mul_f32 v[32:33], v[32:33], v[184:185]
    v_pk_mul_f32 v[18:19], v[34:35], v[178:179]
    v_pk_mul_f32 v[34:35], v[34:35], v[186:187]
    v_pk_mul_f32 v[20:21], v[36:37], v[180:181]
    v_pk_mul_f32 v[36:37], v[36:37], v[188:189]
    v_pk_mul_f32 v[22:23], v[38:39], v[182:183]
    v_pk_mul_f32 v[38:39], v[38:39], v[190:191]
    v_pk_fma_f32 v[16:17], v[40:41], v[184:185], v[16:17] neg_lo:[1,0,0] neg_hi:[1,0,0]
    v_pk_fma_f32 v[32:33], v[40:41], v[176:177], v[32:33]
    v_pk_fma_f32 v[18:19], v[42:43], v[186:187], v[18:19] neg_lo:[1,0,0] neg_hi:[1,0,0]
    v_pk_fma_f32 v[34:35], v[42:43], v[178:179], v[34:35]
    v_pk_fma_f32 v[20:21], v[44:45], v[188:189], v[20:21] neg_lo:[1,0,0] neg_hi:[1,0,0]
    v_pk_fma_f32 v[36:37], v[44:45], v[180:181], v[36:37]
    v_pk_fma_f32 v[22:23], v[46:47], v[190:191], v[22:23] neg_lo:[1,0,0] neg_hi:[1,0,0]
    v_pk_fma_f32 v[38:39], v[46:47], v[182:183], v[38:39]
    v_mfma_f32_16x16x32_bf16 v[76:79], v[52:55], a[72:75], 0
    s_nop 0
    v_cvt_pk_bf16_f32 v24, v16, v17
    v_cvt_pk_bf16_f32 v28, v32, v33
    v_mfma_f32_16x16x32_bf16 v[96:99], v[80:83], a[76:79], 0
    s_nop 0
    v_cvt_pk_bf16_f32 v25, v18, v19
    v_cvt_pk_bf16_f32 v29, v34, v35
    v_mfma_f32_16x16x32_bf16 v[100:103], v[84:87], a[76:79], 0
    s_nop 0
    v_cvt_pk_bf16_f32 v26, v20, v21
    v_cvt_pk_bf16_f32 v30, v36, v37
    v_mfma_f32_16x16x32_bf16 v[104:107], v[80:83], a[80:83], 0
    s_nop 0
    v_cvt_pk_bf16_f32 v27, v22, v23
    v_cvt_pk_bf16_f32 v31, v38, v39
    v_mfma_f32_16x16x32_bf16 v[108:111], v[84:87], a[80:83], 0
    s_nop 0
    v_cvt_pk_bf16_f32 v59, v70, v71
    v_cvt_pk_bf16_f32 v60, v72, v73
    v_mfma_f32_16x16x32_bf16 v[32:35], v[24:27], a[124:127], 0
    s_nop 0
    v_cvt_pk_bf16_f32 v61, v74, v75
    v_cvt_pk_bf16_f32 v62, v76, v77
    v_mfma_f32_16x16x32_bf16 v[36:39], v[24:27], a[132:135], 0
    v_cvt_pk_bf16_f32 v63, v78, v79
    v_cvt_pk_bf16_f32 v88, v96, v97
    v_mfma_f32_16x16x32_bf16 v[40:43], v[24:27], a[136:139], 0
    v_cvt_pk_bf16_f32 v89, v98, v99
    v_cvt_pk_bf16_f32 v90, v100, v101
    v_mfma_f32_16x16x32_bf16 v[44:47], v[24:27], a[144:147], 0
    v_cvt_pk_bf16_f32 v91, v102, v103
    v_cvt_pk_bf16_f32 v92, v104, v105
    v_mfma_f32_16x16x32_bf16 v[32:35], v[28:31], a[128:131], v[32:35]
    s_nop 0
    v_cvt_pk_bf16_f32 v93, v106, v107
    v_cvt_pk_bf16_f32 v94, v108, v109
    v_mfma_f32_16x16x32_bf16 v[36:39], v[28:31], a[124:127], v[36:39]
    s_nop 0
    v_cvt_pk_bf16_f32 v95, v110, v111
    s_nop 0
    v_mfma_f32_16x16x32_bf16 v[40:43], v[28:31], a[140:143], v[40:43]
    s_nop 0
    v_cvt_pk_bf16_f32 v16, v32, v33
    v_cvt_pk_bf16_f32 v17, v34, v35
    v_mfma_f32_16x16x32_bf16 v[44:47], v[28:31], a[136:139], v[44:47]
    s_nop 0
    v_cvt_pk_bf16_f32 v18, v36, v37
    v_cvt_pk_bf16_f32 v19, v38, v39
    v_mfma_f32_16x16x32_bf16 v[64:67], a[100:103], v[56:59], 0
    s_nop 0
    v_cvt_pk_bf16_f32 v20, v40, v41
    v_cvt_pk_bf16_f32 v21, v42, v43
    v_mfma_f32_16x16x32_bf16 v[32:35], a[148:151], v[16:19], 0
    s_nop 0
    v_cvt_pk_bf16_f32 v22, v44, v45
    v_cvt_pk_bf16_f32 v23, v46, v47
    v_mfma_f32_16x16x32_bf16 v[36:39], a[152:155], v[16:19], 0
    s_nop 2
    v_mfma_f32_16x16x32_bf16 v[40:43], a[148:151], v[20:23], 0
    s_nop 0
    v_cvt_pk_bf16_f32 v24, v32, v33
    v_cvt_pk_bf16_f32 v25, v34, v35
    v_mfma_f32_16x16x32_bf16 v[44:47], a[152:155], v[20:23], 0
    s_nop 0
    v_cvt_pk_bf16_f32 v26, v36, v37
    v_cvt_pk_bf16_f32 v27, v38, v39
    v_mfma_f32_16x16x32_bf16 v[72:75], a[104:107], v[56:59], 0
    s_nop 0
    v_cvt_pk_bf16_f32 v28, v40, v41
    v_cvt_pk_bf16_f32 v29, v42, v43
    v_mfma_f32_16x16x32_bf16 v[68:71], a[112:115], v[56:59], 0
    v_cvt_pk_bf16_f32 v30, v44, v45
    v_cvt_pk_bf16_f32 v31, v46, v47
    v_mfma_f32_16x16x32_bf16 v[76:79], a[116:119], v[56:59], 0
    ds_write_b128 v7, v[24:27] offset:0
    v_mfma_f32_16x16x32_bf16 v[64:67], a[108:111], v[60:63], v[64:67]
    ds_write_b128 v7, v[28:31] offset:256
    v_mfma_f32_16x16x32_bf16 v[72:75], a[100:103], v[60:63], v[72:75]
    v_mfma_f32_16x16x32_bf16 v[68:71], a[120:123], v[60:63], v[68:71]
    v_mfma_f32_16x16x32_bf16 v[76:79], a[112:115], v[60:63], v[76:79]
    s_nop 2
    v_mfma_f32_16x16x32_bf16 v[96:99], a[100:103], v[88:91], 0
    s_nop 2
    v_mfma_f32_16x16x32_bf16 v[104:107], a[104:107], v[88:91], 0
    v_pk_mul_f32 v[48:49], v[64:65], v[192:193]
    v_pk_mul_f32 v[64:65], v[64:65], v[200:201]
    v_pk_mul_f32 v[50:51], v[66:67], v[194:195]
    v_pk_mul_f32 v[66:67], v[66:67], v[202:203]
    v_pk_mul_f32 v[52:53], v[68:69], v[196:197]
    v_pk_mul_f32 v[68:69], v[68:69], v[204:205]
    v_pk_mul_f32 v[54:55], v[70:71], v[198:199]
    v_pk_mul_f32 v[70:71], v[70:71], v[206:207]
    v_pk_fma_f32 v[48:49], v[72:73], v[200:201], v[48:49] neg_lo:[1,0,0] neg_hi:[1,0,0]
    v_pk_fma_f32 v[64:65], v[72:73], v[192:193], v[64:65]
    v_pk_fma_f32 v[50:51], v[74:75], v[202:203], v[50:51] neg_lo:[1,0,0] neg_hi:[1,0,0]
    v_pk_fma_f32 v[66:67], v[74:75], v[194:195], v[66:67]
    v_pk_fma_f32 v[52:53], v[76:77], v[204:205], v[52:53] neg_lo:[1,0,0] neg_hi:[1,0,0]
    v_pk_fma_f32 v[68:69], v[76:77], v[196:197], v[68:69]
    v_pk_fma_f32 v[54:55], v[78:79], v[206:207], v[54:55] neg_lo:[1,0,0] neg_hi:[1,0,0]
    v_pk_fma_f32 v[70:71], v[78:79], v[198:199], v[70:71]
    v_mfma_f32_16x16x32_bf16 v[100:103], a[112:115], v[88:91], 0
    s_waitcnt lgkmcnt(0)
    v_cvt_pk_bf16_f32 v56, v48, v49
    v_cvt_pk_bf16_f32 v60, v64, v65
    v_mfma_f32_16x16x32_bf16 v[108:111], a[116:119], v[88:91], 0
    v_cvt_pk_bf16_f32 v57, v50, v51
    v_cvt_pk_bf16_f32 v61, v66, v67
    v_mfma_f32_16x16x32_bf16 v[96:99], a[108:111], v[92:95], v[96:99]
    v_cvt_pk_bf16_f32 v58, v52, v53
    v_cvt_pk_bf16_f32 v62, v68, v69
    v_mfma_f32_16x16x32_bf16 v[104:107], a[100:103], v[92:95], v[104:107]
    v_cvt_pk_bf16_f32 v59, v54, v55
    v_cvt_pk_bf16_f32 v63, v70, v71
    v_mfma_f32_16x16x32_bf16 v[100:103], a[120:123], v[92:95], v[100:103]
    v_mfma_f32_16x16x32_bf16 v[64:67], v[56:59], a[124:127], 0
    v_mfma_f32_16x16x32_bf16 v[68:71], v[56:59], a[132:135], 0
    v_mfma_f32_16x16x32_bf16 v[72:75], v[56:59], a[136:139], 0
    v_mfma_f32_16x16x32_bf16 v[76:79], v[56:59], a[144:147], 0
    v_mfma_f32_16x16x32_bf16 v[64:67], v[60:63], a[128:131], v[64:67]
    s_nop 2
    v_mfma_f32_16x16x32_bf16 v[68:71], v[60:63], a[124:127], v[68:71]
    s_nop 2
    v_mfma_f32_16x16x32_bf16 v[72:75], v[60:63], a[140:143], v[72:75]
    s_nop 0
    v_cvt_pk_bf16_f32 v48, v64, v65
    v_cvt_pk_bf16_f32 v49, v66, v67
    v_mfma_f32_16x16x32_bf16 v[76:79], v[60:63], a[136:139], v[76:79]
    s_nop 0
    v_cvt_pk_bf16_f32 v50, v68, v69
    v_cvt_pk_bf16_f32 v51, v70, v71
    v_mfma_f32_16x16x32_bf16 v[108:111], a[112:115], v[92:95], v[108:111]
    s_nop 0
    v_cvt_pk_bf16_f32 v52, v72, v73
    v_cvt_pk_bf16_f32 v53, v74, v75
    v_mfma_f32_16x16x32_bf16 v[64:67], a[156:159], v[48:51], 0
    s_nop 0
    v_cvt_pk_bf16_f32 v54, v76, v77
    v_cvt_pk_bf16_f32 v55, v78, v79
    v_mfma_f32_16x16x32_bf16 v[68:71], a[160:163], v[48:51], 0
    s_nop 2
    v_mfma_f32_16x16x32_bf16 v[72:75], a[156:159], v[52:55], 0
    s_nop 0
    v_cvt_pk_bf16_f32 v56, v64, v65
    v_cvt_pk_bf16_f32 v57, v66, v67
    v_mfma_f32_16x16x32_bf16 v[76:79], a[160:163], v[52:55], 0
    s_nop 0
    v_cvt_pk_bf16_f32 v58, v68, v69
    v_cvt_pk_bf16_f32 v59, v70, v71
    s_nop 0
    v_cvt_pk_bf16_f32 v60, v72, v73
    s_nop 1
    v_pk_mul_f32 v[80:81], v[96:97], v[208:209]
    v_pk_mul_f32 v[96:97], v[96:97], v[216:217]
    v_pk_mul_f32 v[82:83], v[98:99], v[210:211]
    v_pk_mul_f32 v[98:99], v[98:99], v[218:219]
    v_pk_mul_f32 v[84:85], v[100:101], v[212:213]
    v_pk_mul_f32 v[100:101], v[100:101], v[220:221]
    v_pk_mul_f32 v[86:87], v[102:103], v[214:215]
    v_pk_mul_f32 v[102:103], v[102:103], v[222:223]
    v_pk_fma_f32 v[80:81], v[104:105], v[216:217], v[80:81] neg_lo:[1,0,0] neg_hi:[1,0,0]
    v_pk_fma_f32 v[96:97], v[104:105], v[208:209], v[96:97]
    v_pk_fma_f32 v[82:83], v[106:107], v[218:219], v[82:83] neg_lo:[1,0,0] neg_hi:[1,0,0]
    v_pk_fma_f32 v[98:99], v[106:107], v[210:211], v[98:99]
    v_pk_fma_f32 v[84:85], v[108:109], v[220:221], v[84:85] neg_lo:[1,0,0] neg_hi:[1,0,0]
    v_pk_fma_f32 v[100:101], v[108:109], v[212:213], v[100:101]
    v_pk_fma_f32 v[86:87], v[110:111], v[222:223], v[86:87] neg_lo:[1,0,0] neg_hi:[1,0,0]
    v_pk_fma_f32 v[102:103], v[110:111], v[214:215], v[102:103]
    v_mfma_f32_16x16x32_bf16 v[128:131], v[112:115], a[84:87], 0
    s_nop 0
    v_cvt_pk_bf16_f32 v61, v74, v75
    v_cvt_pk_bf16_f32 v62, v76, v77
    v_mfma_f32_16x16x32_bf16 v[132:135], v[116:119], a[84:87], 0
    s_nop 0
    v_cvt_pk_bf16_f32 v63, v78, v79
    v_cvt_pk_bf16_f32 v88, v80, v81
    v_mfma_f32_16x16x32_bf16 v[136:139], v[112:115], a[88:91], 0
    s_nop 0
    ds_write_b128 v7, v[56:59] offset:2176
    v_mfma_f32_16x16x32_bf16 v[140:143], v[116:119], a[88:91], 0
    s_nop 0
    ds_write_b128 v7, v[60:63] offset:2432
    v_mfma_f32_16x16x32_bf16 v[160:163], v[144:147], a[92:95], 0
    s_nop 0
    v_cvt_pk_bf16_f32 v92, v96, v97
    v_cvt_pk_bf16_f32 v89, v82, v83
    v_mfma_f32_16x16x32_bf16 v[164:167], v[148:151], a[92:95], 0
    s_nop 0
    v_cvt_pk_bf16_f32 v93, v98, v99
    v_cvt_pk_bf16_f32 v90, v84, v85
    v_mfma_f32_16x16x32_bf16 v[168:171], v[144:147], a[96:99], 0
    s_nop 0
    v_cvt_pk_bf16_f32 v94, v100, v101
    v_cvt_pk_bf16_f32 v91, v86, v87
    v_mfma_f32_16x16x32_bf16 v[172:175], v[148:151], a[96:99], 0
    s_nop 0
    v_cvt_pk_bf16_f32 v95, v102, v103
    v_cvt_pk_bf16_f32 v120, v128, v129
    v_mfma_f32_16x16x32_bf16 v[96:99], v[88:91], a[124:127], 0
    s_nop 0
    v_cvt_pk_bf16_f32 v121, v130, v131
    v_cvt_pk_bf16_f32 v122, v132, v133
    v_mfma_f32_16x16x32_bf16 v[100:103], v[88:91], a[132:135], 0
    v_cvt_pk_bf16_f32 v123, v134, v135
    v_cvt_pk_bf16_f32 v124, v136, v137
    v_mfma_f32_16x16x32_bf16 v[104:107], v[88:91], a[136:139], 0
    s_waitcnt lgkmcnt(1)
    v_cvt_pk_bf16_f32 v125, v138, v139
    v_cvt_pk_bf16_f32 v126, v140, v141
    v_mfma_f32_16x16x32_bf16 v[108:111], v[88:91], a[144:147], 0
    s_waitcnt lgkmcnt(0)
    v_cvt_pk_bf16_f32 v127, v142, v143
    v_cvt_pk_bf16_f32 v152, v160, v161
    v_mfma_f32_16x16x32_bf16 v[96:99], v[92:95], a[128:131], v[96:99]
    s_nop 0
    v_cvt_pk_bf16_f32 v153, v162, v163
    v_cvt_pk_bf16_f32 v154, v164, v165
    v_mfma_f32_16x16x32_bf16 v[100:103], v[92:95], a[124:127], v[100:103]
    s_nop 0
    v_cvt_pk_bf16_f32 v155, v166, v167
    v_cvt_pk_bf16_f32 v156, v168, v169
    v_mfma_f32_16x16x32_bf16 v[104:107], v[92:95], a[140:143], v[104:107]
    s_nop 0
    v_cvt_pk_bf16_f32 v80, v96, v97
    v_cvt_pk_bf16_f32 v81, v98, v99
    v_mfma_f32_16x16x32_bf16 v[108:111], v[92:95], a[136:139], v[108:111]
    s_nop 0
    v_cvt_pk_bf16_f32 v82, v100, v101
    v_cvt_pk_bf16_f32 v83, v102, v103
    v_mfma_f32_16x16x32_bf16 v[128:131], a[100:103], v[120:123], 0
    s_nop 0
    v_cvt_pk_bf16_f32 v84, v104, v105
    v_cvt_pk_bf16_f32 v85, v106, v107
    v_mfma_f32_16x16x32_bf16 v[96:99], a[164:167], v[80:83], 0
    s_nop 0
    v_cvt_pk_bf16_f32 v86, v108, v109
    v_cvt_pk_bf16_f32 v87, v110, v111
    v_mfma_f32_16x16x32_bf16 v[100:103], a[168:171], v[80:83], 0
    s_nop 0
    v_cvt_pk_bf16_f32 v157, v170, v171
    v_cvt_pk_bf16_f32 v158, v172, v173
    v_mfma_f32_16x16x32_bf16 v[104:107], a[164:167], v[84:87], 0
    s_nop 0
    v_cvt_pk_bf16_f32 v88, v96, v97
    v_cvt_pk_bf16_f32 v89, v98, v99
    v_mfma_f32_16x16x32_bf16 v[108:111], a[168:171], v[84:87], 0
    s_nop 0
    v_cvt_pk_bf16_f32 v90, v100, v101
    v_cvt_pk_bf16_f32 v91, v102, v103
    v_mfma_f32_16x16x32_bf16 v[136:139], a[104:107], v[120:123], 0
    s_nop 0
    v_cvt_pk_bf16_f32 v92, v104, v105
    v_cvt_pk_bf16_f32 v93, v106, v107
    v_mfma_f32_16x16x32_bf16 v[132:135], a[112:115], v[120:123], 0
    v_cvt_pk_bf16_f32 v94, v108, v109
    v_cvt_pk_bf16_f32 v95, v110, v111
    v_mfma_f32_16x16x32_bf16 v[140:143], a[116:119], v[120:123], 0
    ds_write_b128 v7, v[88:91] offset:4352
    v_mfma_f32_16x16x32_bf16 v[128:131], a[108:111], v[124:127], v[128:131]
    ds_write_b128 v7, v[92:95] offset:4608
    v_mfma_f32_16x16x32_bf16 v[136:139], a[100:103], v[124:127], v[136:139]
    v_cvt_pk_bf16_f32 v159, v174, v175
    v_mov_b32 v106, 0
    v_mfma_f32_16x16x32_bf16 v[132:135], a[120:123], v[124:127], v[132:135]
    v_mov_b32 v107, 0
    v_mfma_f32_16x16x32_bf16 v[140:143], a[112:115], v[124:127], v[140:143]
    s_nop 2
    v_mfma_f32_16x16x32_bf16 v[160:163], a[100:103], v[152:155], 0
    s_nop 2
    v_mfma_f32_16x16x32_bf16 v[168:171], a[104:107], v[152:155], 0
    v_pk_mul_f32 v[112:113], v[128:129], v[224:225]
    v_pk_mul_f32 v[128:129], v[128:129], v[232:233]
    v_pk_mul_f32 v[114:115], v[130:131], v[226:227]
    v_pk_mul_f32 v[130:131], v[130:131], v[234:235]
    v_pk_mul_f32 v[116:117], v[132:133], v[228:229]
    v_pk_mul_f32 v[132:133], v[132:133], v[236:237]
    v_pk_mul_f32 v[118:119], v[134:135], v[230:231]
    v_pk_mul_f32 v[134:135], v[134:135], v[238:239]
    v_pk_fma_f32 v[112:113], v[136:137], v[232:233], v[112:113] neg_lo:[1,0,0] neg_hi:[1,0,0]
    v_pk_fma_f32 v[128:129], v[136:137], v[224:225], v[128:129]
    v_pk_fma_f32 v[114:115], v[138:139], v[234:235], v[114:115] neg_lo:[1,0,0] neg_hi:[1,0,0]
    v_pk_fma_f32 v[130:131], v[138:139], v[226:227], v[130:131]
    v_pk_fma_f32 v[116:117], v[140:141], v[236:237], v[116:117] neg_lo:[1,0,0] neg_hi:[1,0,0]
    v_pk_fma_f32 v[132:133], v[140:141], v[228:229], v[132:133]
    v_pk_fma_f32 v[118:119], v[142:143], v[238:239], v[118:119] neg_lo:[1,0,0] neg_hi:[1,0,0]
    v_pk_fma_f32 v[134:135], v[142:143], v[230:231], v[134:135]
    v_mfma_f32_16x16x32_bf16 v[164:167], a[112:115], v[152:155], 0
    s_waitcnt lgkmcnt(0)
    v_cvt_pk_bf16_f32 v120, v112, v113
    v_cvt_pk_bf16_f32 v124, v128, v129
    v_mfma_f32_16x16x32_bf16 v[172:175], a[116:119], v[152:155], 0
    v_cvt_pk_bf16_f32 v121, v114, v115
    v_cvt_pk_bf16_f32 v125, v130, v131
    v_mfma_f32_16x16x32_bf16 v[160:163], a[108:111], v[156:159], v[160:163]
    v_cvt_pk_bf16_f32 v122, v116, v117
    v_cvt_pk_bf16_f32 v126, v132, v133
    v_mfma_f32_16x16x32_bf16 v[168:171], a[100:103], v[156:159], v[168:171]
    v_cvt_pk_bf16_f32 v123, v118, v119
    v_cvt_pk_bf16_f32 v127, v134, v135
    v_mfma_f32_16x16x32_bf16 v[164:167], a[120:123], v[156:159], v[164:167]
    v_mfma_f32_16x16x32_bf16 v[128:131], v[120:123], a[124:127], 0
    v_mfma_f32_16x16x32_bf16 v[132:135], v[120:123], a[132:135], 0
    v_mfma_f32_16x16x32_bf16 v[136:139], v[120:123], a[136:139], 0
    v_mfma_f32_16x16x32_bf16 v[140:143], v[120:123], a[144:147], 0
    v_mfma_f32_16x16x32_bf16 v[128:131], v[124:127], a[128:131], v[128:131]
    s_nop 2
    v_mfma_f32_16x16x32_bf16 v[132:135], v[124:127], a[124:127], v[132:135]
    s_nop 2
    v_mfma_f32_16x16x32_bf16 v[136:139], v[124:127], a[140:143], v[136:139]
    s_nop 0
    v_cvt_pk_bf16_f32 v112, v128, v129
    v_cvt_pk_bf16_f32 v113, v130, v131
    v_mfma_f32_16x16x32_bf16 v[140:143], v[124:127], a[136:139], v[140:143]
    s_nop 0
    v_cvt_pk_bf16_f32 v114, v132, v133
    v_cvt_pk_bf16_f32 v115, v134, v135
    v_mfma_f32_16x16x32_bf16 v[172:175], a[112:115], v[156:159], v[172:175]
    s_nop 0
    v_cvt_pk_bf16_f32 v116, v136, v137
    v_cvt_pk_bf16_f32 v117, v138, v139
    v_mfma_f32_16x16x32_bf16 v[128:131], a[172:175], v[112:115], 0
    s_nop 0
    v_cvt_pk_bf16_f32 v118, v140, v141
    v_cvt_pk_bf16_f32 v119, v142, v143
    v_mfma_f32_16x16x32_bf16 v[132:135], a[176:179], v[112:115], 0
    s_nop 2
    v_mfma_f32_16x16x32_bf16 v[136:139], a[172:175], v[116:119], 0
    s_nop 0
    v_cvt_pk_bf16_f32 v120, v128, v129
    v_cvt_pk_bf16_f32 v121, v130, v131
    v_mfma_f32_16x16x32_bf16 v[140:143], a[176:179], v[116:119], 0
    s_nop 0
    v_cvt_pk_bf16_f32 v122, v132, v133
    v_cvt_pk_bf16_f32 v123, v134, v135
    v_mov_b32 v130, 0
    v_cvt_pk_bf16_f32 v124, v136, v137
    s_nop 1
    v_pk_mul_f32 v[144:145], v[160:161], v[240:241]
    v_pk_mul_f32 v[160:161], v[160:161], v[248:249]
    v_pk_mul_f32 v[146:147], v[162:163], v[242:243]
    v_pk_mul_f32 v[162:163], v[162:163], v[250:251]
    v_pk_mul_f32 v[148:149], v[164:165], v[244:245]
    v_pk_mul_f32 v[164:165], v[164:165], v[252:253]
    v_pk_mul_f32 v[150:151], v[166:167], v[246:247]
    v_pk_mul_f32 v[166:167], v[166:167], v[254:255]
    v_pk_fma_f32 v[144:145], v[168:169], v[248:249], v[144:145] neg_lo:[1,0,0] neg_hi:[1,0,0]
    v_pk_fma_f32 v[160:161], v[168:169], v[240:241], v[160:161]
    v_pk_fma_f32 v[146:147], v[170:171], v[250:251], v[146:147] neg_lo:[1,0,0] neg_hi:[1,0,0]
    v_pk_fma_f32 v[162:163], v[170:171], v[242:243], v[162:163]
    v_pk_fma_f32 v[148:149], v[172:173], v[252:253], v[148:149] neg_lo:[1,0,0] neg_hi:[1,0,0]
    v_pk_fma_f32 v[164:165], v[172:173], v[244:245], v[164:165]
    v_pk_fma_f32 v[150:151], v[174:175], v[254:255], v[150:151] neg_lo:[1,0,0] neg_hi:[1,0,0]
    v_pk_fma_f32 v[166:167], v[174:175], v[246:247], v[166:167]
    v_cvt_pk_bf16_f32 v125, v138, v139
    v_cvt_pk_bf16_f32 v126, v140, v141
    v_cvt_pk_bf16_f32 v127, v142, v143
    ds_write_b128 v7, v[120:123] offset:6528
    ds_write_b128 v7, v[124:127] offset:6784
    v_cvt_pk_bf16_f32 v152, v144, v145
    v_cvt_pk_bf16_f32 v156, v160, v161
    v_cvt_pk_bf16_f32 v153, v146, v147
    v_cvt_pk_bf16_f32 v157, v162, v163
    v_cvt_pk_bf16_f32 v154, v148, v149
    v_cvt_pk_bf16_f32 v158, v164, v165
    v_cvt_pk_bf16_f32 v155, v150, v151
    v_cvt_pk_bf16_f32 v159, v166, v167
    v_mov_b32 v118, 0
    v_mfma_f32_16x16x32_bf16 v[160:163], v[152:155], a[124:127], 0
    v_mov_b32 v119, 0
    v_mov_b32 v131, 0
    v_mfma_f32_16x16x32_bf16 v[164:167], v[152:155], a[132:135], 0
    v_mov_b32 v142, 0
    v_mov_b32 v143, 0
    v_mfma_f32_16x16x32_bf16 v[168:171], v[152:155], a[136:139], 0
    v_mfma_f32_16x16x32_bf16 v[172:175], v[152:155], a[144:147], 0
    v_mfma_f32_16x16x32_bf16 v[160:163], v[156:159], a[128:131], v[160:163]
    s_waitcnt lgkmcnt(1)
    s_nop 1
    v_mfma_f32_16x16x32_bf16 v[164:167], v[156:159], a[124:127], v[164:167]
    s_waitcnt lgkmcnt(0)
    s_nop 1
    v_mfma_f32_16x16x32_bf16 v[168:171], v[156:159], a[140:143], v[168:171]
    s_nop 0
    v_cvt_pk_bf16_f32 v144, v160, v161
    v_cvt_pk_bf16_f32 v145, v162, v163
    v_mfma_f32_16x16x32_bf16 v[172:175], v[156:159], a[136:139], v[172:175]
    s_nop 0
    v_cvt_pk_bf16_f32 v146, v164, v165
    v_cvt_pk_bf16_f32 v147, v166, v167
    s_nop 0
    v_cvt_pk_bf16_f32 v148, v168, v169
    v_mfma_f32_16x16x32_bf16 v[160:163], a[180:183], v[144:147], 0
    s_nop 0
    v_cvt_pk_bf16_f32 v149, v170, v171
    v_cvt_pk_bf16_f32 v150, v172, v173
    v_mfma_f32_16x16x32_bf16 v[164:167], a[184:187], v[144:147], 0
    s_nop 0
    v_cvt_pk_bf16_f32 v151, v174, v175
    s_nop 1
    v_mfma_f32_16x16x32_bf16 v[168:171], a[180:183], v[148:151], 0
    s_nop 0
    v_cvt_pk_bf16_f32 v152, v160, v161
    v_cvt_pk_bf16_f32 v153, v162, v163
    v_mfma_f32_16x16x32_bf16 v[172:175], a[184:187], v[148:151], 0
    s_nop 0
    v_cvt_pk_bf16_f32 v154, v164, v165
    v_cvt_pk_bf16_f32 v155, v166, v167
    s_nop 0
    v_cvt_pk_bf16_f32 v156, v168, v169
    v_cvt_pk_bf16_f32 v157, v170, v171
    s_nop 1
    v_cvt_pk_bf16_f32 v158, v172, v173
    v_cvt_pk_bf16_f32 v159, v174, v175
    ds_write_b128 v7, v[152:155] offset:8704
    ds_write_b128 v7, v[156:159] offset:8960
    s_waitcnt lgkmcnt(0)
    s_barrier
    ds_read_b64_tr_b16 v[96:97], v8 offset:0
    ds_read_b64_tr_b16 v[98:99], v8 offset:4352
    ds_read_b64_tr_b16 v[100:101], v8 offset:17408
    ds_read_b64_tr_b16 v[102:103], v8 offset:21760
    ds_read_b64_tr_b16 v[104:105], v9 offset:34816
    ds_read_b64_tr_b16 v[108:109], v8 offset:32
    ds_read_b64_tr_b16 v[110:111], v8 offset:4384
    ds_read_b64_tr_b16 v[112:113], v8 offset:17440
    ds_read_b64_tr_b16 v[114:115], v8 offset:21792
    ds_read_b64_tr_b16 v[116:117], v9 offset:34848
    ds_read_b64_tr_b16 v[120:121], v8 offset:64
    ds_read_b64_tr_b16 v[122:123], v8 offset:4416
    ds_read_b64_tr_b16 v[124:125], v8 offset:17472
    ds_read_b64_tr_b16 v[126:127], v8 offset:21824
    ds_read_b64_tr_b16 v[128:129], v9 offset:34880
    ds_read_b64_tr_b16 v[132:133], v8 offset:96
    ds_read_b64_tr_b16 v[134:135], v8 offset:4448
    ds_read_b64_tr_b16 v[136:137], v8 offset:17504
    ds_read_b64_tr_b16 v[138:139], v8 offset:21856
    ds_read_b64_tr_b16 v[140:141], v9 offset:34912
    s_waitcnt lgkmcnt(15)
    v_mfma_f32_32x32x16_bf16 v[16:31], v[96:99], a[188:191], 0
    s_waitcnt lgkmcnt(15)
    v_mfma_f32_32x32x16_bf16 v[16:31], v[100:103], a[192:195], v[16:31]
    s_waitcnt lgkmcnt(8)
    v_mfma_f32_32x32x16_bf16 v[16:31], v[104:107], a[196:199], v[16:31]
    s_waitcnt lgkmcnt(4)
    s_nop 5
    v_mfma_f32_32x32x16_bf16 v[80:95], v[96:99], a[200:203], 0
    s_waitcnt lgkmcnt(0)
    s_nop 2
    v_cvt_pk_bf16_f32 v16, v16, v17
    v_cvt_pk_bf16_f32 v17, v18, v19
    v_cvt_pk_bf16_f32 v18, v20, v21
    v_mfma_f32_32x32x16_bf16 v[80:95], v[100:103], a[204:207], v[80:95]
    v_cvt_pk_bf16_f32 v19, v22, v23
    v_cvt_pk_bf16_f32 v20, v24, v25
    v_cvt_pk_bf16_f32 v21, v26, v27
    v_cvt_pk_bf16_f32 v22, v28, v29
    v_cvt_pk_bf16_f32 v23, v30, v31
    v_mfma_f32_32x32x16_bf16 v[80:95], v[104:107], a[208:211], v[80:95]
    buffer_store_dwordx4 v[16:19], v14, s[8:11], s76 offen offset:0 sc1
    v_mfma_f32_32x32x16_bf16 v[32:47], v[108:111], a[188:191], 0
    buffer_store_dwordx4 v[20:23], v14, s[8:11], s76 offen offset:1280 sc1
    v_mfma_f32_32x32x16_bf16 v[32:47], v[112:115], a[192:195], v[32:47]
    v_mfma_f32_32x32x16_bf16 v[32:47], v[116:119], a[196:199], v[32:47]
    s_nop 6
    v_mfma_f32_32x32x16_bf16 v[80:95], v[108:111], a[212:215], v[80:95]
    s_nop 3
    v_cvt_pk_bf16_f32 v32, v32, v33
    v_cvt_pk_bf16_f32 v33, v34, v35
    v_cvt_pk_bf16_f32 v34, v36, v37
    v_mfma_f32_32x32x16_bf16 v[80:95], v[112:115], a[216:219], v[80:95]
    v_cvt_pk_bf16_f32 v35, v38, v39
    v_cvt_pk_bf16_f32 v36, v40, v41
    v_cvt_pk_bf16_f32 v37, v42, v43
    v_cvt_pk_bf16_f32 v38, v44, v45
    v_cvt_pk_bf16_f32 v39, v46, v47
    v_mfma_f32_32x32x16_bf16 v[80:95], v[116:119], a[220:223], v[80:95]
    buffer_store_dwordx4 v[32:35], v14, s[8:11], s85 offen offset:0 sc1
    v_mfma_f32_32x32x16_bf16 v[48:63], v[120:123], a[188:191], 0
    buffer_store_dwordx4 v[36:39], v14, s[8:11], s85 offen offset:1280 sc1
    v_mfma_f32_32x32x16_bf16 v[48:63], v[124:127], a[192:195], v[48:63]
    v_mfma_f32_32x32x16_bf16 v[48:63], v[128:131], a[196:199], v[48:63]
    s_nop 6
    v_mfma_f32_32x32x16_bf16 v[80:95], v[120:123], a[224:227], v[80:95]
    s_nop 3
    v_cvt_pk_bf16_f32 v48, v48, v49
    v_cvt_pk_bf16_f32 v49, v50, v51
    v_cvt_pk_bf16_f32 v50, v52, v53
    v_mfma_f32_32x32x16_bf16 v[80:95], v[124:127], a[228:231], v[80:95]
    v_cvt_pk_bf16_f32 v51, v54, v55
    v_cvt_pk_bf16_f32 v52, v56, v57
    v_cvt_pk_bf16_f32 v53, v58, v59
    v_cvt_pk_bf16_f32 v54, v60, v61
    v_cvt_pk_bf16_f32 v55, v62, v63
    v_mfma_f32_32x32x16_bf16 v[80:95], v[128:131], a[232:235], v[80:95]
    buffer_store_dwordx4 v[48:51], v14, s[8:11], s88 offen offset:0 sc1
    v_mfma_f32_32x32x16_bf16 v[64:79], v[132:135], a[188:191], 0
    buffer_store_dwordx4 v[52:55], v14, s[8:11], s88 offen offset:1280 sc1
    v_mfma_f32_32x32x16_bf16 v[64:79], v[136:139], a[192:195], v[64:79]
    v_mfma_f32_32x32x16_bf16 v[64:79], v[140:143], a[196:199], v[64:79]
    s_nop 6
    v_mfma_f32_32x32x16_bf16 v[80:95], v[132:135], a[236:239], v[80:95]
    s_nop 3
    v_cvt_pk_bf16_f32 v64, v64, v65
    v_cvt_pk_bf16_f32 v65, v66, v67
    v_cvt_pk_bf16_f32 v66, v68, v69
    v_mfma_f32_32x32x16_bf16 v[80:95], v[136:139], a[240:243], v[80:95]
    v_cvt_pk_bf16_f32 v67, v70, v71
    v_cvt_pk_bf16_f32 v68, v72, v73
    v_cvt_pk_bf16_f32 v69, v74, v75
    v_cvt_pk_bf16_f32 v70, v76, v77
    v_cvt_pk_bf16_f32 v71, v78, v79
    v_mfma_f32_32x32x16_bf16 v[80:95], v[140:143], a[244:247], v[80:95]
    s_nop 1
    buffer_store_dwordx4 v[64:67], v14, s[8:11], s89 offen offset:0 sc1
    buffer_store_dwordx4 v[68:71], v14, s[8:11], s89 offen offset:1280 sc1
    s_nop 7
    v_cvt_pk_bf16_f32 v80, v80, v81
    v_cvt_pk_bf16_f32 v81, v82, v83
    v_cvt_pk_bf16_f32 v82, v84, v85
    v_cvt_pk_bf16_f32 v83, v86, v87
    v_cvt_pk_bf16_f32 v84, v88, v89
    v_cvt_pk_bf16_f32 v85, v90, v91
    v_cvt_pk_bf16_f32 v86, v92, v93
    v_cvt_pk_bf16_f32 v87, v94, v95
    buffer_store_dwordx4 v[80:83], v15, s[8:11], s76 offen offset:1024 sc1
    buffer_store_dwordx4 v[84:87], v15, s[8:11], s76 offen offset:2304 sc1
    s_waitcnt vmcnt(0)
    s_barrier
    buffer_store_dwordx2 v[10:11], v3, s[8:11], s77 offen offset:640 sc1
    s_cmp_lg_u32 s2, 0
    s_cbranch_scc1 L_sdone
    s_mul_i32 s56, s32, 192
    v_add_u32 v6, s56, v0
    v_mul_u32_u24 v6, 128, v6
    s_mov_b32 s60, 12648448
    s_mov_b32 s61, 12656640
    s_mov_b32 s62, 12664832
    buffer_load_dwordx2 v[16:17], v6, s[8:11], s60 offen sc1
    buffer_load_dwordx2 v[18:19], v6, s[8:11], s61 offen sc1
    buffer_load_dwordx2 v[20:21], v6, s[8:11], s62 offen sc1
    s_waitcnt vmcnt(2)
    v_cmp_ne_u64 vcc, s[86:87], v[16:17]
    s_waitcnt vmcnt(1)
    v_cmp_ne_u64 s[56:57], s[86:87], v[18:19]
    s_or_b64 vcc, vcc, s[56:57]
    s_waitcnt vmcnt(0)
    v_cmp_ne_u64 s[56:57], s[86:87], v[20:21]
    s_or_b64 vcc, vcc, s[56:57]
    s_cbranch_vccnz L_slow_all
L_back_all:
L_spec_h3:
    s_cbranch_execz L_spec_hr
    s_barrier
    buffer_store_dwordx2 v[10:11], v3, s[8:11], 0 offen sc1
L_sdone:
L_end2:
    s_endpgm
L_slow_ns:
    s_mov_b32 s93, 0
L_spin_ns:
    buffer_load_dwordx4 v[108:111], v2, s[8:11], s61 offen sc1
    buffer_load_dwordx4 v[112:115], v2, s[8:11], s62 offen sc1
    buffer_load_dwordx4 v[116:119], v2, s[8:11], s63 offen sc1
    s_waitcnt vmcnt(0)
    v_cmp_ne_u64 vcc, s[86:87], v[110:111]
    v_cmp_ne_u64 s[56:57], s[86:87], v[114:115]
    v_cmp_ne_u64 s[58:59], s[86:87], v[118:119]
    s_or_b64 vcc, vcc, s[56:57]
    s_or_b64 vcc, vcc, s[58:59]
    s_nop 1
    s_cbranch_vccz L_back_ns
    s_sleep 2
    s_add_u32 s93, s93, 1
    s_cmp_lt_u32 s93, 20000
    s_cbranch_scc1 L_spin_ns
    s_branch L_back_ns
L_slow_tf:
    s_mov_b32 s93, 0
L_spin_tf:
    buffer_load_dwordx2 v[130:131], v121, s[8:11], s81 offen offset:512 sc1
    s_waitcnt vmcnt(0)
    v_cmp_ne_u64 vcc, s[86:87], v[130:131]
    s_nop 1
    s_cbranch_vccz L_back_tf
    s_sleep 2
    s_add_u32 s93, s93, 1
    s_cmp_lt_u32 s93, 20000
    s_cbranch_scc1 L_spin_tf
    s_branch L_back_tf
L_slow_all:
    s_mov_b32 s93, 0
L_spin_all:
    buffer_load_dwordx2 v[16:17], v6, s[8:11], s60 offen sc1
    buffer_load_dwordx2 v[18:19], v6, s[8:11], s61 offen sc1
    buffer_load_dwordx2 v[20:21], v6, s[8:11], s62 offen sc1
    s_waitcnt vmcnt(0)
    v_cmp_ne_u64 vcc, s[86:87], v[16:17]
    v_cmp_ne_u64 s[56:57], s[86:87], v[18:19]
    s_or_b64 vcc, vcc, s[56:57]
    v_cmp_ne_u64 s[56:57], s[86:87], v[20:21]
    s_or_b64 vcc, vcc, s[56:57]
    s_nop 1
    s_cbranch_vccz L_back_all
    s_sleep 8
    s_add_u32 s93, s93, 1
    s_cmp_lt_u32 s93, 20000
    s_cbranch_scc1 L_spin_all
    s_branch L_back_all
L_code_end:
    s_endpgm
.section .rodata,"a"
.p2align 6
.amdhsa_kernel recurrent_scan__spectral_gfnet__geglu_ffn__prompt_kernel
  .amdhsa_next_free_vgpr 512
  .amdhsa_next_free_sgpr 102
  .amdhsa_accum_offset 256
  .amdhsa_group_segment_fixed_size 0
  .amdhsa_kernarg_size 80
  .amdhsa_user_sgpr_count 2
  .amdhsa_user_sgpr_kernarg_segment_ptr 1
  .amdhsa_system_sgpr_workgroup_id_x 1
.end_amdhsa_kernel
.text
```
